```python
import torch

def _softmax(x, axis=-1):
    return torch.softmax(x, dim=axis)
def _gelu(x):
    return torch.nn.functional.gelu(x, approximate="tanh")
def _silu(x):
    return torch.nn.functional.silu(x)
def _sigmoid(x):
    return torch.sigmoid(x)
def _layernorm(x, axis=-1, eps=1e-5):
    m = x.mean(dim=axis, keepdim=True)
    v = x.var(dim=axis, keepdim=True, unbiased=False)
    return (x - m) / torch.sqrt(v + eps)
def _scatter_add(tgt, idx, src, axis=0):
    return tgt.clone().index_add_(axis, idx, src)
def _segment_sum(src, seg, n):
    out = torch.zeros((n,) + src.shape[1:], dtype=src.dtype)
    return out.index_add_(0, seg, src)
def _pad(x, pw):
    flat = tuple(v for pair in reversed(pw) for v in pair)
    return torch.nn.functional.pad(x, flat)

kernel_name = 'standalone__gqa_softmax__near_ridge'

def setup_inputs():

    _w = (lambda a: (lambda t: t.to(torch.bfloat16) if t.is_floating_point() else t)(torch.as_tensor(a)))
    B, Hq, Hkv, Sq, Sk, D = 32, 32, 16, 384, 512, 128
    return {
        "q": _w((lambda *s: torch.randn(*s, dtype=torch.bfloat16) * 0.8)(B, Hq, Sq, D)),
        "k": _w((lambda *s: torch.randn(*s, dtype=torch.bfloat16) * 0.8)(B, Hkv, Sk, D)),
        "v": _w((lambda *s: torch.randn(*s, dtype=torch.bfloat16) * 0.05)(B, Hkv, Sk, D)),
    }

def reference(q, k, v):
    B, Hq, Sq, D = q.shape
    Hkv = k.shape[1]
    rep = Hq // Hkv
    k = (lambda x, n, axis: torch.repeat_interleave(x, n, dim=axis))(k, rep, axis=1)
    v = (lambda x, n, axis: torch.repeat_interleave(x, n, dim=axis))(v, rep, axis=1)
    scale = D ** -0.5
    scores = torch.einsum("bhqd,bhkd->bhqk", q, k) * scale
    p = _softmax(scores, axis=-1)
    return torch.einsum("bhqk,bhkd->bhqd", p, v)
```

```asm
; @launch grid=(256,1,1) block=(256,1,1) lds=163840
.amdgcn_target "amdgcn-amd-amdhsa--gfx950"
.text
.globl standalone__gqa_softmax__near_ridge_kernel
.p2align 8
.type standalone__gqa_softmax__near_ridge_kernel,@function
standalone__gqa_softmax__near_ridge_kernel:
s_cmpk_ge_u32 s2, 256
s_cbranch_scc1 Lend
s_load_dwordx2 s[4:5], s[0:1], 0
s_load_dwordx2 s[8:9], s[0:1], 8
s_load_dwordx2 s[12:13], s[0:1], 16
s_load_dwordx2 s[16:17], s[0:1], 24
v_lshrrev_b32 v56, 6, v0
s_getpc_b64 s[52:53]
Lpc:
s_lshl_b32 s37, s2, 9
s_and_b32 s37, s37, 0xf000
s_min_u32 s37, s37, Lslow - Lpc - 4096
v_lshl_add_u32 v59, v0, 4, s37
global_load_dwordx4 v[48:51], v59, s[52:53]
v_readfirstlane_b32 s20, v56
v_and_b32 v0, 63, v0
v_lshrrev_b32 v58, 4, v0
v_and_b32 v57, 15, v0
v_and_b32 v59, 7, v0
v_xor_b32 v59, v59, v58
v_lshlrev_b32 v59, 4, v59
v_lshrrev_b32 v60, 3, v0
v_mul_u32_u24 v6, 96, v56
v_add_u32 v5, v6, v60
v_lshl_add_u32 v5, v5, 8, v59
v_xor_b32 v59, v57, v58
v_lshl_add_u32 v60, v56, 3, v58
v_lshl_add_u32 v3, v60, 4, v59
v_lshlrev_b32 v3, 4, v3
v_and_b32 v60, 2, v58
v_add_u32 v60, v60, v58
v_lshl_add_u32 v60, v60, 2, v56
v_lshl_add_u32 v4, v60, 4, v57
v_lshlrev_b32 v4, 4, v4
s_lshr_b32 s37, s2, 4
s_and_b32 s28, s2, 7
s_lshl3_add_u32 s37, s37, s28
s_lshl_b32 s36, s37, 17
s_lshr_b32 s28, s2, 3
s_and_b32 s28, s28, 1
s_lshl1_add_u32 s37, s37, s28
s_mul_i32 s35, s37, 98304
s_add_u32 s34, s20, 4
s_mulk_i32 s34, 8448
s_mul_i32 s21, s20, 2112
s_add_u32 s22, s21, 67584
s_mov_b32 s26, s36
s_mov_b32 s6, 100663296
s_mov_b32 s10, 67108864
s_mov_b32 s14, s10
s_mov_b32 s7, 0x20000
s_mov_b32 s11, s7
s_mov_b32 s15, s7
s_waitcnt lgkmcnt(0)
s_add_u32 m0, s34, 0
s_add_u32 s28, s35, 0
buffer_load_dwordx4 v5, s[4:7], s28 offen offset:0 nt lds
buffer_load_dwordx4 v5, s[4:7], s28 offen offset:2048 nt lds
s_mov_b32 s19, 0x20000
s_mov_b32 s25, s35
s_mov_b32 s27, s36
v_and_b32 v59, 7, v57
v_add_u32 v6, v6, v59
v_lshlrev_b32 v6, 8, v6
v_lshrrev_b32 v59, 3, v57
v_lshl_add_u32 v6, v59, 6, v6
v_lshl_add_u32 v6, v58, 4, v6
v_lshrrev_b32 v59, 2, v57
v_mul_u32_u24 v1, 2112, v59
v_add_u32 v2, 67584, v1
v_and_b32 v59, 3, v57
v_lshl_add_u32 v1, v59, 8, v1
v_xor_b32 v60, v58, v59
v_lshl_add_u32 v1, v60, 4, v1
v_lshrrev_b32 v60, 1, v58
v_lshl_add_u32 v2, v60, 9, v2
v_and_b32 v60, 1, v58
v_mul_u32_u24 v60, 1032, v60
v_add_u32 v2, v2, v60
v_lshl_add_u32 v2, v59, 4, v2
v_mov_b32 v60, 0x3f803f80
v_xor_b32 v24, v59, v58
v_cmp_gt_u32 vcc, 2, v24
s_nop 1
v_cndmask_b32 v24, 0, v60, vcc
v_mov_b32 v25, v24
v_mov_b32 v26, v24
v_mov_b32 v27, v24
v_and_b32 v60, 1, v57
v_mul_u32_u24 v60, 0xaaaa, v60
v_add_u32 v60, 0x4444, v60
v_lshl_or_b32 v28, v60, 16, v60
v_mov_b64 v[12:13], 0
v_mov_b64 v[14:15], 0
v_mov_b64 v[16:17], 0
v_mov_b64 v[18:19], 0
v_mov_b64 v[20:21], 0
v_mov_b64 v[22:23], 0
v_bfe_u32 v59, v57, 1, 2
v_xor_b32 v59, v59, v58
v_lshlrev_b32 v59, 4, v59
v_lshl_add_u32 v8, v57, 7, v59
v_lshrrev_b32 v59, 3, v57
v_lshl_add_u32 v8, v59, 10, v8
s_mul_i32 s51, s20, 7168
s_add_u32 s51, s51, 135168
v_add_u32 v10, s34, v8
v_add_u32 v11, 67584, v10
v_add_u32 v8, s51, v8
s_mov_b32 s23, 0
s_mov_b32 s29, 0
s_mov_b32 s38, 1
s_mov_b32 s30, 0x3e0293ee
s_mov_b32 s31, 0x3e0293ee
s_mov_b32 s32, 0xffff0000
s_mov_b32 s33, 0x30800000
s_mov_b32 s56, 0x23000000
s_mov_b32 vcc_lo, 0xff00ff00
s_mov_b32 vcc_hi, 0xff00ff00
s_mov_b32 s18, 0
s_mov_b32 s39, 0
s_mov_b32 s50, 0
s_mov_b32 s24, s25
s_add_u32 s25, s25, 25165824
s_add_u32 s27, s27, 16777216
s_cmp_lt_u32 s23, 3
s_cselect_b32 s6, s6, 0
s_add_u32 m0, s34, 896
s_nop 0
buffer_load_dwordx4 v5, s[4:7], s28 offen offset:128 nt lds
buffer_load_dwordx4 v5, s[4:7], s28 offen offset:2176 nt lds
s_add_u32 m0, s21, 0
s_nop 0
buffer_load_dwordx4 v3, s[8:11], s26 offen offset:0 nt lds
buffer_load_dwordx4 v3, s[8:11], s26 offen offset:1024 nt lds
s_add_u32 m0, s22, 0
s_nop 0
buffer_load_dwordx4 v4, s[12:15], s26 offen offset:0 nt lds
s_sub_u32 m0, m0, 1016
s_nop 0
buffer_load_dwordx4 v4, s[12:15], s26 offen offset:2048 nt lds
s_add_u32 s26, s26, 8192
s_add_u32 m0, s34, 4096
s_add_u32 s28, s35, 4096
buffer_load_dwordx4 v5, s[4:7], s28 offen offset:0 nt lds
buffer_load_dwordx4 v5, s[4:7], s28 offen offset:2048 nt lds
s_add_u32 m0, s34, 4992
s_nop 0
buffer_load_dwordx4 v5, s[4:7], s28 offen offset:128 nt lds
buffer_load_dwordx4 v5, s[4:7], s28 offen offset:2176 nt lds
s_waitcnt vmcnt(10)
ds_read_b128 v[160:163], v10 offset:0
ds_read_b128 v[164:167], v10 offset:64
s_waitcnt vmcnt(8)
ds_read_b128 v[168:171], v10 offset:1024
ds_read_b128 v[172:175], v10 offset:1088
s_waitcnt lgkmcnt(0)
v_lshlrev_b32 v56, 16, v160
v_and_b32 v57, s32, v160
v_lshlrev_b32 v58, 16, v161
v_and_b32 v59, s32, v161
v_lshlrev_b32 v60, 16, v162
v_and_b32 v61, s32, v162
v_lshlrev_b32 v62, 16, v163
v_and_b32 v63, s32, v163
v_pk_mul_f32 v[56:57], v[56:57], s[30:31]
v_pk_mul_f32 v[58:59], v[58:59], s[30:31]
v_pk_mul_f32 v[60:61], v[60:61], s[30:31]
v_pk_mul_f32 v[62:63], v[62:63], s[30:31]
v_cvt_pk_bf16_f32 v160, v56, v57
v_cvt_pk_bf16_f32 v161, v58, v59
v_cvt_pk_bf16_f32 v162, v60, v61
v_cvt_pk_bf16_f32 v163, v62, v63
v_lshlrev_b32 v56, 16, v164
v_and_b32 v57, s32, v164
v_lshlrev_b32 v58, 16, v165
v_and_b32 v59, s32, v165
v_lshlrev_b32 v60, 16, v166
v_and_b32 v61, s32, v166
v_lshlrev_b32 v62, 16, v167
v_and_b32 v63, s32, v167
v_pk_mul_f32 v[56:57], v[56:57], s[30:31]
v_pk_mul_f32 v[58:59], v[58:59], s[30:31]
v_pk_mul_f32 v[60:61], v[60:61], s[30:31]
v_pk_mul_f32 v[62:63], v[62:63], s[30:31]
v_cvt_pk_bf16_f32 v164, v56, v57
v_cvt_pk_bf16_f32 v165, v58, v59
v_cvt_pk_bf16_f32 v166, v60, v61
v_cvt_pk_bf16_f32 v167, v62, v63
v_accvgpr_write_b32 a96, v160
v_accvgpr_write_b32 a97, v161
v_accvgpr_write_b32 a98, v162
v_accvgpr_write_b32 a99, v163
v_accvgpr_write_b32 a100, v164
v_accvgpr_write_b32 a101, v165
v_accvgpr_write_b32 a102, v166
v_accvgpr_write_b32 a103, v167
s_add_u32 m0, s34, 67584
s_add_u32 s28, s35, 8192
buffer_load_dwordx4 v5, s[4:7], s28 offen offset:0 nt lds
buffer_load_dwordx4 v5, s[4:7], s28 offen offset:2048 nt lds
v_lshlrev_b32 v56, 16, v168
v_and_b32 v57, s32, v168
v_lshlrev_b32 v58, 16, v169
v_and_b32 v59, s32, v169
v_lshlrev_b32 v60, 16, v170
v_and_b32 v61, s32, v170
v_lshlrev_b32 v62, 16, v171
v_and_b32 v63, s32, v171
v_pk_mul_f32 v[56:57], v[56:57], s[30:31]
v_pk_mul_f32 v[58:59], v[58:59], s[30:31]
v_pk_mul_f32 v[60:61], v[60:61], s[30:31]
v_pk_mul_f32 v[62:63], v[62:63], s[30:31]
v_cvt_pk_bf16_f32 v168, v56, v57
v_cvt_pk_bf16_f32 v169, v58, v59
v_cvt_pk_bf16_f32 v170, v60, v61
v_cvt_pk_bf16_f32 v171, v62, v63
v_lshlrev_b32 v56, 16, v172
v_and_b32 v57, s32, v172
v_lshlrev_b32 v58, 16, v173
v_and_b32 v59, s32, v173
v_lshlrev_b32 v60, 16, v174
v_and_b32 v61, s32, v174
v_lshlrev_b32 v62, 16, v175
v_and_b32 v63, s32, v175
v_pk_mul_f32 v[56:57], v[56:57], s[30:31]
v_pk_mul_f32 v[58:59], v[58:59], s[30:31]
v_pk_mul_f32 v[60:61], v[60:61], s[30:31]
v_pk_mul_f32 v[62:63], v[62:63], s[30:31]
v_cvt_pk_bf16_f32 v172, v56, v57
v_cvt_pk_bf16_f32 v173, v58, v59
v_cvt_pk_bf16_f32 v174, v60, v61
v_cvt_pk_bf16_f32 v175, v62, v63
v_accvgpr_write_b32 a104, v168
v_accvgpr_write_b32 a105, v169
v_accvgpr_write_b32 a106, v170
v_accvgpr_write_b32 a107, v171
v_accvgpr_write_b32 a108, v172
v_accvgpr_write_b32 a109, v173
v_accvgpr_write_b32 a110, v174
v_accvgpr_write_b32 a111, v175
s_waitcnt vmcnt(6)
s_barrier
ds_read_b128 a[192:195], v1 offset:0
ds_read_b128 a[196:199], v1 offset:64
ds_read_b128 a[200:203], v1 offset:128
ds_read_b128 a[204:207], v1 offset:192
ds_read_b128 a[208:211], v1 offset:1024
ds_read_b128 a[212:215], v1 offset:1088
ds_read_b128 a[216:219], v1 offset:1152
ds_read_b128 a[220:223], v1 offset:1216
ds_read_b64_tr_b16 a[224:225], v2 offset:0
ds_read_b64_tr_b16 a[226:227], v2 offset:256
ds_read_b64_tr_b16 a[228:229], v2 offset:8
ds_read_b64_tr_b16 a[230:231], v2 offset:264
ds_read_b64_tr_b16 a[232:233], v2 offset:64
ds_read_b64_tr_b16 a[234:235], v2 offset:320
ds_read_b64_tr_b16 a[236:237], v2 offset:72
ds_read_b64_tr_b16 a[238:239], v2 offset:328
ds_read_b64_tr_b16 a[240:241], v2 offset:128
ds_read_b64_tr_b16 a[242:243], v2 offset:384
ds_read_b64_tr_b16 a[244:245], v2 offset:136
ds_read_b64_tr_b16 a[246:247], v2 offset:392
ds_read_b64_tr_b16 a[248:249], v2 offset:192
ds_read_b64_tr_b16 a[250:251], v2 offset:448
ds_read_b64_tr_b16 a[252:253], v2 offset:200
ds_read_b64_tr_b16 a[254:255], v2 offset:456
s_add_u32 m0, s34, 68480
s_nop 0
buffer_load_dwordx4 v5, s[4:7], s28 offen offset:128 nt lds
buffer_load_dwordx4 v5, s[4:7], s28 offen offset:2176 nt lds
s_add_u32 m0, s34, 71680
s_add_u32 s28, s35, 12288
buffer_load_dwordx4 v5, s[4:7], s28 offen offset:0 nt lds
buffer_load_dwordx4 v5, s[4:7], s28 offen offset:2048 nt lds
s_waitcnt lgkmcnt(15)
v_mfma_f32_16x16x32_bf16 v[32:35], a[192:195], a[96:99], 0
v_mfma_f32_16x16x32_bf16 v[32:35], a[196:199], a[100:103], v[32:35]
v_mfma_f32_16x16x32_bf16 v[32:35], a[200:203], a[104:107], v[32:35]
v_mfma_f32_16x16x32_bf16 v[32:35], a[204:207], a[108:111], v[32:35]
v_mfma_f32_16x16x32_bf16 v[36:39], a[208:211], a[96:99], 0
v_mfma_f32_16x16x32_bf16 v[36:39], a[212:215], a[100:103], v[36:39]
v_mfma_f32_16x16x32_bf16 v[36:39], a[216:219], a[104:107], v[36:39]
v_mfma_f32_16x16x32_bf16 v[36:39], a[220:223], a[108:111], v[36:39]
s_waitcnt vmcnt(8)
ds_read_b128 v[176:179], v10 offset:4096
ds_read_b128 v[180:183], v10 offset:4160
s_waitcnt vmcnt(6)
ds_read_b128 v[184:187], v10 offset:5120
ds_read_b128 v[188:191], v10 offset:5184
s_waitcnt lgkmcnt(0)
s_add_u32 m0, s34, 72576
s_nop 0
buffer_load_dwordx4 v5, s[4:7], s28 offen offset:128 nt lds
buffer_load_dwordx4 v5, s[4:7], s28 offen offset:2176 nt lds
v_lshlrev_b32 v56, 16, v176
v_and_b32 v57, s32, v176
v_lshlrev_b32 v58, 16, v177
v_and_b32 v59, s32, v177
v_lshlrev_b32 v60, 16, v178
v_and_b32 v61, s32, v178
v_lshlrev_b32 v62, 16, v179
v_and_b32 v63, s32, v179
v_pk_mul_f32 v[56:57], v[56:57], s[30:31]
v_pk_mul_f32 v[58:59], v[58:59], s[30:31]
v_pk_mul_f32 v[60:61], v[60:61], s[30:31]
v_pk_mul_f32 v[62:63], v[62:63], s[30:31]
v_cvt_pk_bf16_f32 v176, v56, v57
v_cvt_pk_bf16_f32 v177, v58, v59
v_cvt_pk_bf16_f32 v178, v60, v61
v_cvt_pk_bf16_f32 v179, v62, v63
v_lshlrev_b32 v56, 16, v180
v_and_b32 v57, s32, v180
v_lshlrev_b32 v58, 16, v181
v_and_b32 v59, s32, v181
v_lshlrev_b32 v60, 16, v182
v_and_b32 v61, s32, v182
v_lshlrev_b32 v62, 16, v183
v_and_b32 v63, s32, v183
v_pk_mul_f32 v[56:57], v[56:57], s[30:31]
v_pk_mul_f32 v[58:59], v[58:59], s[30:31]
v_pk_mul_f32 v[60:61], v[60:61], s[30:31]
v_pk_mul_f32 v[62:63], v[62:63], s[30:31]
v_cvt_pk_bf16_f32 v180, v56, v57
v_cvt_pk_bf16_f32 v181, v58, v59
v_cvt_pk_bf16_f32 v182, v60, v61
v_cvt_pk_bf16_f32 v183, v62, v63
v_accvgpr_write_b32 a112, v176
v_accvgpr_write_b32 a113, v177
v_accvgpr_write_b32 a114, v178
v_accvgpr_write_b32 a115, v179
v_accvgpr_write_b32 a116, v180
v_accvgpr_write_b32 a117, v181
v_accvgpr_write_b32 a118, v182
v_accvgpr_write_b32 a119, v183
s_add_u32 m0, s34, 0
s_add_u32 s28, s35, 16384
buffer_load_dwordx4 v5, s[4:7], s28 offen offset:0 nt lds
buffer_load_dwordx4 v5, s[4:7], s28 offen offset:2048 nt lds
v_lshlrev_b32 v56, 16, v184
v_and_b32 v57, s32, v184
v_lshlrev_b32 v58, 16, v185
v_and_b32 v59, s32, v185
v_lshlrev_b32 v60, 16, v186
v_and_b32 v61, s32, v186
v_lshlrev_b32 v62, 16, v187
v_and_b32 v63, s32, v187
v_pk_mul_f32 v[56:57], v[56:57], s[30:31]
v_pk_mul_f32 v[58:59], v[58:59], s[30:31]
v_pk_mul_f32 v[60:61], v[60:61], s[30:31]
v_pk_mul_f32 v[62:63], v[62:63], s[30:31]
v_cvt_pk_bf16_f32 v184, v56, v57
v_cvt_pk_bf16_f32 v185, v58, v59
v_cvt_pk_bf16_f32 v186, v60, v61
v_cvt_pk_bf16_f32 v187, v62, v63
v_lshlrev_b32 v56, 16, v188
v_and_b32 v57, s32, v188
v_lshlrev_b32 v58, 16, v189
v_and_b32 v59, s32, v189
v_lshlrev_b32 v60, 16, v190
v_and_b32 v61, s32, v190
v_lshlrev_b32 v62, 16, v191
v_and_b32 v63, s32, v191
v_pk_mul_f32 v[56:57], v[56:57], s[30:31]
v_pk_mul_f32 v[58:59], v[58:59], s[30:31]
v_pk_mul_f32 v[60:61], v[60:61], s[30:31]
v_pk_mul_f32 v[62:63], v[62:63], s[30:31]
v_cvt_pk_bf16_f32 v188, v56, v57
v_cvt_pk_bf16_f32 v189, v58, v59
v_cvt_pk_bf16_f32 v190, v60, v61
v_cvt_pk_bf16_f32 v191, v62, v63
v_accvgpr_write_b32 a120, v184
v_accvgpr_write_b32 a121, v185
v_accvgpr_write_b32 a122, v186
v_accvgpr_write_b32 a123, v187
v_accvgpr_write_b32 a124, v188
v_accvgpr_write_b32 a125, v189
v_accvgpr_write_b32 a126, v190
v_accvgpr_write_b32 a127, v191
v_mfma_f32_16x16x32_bf16 v[40:43], a[192:195], a[112:115], 0
v_exp_f32 v32, v32
v_mfma_f32_16x16x32_bf16 v[40:43], a[196:199], a[116:119], v[40:43]
v_mfma_f32_16x16x32_bf16 v[40:43], a[200:203], a[120:123], v[40:43]
v_exp_f32 v33, v33
v_mfma_f32_16x16x32_bf16 v[40:43], a[204:207], a[124:127], v[40:43]
v_exp_f32 v34, v34
v_exp_f32 v35, v35
v_cvt_pk_bf16_f32 v48, v32, v33
v_cvt_pk_bf16_f32 v49, v34, v35
v_mfma_f32_16x16x32_bf16 v[44:47], a[208:211], a[112:115], 0
v_exp_f32 v36, v36
v_mfma_f32_16x16x32_bf16 v[44:47], a[212:215], a[116:119], v[44:47]
v_mfma_f32_16x16x32_bf16 v[44:47], a[216:219], a[120:123], v[44:47]
v_exp_f32 v37, v37
v_mfma_f32_16x16x32_bf16 v[44:47], a[220:223], a[124:127], v[44:47]
v_exp_f32 v38, v38
v_exp_f32 v39, v39
v_cvt_pk_bf16_f32 v50, v36, v37
v_cvt_pk_bf16_f32 v51, v38, v39
s_waitcnt vmcnt(8)
ds_read_b128 v[192:195], v11 offset:0
ds_read_b128 v[196:199], v11 offset:64
s_waitcnt vmcnt(6)
ds_read_b128 v[200:203], v11 offset:1024
ds_read_b128 v[204:207], v11 offset:1088
s_waitcnt lgkmcnt(0)
s_add_u32 m0, s34, 896
s_nop 0
buffer_load_dwordx4 v5, s[4:7], s28 offen offset:128 nt lds
buffer_load_dwordx4 v5, s[4:7], s28 offen offset:2176 nt lds
v_lshlrev_b32 v56, 16, v192
v_and_b32 v57, s32, v192
v_lshlrev_b32 v58, 16, v193
v_and_b32 v59, s32, v193
v_lshlrev_b32 v60, 16, v194
v_and_b32 v61, s32, v194
v_lshlrev_b32 v62, 16, v195
v_and_b32 v63, s32, v195
v_pk_mul_f32 v[56:57], v[56:57], s[30:31]
v_pk_mul_f32 v[58:59], v[58:59], s[30:31]
v_pk_mul_f32 v[60:61], v[60:61], s[30:31]
v_pk_mul_f32 v[62:63], v[62:63], s[30:31]
v_cvt_pk_bf16_f32 v192, v56, v57
v_cvt_pk_bf16_f32 v193, v58, v59
v_cvt_pk_bf16_f32 v194, v60, v61
v_cvt_pk_bf16_f32 v195, v62, v63
v_lshlrev_b32 v56, 16, v196
v_and_b32 v57, s32, v196
v_lshlrev_b32 v58, 16, v197
v_and_b32 v59, s32, v197
v_lshlrev_b32 v60, 16, v198
v_and_b32 v61, s32, v198
v_lshlrev_b32 v62, 16, v199
v_and_b32 v63, s32, v199
v_pk_mul_f32 v[56:57], v[56:57], s[30:31]
v_pk_mul_f32 v[58:59], v[58:59], s[30:31]
v_pk_mul_f32 v[60:61], v[60:61], s[30:31]
v_pk_mul_f32 v[62:63], v[62:63], s[30:31]
v_cvt_pk_bf16_f32 v196, v56, v57
v_cvt_pk_bf16_f32 v197, v58, v59
v_cvt_pk_bf16_f32 v198, v60, v61
v_cvt_pk_bf16_f32 v199, v62, v63
v_accvgpr_write_b32 a128, v192
v_accvgpr_write_b32 a129, v193
v_accvgpr_write_b32 a130, v194
v_accvgpr_write_b32 a131, v195
v_accvgpr_write_b32 a132, v196
v_accvgpr_write_b32 a133, v197
v_accvgpr_write_b32 a134, v198
v_accvgpr_write_b32 a135, v199
s_add_u32 m0, s34, 4096
s_add_u32 s28, s35, 20480
buffer_load_dwordx4 v5, s[4:7], s28 offen offset:0 nt lds
buffer_load_dwordx4 v5, s[4:7], s28 offen offset:2048 nt lds
v_lshlrev_b32 v56, 16, v200
v_and_b32 v57, s32, v200
v_lshlrev_b32 v58, 16, v201
v_and_b32 v59, s32, v201
v_lshlrev_b32 v60, 16, v202
v_and_b32 v61, s32, v202
v_lshlrev_b32 v62, 16, v203
v_and_b32 v63, s32, v203
v_pk_mul_f32 v[56:57], v[56:57], s[30:31]
v_pk_mul_f32 v[58:59], v[58:59], s[30:31]
v_pk_mul_f32 v[60:61], v[60:61], s[30:31]
v_pk_mul_f32 v[62:63], v[62:63], s[30:31]
v_cvt_pk_bf16_f32 v200, v56, v57
v_cvt_pk_bf16_f32 v201, v58, v59
v_cvt_pk_bf16_f32 v202, v60, v61
v_cvt_pk_bf16_f32 v203, v62, v63
v_lshlrev_b32 v56, 16, v204
v_and_b32 v57, s32, v204
v_lshlrev_b32 v58, 16, v205
v_and_b32 v59, s32, v205
v_lshlrev_b32 v60, 16, v206
v_and_b32 v61, s32, v206
v_lshlrev_b32 v62, 16, v207
v_and_b32 v63, s32, v207
v_pk_mul_f32 v[56:57], v[56:57], s[30:31]
v_pk_mul_f32 v[58:59], v[58:59], s[30:31]
v_pk_mul_f32 v[60:61], v[60:61], s[30:31]
v_pk_mul_f32 v[62:63], v[62:63], s[30:31]
v_cvt_pk_bf16_f32 v204, v56, v57
v_cvt_pk_bf16_f32 v205, v58, v59
v_cvt_pk_bf16_f32 v206, v60, v61
v_cvt_pk_bf16_f32 v207, v62, v63
v_accvgpr_write_b32 a136, v200
v_accvgpr_write_b32 a137, v201
v_accvgpr_write_b32 a138, v202
v_accvgpr_write_b32 a139, v203
v_accvgpr_write_b32 a140, v204
v_accvgpr_write_b32 a141, v205
v_accvgpr_write_b32 a142, v206
v_accvgpr_write_b32 a143, v207
v_mfma_f32_16x16x32_bf16 v[32:35], a[192:195], a[128:131], 0
v_exp_f32 v40, v40
v_mfma_f32_16x16x32_bf16 v[32:35], a[196:199], a[132:135], v[32:35]
v_mfma_f32_16x16x32_bf16 v[32:35], a[200:203], a[136:139], v[32:35]
v_exp_f32 v41, v41
v_mfma_f32_16x16x32_bf16 v[32:35], a[204:207], a[140:143], v[32:35]
v_mfma_f32_16x16x32_bf16 a[0:3], a[224:227], v[48:51], 0
v_exp_f32 v42, v42
v_mfma_f32_16x16x32_bf16 a[4:7], a[228:231], v[48:51], 0
v_mfma_f32_16x16x32_bf16 a[8:11], a[232:235], v[48:51], 0
v_exp_f32 v43, v43
v_mfma_f32_16x16x32_bf16 a[12:15], a[236:239], v[48:51], 0
v_cvt_pk_bf16_f32 v52, v40, v41
v_cvt_pk_bf16_f32 v53, v42, v43
v_mfma_f32_16x16x32_bf16 v[36:39], a[208:211], a[128:131], 0
v_exp_f32 v44, v44
v_mfma_f32_16x16x32_bf16 v[36:39], a[212:215], a[132:135], v[36:39]
v_mfma_f32_16x16x32_bf16 v[36:39], a[216:219], a[136:139], v[36:39]
v_exp_f32 v45, v45
v_mfma_f32_16x16x32_bf16 v[36:39], a[220:223], a[140:143], v[36:39]
v_mfma_f32_16x16x32_bf16 a[16:19], a[240:243], v[48:51], 0
v_exp_f32 v46, v46
v_mfma_f32_16x16x32_bf16 a[20:23], a[244:247], v[48:51], 0
v_mfma_f32_16x16x32_bf16 a[24:27], a[248:251], v[48:51], 0
v_exp_f32 v47, v47
v_mfma_f32_16x16x32_bf16 a[28:31], a[252:255], v[48:51], 0
v_cvt_pk_bf16_f32 v54, v44, v45
v_cvt_pk_bf16_f32 v55, v46, v47
s_waitcnt vmcnt(8)
ds_read_b128 v[208:211], v11 offset:4096
ds_read_b128 v[212:215], v11 offset:4160
s_waitcnt vmcnt(6)
ds_read_b128 v[216:219], v11 offset:5120
ds_read_b128 v[220:223], v11 offset:5184
s_waitcnt lgkmcnt(0)
s_add_u32 m0, s34, 4992
s_nop 0
buffer_load_dwordx4 v5, s[4:7], s28 offen offset:128 nt lds
buffer_load_dwordx4 v5, s[4:7], s28 offen offset:2176 nt lds
v_lshlrev_b32 v56, 16, v208
v_and_b32 v57, s32, v208
v_lshlrev_b32 v58, 16, v209
v_and_b32 v59, s32, v209
v_lshlrev_b32 v60, 16, v210
v_and_b32 v61, s32, v210
v_lshlrev_b32 v62, 16, v211
v_and_b32 v63, s32, v211
v_pk_mul_f32 v[56:57], v[56:57], s[30:31]
v_pk_mul_f32 v[58:59], v[58:59], s[30:31]
v_pk_mul_f32 v[60:61], v[60:61], s[30:31]
v_pk_mul_f32 v[62:63], v[62:63], s[30:31]
v_cvt_pk_bf16_f32 v208, v56, v57
v_cvt_pk_bf16_f32 v209, v58, v59
v_cvt_pk_bf16_f32 v210, v60, v61
v_cvt_pk_bf16_f32 v211, v62, v63
v_lshlrev_b32 v56, 16, v212
v_and_b32 v57, s32, v212
v_lshlrev_b32 v58, 16, v213
v_and_b32 v59, s32, v213
v_lshlrev_b32 v60, 16, v214
v_and_b32 v61, s32, v214
v_lshlrev_b32 v62, 16, v215
v_and_b32 v63, s32, v215
v_pk_mul_f32 v[56:57], v[56:57], s[30:31]
v_pk_mul_f32 v[58:59], v[58:59], s[30:31]
v_pk_mul_f32 v[60:61], v[60:61], s[30:31]
v_pk_mul_f32 v[62:63], v[62:63], s[30:31]
v_cvt_pk_bf16_f32 v212, v56, v57
v_cvt_pk_bf16_f32 v213, v58, v59
v_cvt_pk_bf16_f32 v214, v60, v61
v_cvt_pk_bf16_f32 v215, v62, v63
v_accvgpr_write_b32 a144, v208
v_accvgpr_write_b32 a145, v209
v_accvgpr_write_b32 a146, v210
v_accvgpr_write_b32 a147, v211
v_accvgpr_write_b32 a148, v212
v_accvgpr_write_b32 a149, v213
v_accvgpr_write_b32 a150, v214
v_accvgpr_write_b32 a151, v215
s_add_u32 m0, s21, 8448
s_nop 0
buffer_load_dwordx4 v3, s[8:11], s26 offen offset:0 nt lds
buffer_load_dwordx4 v3, s[8:11], s26 offen offset:1024 nt lds
v_lshlrev_b32 v56, 16, v216
v_and_b32 v57, s32, v216
v_lshlrev_b32 v58, 16, v217
v_and_b32 v59, s32, v217
v_lshlrev_b32 v60, 16, v218
v_and_b32 v61, s32, v218
v_lshlrev_b32 v62, 16, v219
v_and_b32 v63, s32, v219
v_pk_mul_f32 v[56:57], v[56:57], s[30:31]
v_pk_mul_f32 v[58:59], v[58:59], s[30:31]
v_pk_mul_f32 v[60:61], v[60:61], s[30:31]
v_pk_mul_f32 v[62:63], v[62:63], s[30:31]
v_cvt_pk_bf16_f32 v216, v56, v57
v_cvt_pk_bf16_f32 v217, v58, v59
v_cvt_pk_bf16_f32 v218, v60, v61
v_cvt_pk_bf16_f32 v219, v62, v63
v_lshlrev_b32 v56, 16, v220
v_and_b32 v57, s32, v220
v_lshlrev_b32 v58, 16, v221
v_and_b32 v59, s32, v221
v_lshlrev_b32 v60, 16, v222
v_and_b32 v61, s32, v222
v_lshlrev_b32 v62, 16, v223
v_and_b32 v63, s32, v223
v_pk_mul_f32 v[56:57], v[56:57], s[30:31]
v_pk_mul_f32 v[58:59], v[58:59], s[30:31]
v_pk_mul_f32 v[60:61], v[60:61], s[30:31]
v_pk_mul_f32 v[62:63], v[62:63], s[30:31]
v_cvt_pk_bf16_f32 v220, v56, v57
v_cvt_pk_bf16_f32 v221, v58, v59
v_cvt_pk_bf16_f32 v222, v60, v61
v_cvt_pk_bf16_f32 v223, v62, v63
v_accvgpr_write_b32 a152, v216
v_accvgpr_write_b32 a153, v217
v_accvgpr_write_b32 a154, v218
v_accvgpr_write_b32 a155, v219
v_accvgpr_write_b32 a156, v220
v_accvgpr_write_b32 a157, v221
v_accvgpr_write_b32 a158, v222
v_accvgpr_write_b32 a159, v223
v_mfma_f32_16x16x32_bf16 v[40:43], a[192:195], a[144:147], 0
v_exp_f32 v32, v32
v_mfma_f32_16x16x32_bf16 v[40:43], a[196:199], a[148:151], v[40:43]
v_mfma_f32_16x16x32_bf16 v[40:43], a[200:203], a[152:155], v[40:43]
v_exp_f32 v33, v33
v_mfma_f32_16x16x32_bf16 v[40:43], a[204:207], a[156:159], v[40:43]
v_smfmac_f32_16x16x64_bf16 v[12:15], v[24:27], v[48:55], v28
v_mfma_f32_16x16x32_bf16 a[32:35], a[224:227], v[52:55], 0
v_exp_f32 v34, v34
v_mfma_f32_16x16x32_bf16 a[36:39], a[228:231], v[52:55], 0
v_mfma_f32_16x16x32_bf16 a[40:43], a[232:235], v[52:55], 0
v_exp_f32 v35, v35
v_mfma_f32_16x16x32_bf16 a[44:47], a[236:239], v[52:55], 0
v_cvt_pk_bf16_f32 v48, v32, v33
v_cvt_pk_bf16_f32 v49, v34, v35
v_mfma_f32_16x16x32_bf16 v[44:47], a[208:211], a[144:147], 0
v_exp_f32 v36, v36
v_mfma_f32_16x16x32_bf16 v[44:47], a[212:215], a[148:151], v[44:47]
v_mfma_f32_16x16x32_bf16 v[44:47], a[216:219], a[152:155], v[44:47]
v_exp_f32 v37, v37
v_mfma_f32_16x16x32_bf16 v[44:47], a[220:223], a[156:159], v[44:47]
v_mfma_f32_16x16x32_bf16 a[48:51], a[240:243], v[52:55], 0
v_exp_f32 v38, v38
v_mfma_f32_16x16x32_bf16 a[52:55], a[244:247], v[52:55], 0
v_mfma_f32_16x16x32_bf16 a[56:59], a[248:251], v[52:55], 0
v_exp_f32 v39, v39
v_mfma_f32_16x16x32_bf16 a[60:63], a[252:255], v[52:55], 0
v_cvt_pk_bf16_f32 v50, v36, v37
v_cvt_pk_bf16_f32 v51, v38, v39
s_waitcnt vmcnt(8)
ds_read_b128 v[224:227], v10 offset:0
ds_read_b128 v[228:231], v10 offset:64
s_waitcnt vmcnt(6)
ds_read_b128 v[232:235], v10 offset:1024
ds_read_b128 v[236:239], v10 offset:1088
s_waitcnt lgkmcnt(0)
s_add_u32 m0, s22, 8448
s_nop 0
buffer_load_dwordx4 v4, s[12:15], s26 offen offset:0 nt lds
s_sub_u32 m0, m0, 1016
s_nop 0
buffer_load_dwordx4 v4, s[12:15], s26 offen offset:2048 nt lds
s_add_u32 s26, s26, 8192
v_lshlrev_b32 v56, 16, v224
v_and_b32 v57, s32, v224
v_lshlrev_b32 v58, 16, v225
v_and_b32 v59, s32, v225
v_lshlrev_b32 v60, 16, v226
v_and_b32 v61, s32, v226
v_lshlrev_b32 v62, 16, v227
v_and_b32 v63, s32, v227
v_pk_mul_f32 v[56:57], v[56:57], s[30:31]
v_pk_mul_f32 v[58:59], v[58:59], s[30:31]
v_pk_mul_f32 v[60:61], v[60:61], s[30:31]
v_pk_mul_f32 v[62:63], v[62:63], s[30:31]
v_cvt_pk_bf16_f32 v224, v56, v57
v_cvt_pk_bf16_f32 v225, v58, v59
v_cvt_pk_bf16_f32 v226, v60, v61
v_cvt_pk_bf16_f32 v227, v62, v63
v_lshlrev_b32 v56, 16, v228
v_and_b32 v57, s32, v228
v_lshlrev_b32 v58, 16, v229
v_and_b32 v59, s32, v229
v_lshlrev_b32 v60, 16, v230
v_and_b32 v61, s32, v230
v_lshlrev_b32 v62, 16, v231
v_and_b32 v63, s32, v231
v_pk_mul_f32 v[56:57], v[56:57], s[30:31]
v_pk_mul_f32 v[58:59], v[58:59], s[30:31]
v_pk_mul_f32 v[60:61], v[60:61], s[30:31]
v_pk_mul_f32 v[62:63], v[62:63], s[30:31]
v_cvt_pk_bf16_f32 v228, v56, v57
v_cvt_pk_bf16_f32 v229, v58, v59
v_cvt_pk_bf16_f32 v230, v60, v61
v_cvt_pk_bf16_f32 v231, v62, v63
v_accvgpr_write_b32 a160, v224
v_accvgpr_write_b32 a161, v225
v_accvgpr_write_b32 a162, v226
v_accvgpr_write_b32 a163, v227
v_accvgpr_write_b32 a164, v228
v_accvgpr_write_b32 a165, v229
v_accvgpr_write_b32 a166, v230
v_accvgpr_write_b32 a167, v231
s_add_u32 m0, s21, 16896
s_nop 0
buffer_load_dwordx4 v3, s[8:11], s26 offen offset:0 nt lds
buffer_load_dwordx4 v3, s[8:11], s26 offen offset:1024 nt lds
v_lshlrev_b32 v56, 16, v232
v_and_b32 v57, s32, v232
v_lshlrev_b32 v58, 16, v233
v_and_b32 v59, s32, v233
v_lshlrev_b32 v60, 16, v234
v_and_b32 v61, s32, v234
v_lshlrev_b32 v62, 16, v235
v_and_b32 v63, s32, v235
v_pk_mul_f32 v[56:57], v[56:57], s[30:31]
v_pk_mul_f32 v[58:59], v[58:59], s[30:31]
v_pk_mul_f32 v[60:61], v[60:61], s[30:31]
v_pk_mul_f32 v[62:63], v[62:63], s[30:31]
v_cvt_pk_bf16_f32 v232, v56, v57
v_cvt_pk_bf16_f32 v233, v58, v59
v_cvt_pk_bf16_f32 v234, v60, v61
v_cvt_pk_bf16_f32 v235, v62, v63
v_lshlrev_b32 v56, 16, v236
v_and_b32 v57, s32, v236
v_lshlrev_b32 v58, 16, v237
v_and_b32 v59, s32, v237
v_lshlrev_b32 v60, 16, v238
v_and_b32 v61, s32, v238
v_lshlrev_b32 v62, 16, v239
v_and_b32 v63, s32, v239
v_pk_mul_f32 v[56:57], v[56:57], s[30:31]
v_pk_mul_f32 v[58:59], v[58:59], s[30:31]
v_pk_mul_f32 v[60:61], v[60:61], s[30:31]
v_pk_mul_f32 v[62:63], v[62:63], s[30:31]
v_cvt_pk_bf16_f32 v236, v56, v57
v_cvt_pk_bf16_f32 v237, v58, v59
v_cvt_pk_bf16_f32 v238, v60, v61
v_cvt_pk_bf16_f32 v239, v62, v63
v_accvgpr_write_b32 a168, v232
v_accvgpr_write_b32 a169, v233
v_accvgpr_write_b32 a170, v234
v_accvgpr_write_b32 a171, v235
v_accvgpr_write_b32 a172, v236
v_accvgpr_write_b32 a173, v237
v_accvgpr_write_b32 a174, v238
v_accvgpr_write_b32 a175, v239
s_add_u32 m0, s22, 16896
s_nop 0
buffer_load_dwordx4 v4, s[12:15], s26 offen offset:0 nt lds
s_sub_u32 m0, m0, 1016
s_nop 0
buffer_load_dwordx4 v4, s[12:15], s26 offen offset:2048 nt lds
s_add_u32 s26, s26, 8192
v_mfma_f32_16x16x32_bf16 v[32:35], a[192:195], a[160:163], 0
v_exp_f32 v40, v40
v_mfma_f32_16x16x32_bf16 v[32:35], a[196:199], a[164:167], v[32:35]
v_mfma_f32_16x16x32_bf16 v[32:35], a[200:203], a[168:171], v[32:35]
v_exp_f32 v41, v41
v_mfma_f32_16x16x32_bf16 v[32:35], a[204:207], a[172:175], v[32:35]
v_mfma_f32_16x16x32_bf16 a[64:67], a[224:227], v[48:51], 0
v_exp_f32 v42, v42
v_mfma_f32_16x16x32_bf16 a[68:71], a[228:231], v[48:51], 0
v_mfma_f32_16x16x32_bf16 a[72:75], a[232:235], v[48:51], 0
v_exp_f32 v43, v43
v_mfma_f32_16x16x32_bf16 a[76:79], a[236:239], v[48:51], 0
v_cvt_pk_bf16_f32 v52, v40, v41
v_cvt_pk_bf16_f32 v53, v42, v43
v_mfma_f32_16x16x32_bf16 v[36:39], a[208:211], a[160:163], 0
v_exp_f32 v44, v44
v_mfma_f32_16x16x32_bf16 v[36:39], a[212:215], a[164:167], v[36:39]
v_mfma_f32_16x16x32_bf16 v[36:39], a[216:219], a[168:171], v[36:39]
v_exp_f32 v45, v45
v_mfma_f32_16x16x32_bf16 v[36:39], a[220:223], a[172:175], v[36:39]
v_mfma_f32_16x16x32_bf16 a[80:83], a[240:243], v[48:51], 0
v_exp_f32 v46, v46
v_mfma_f32_16x16x32_bf16 a[84:87], a[244:247], v[48:51], 0
v_mfma_f32_16x16x32_bf16 a[88:91], a[248:251], v[48:51], 0
v_exp_f32 v47, v47
v_mfma_f32_16x16x32_bf16 a[92:95], a[252:255], v[48:51], 0
v_cvt_pk_bf16_f32 v54, v44, v45
v_cvt_pk_bf16_f32 v55, v46, v47
s_waitcnt vmcnt(10)
ds_read_b128 v[240:243], v10 offset:4096
ds_read_b128 v[244:247], v10 offset:4160
s_waitcnt vmcnt(8)
ds_read_b128 v[248:251], v10 offset:5120
ds_read_b128 v[252:255], v10 offset:5184
s_waitcnt lgkmcnt(0)
s_barrier
v_lshlrev_b32 v56, 16, v240
v_and_b32 v57, s32, v240
v_lshlrev_b32 v58, 16, v241
v_and_b32 v59, s32, v241
v_lshlrev_b32 v60, 16, v242
v_and_b32 v61, s32, v242
v_lshlrev_b32 v62, 16, v243
v_and_b32 v63, s32, v243
v_pk_mul_f32 v[56:57], v[56:57], s[30:31]
v_pk_mul_f32 v[58:59], v[58:59], s[30:31]
v_pk_mul_f32 v[60:61], v[60:61], s[30:31]
v_pk_mul_f32 v[62:63], v[62:63], s[30:31]
v_cvt_pk_bf16_f32 v240, v56, v57
v_cvt_pk_bf16_f32 v241, v58, v59
v_cvt_pk_bf16_f32 v242, v60, v61
v_cvt_pk_bf16_f32 v243, v62, v63
v_lshlrev_b32 v56, 16, v244
v_and_b32 v57, s32, v244
v_lshlrev_b32 v58, 16, v245
v_and_b32 v59, s32, v245
v_lshlrev_b32 v60, 16, v246
v_and_b32 v61, s32, v246
v_lshlrev_b32 v62, 16, v247
v_and_b32 v63, s32, v247
v_pk_mul_f32 v[56:57], v[56:57], s[30:31]
v_pk_mul_f32 v[58:59], v[58:59], s[30:31]
v_pk_mul_f32 v[60:61], v[60:61], s[30:31]
v_pk_mul_f32 v[62:63], v[62:63], s[30:31]
v_cvt_pk_bf16_f32 v244, v56, v57
v_cvt_pk_bf16_f32 v245, v58, v59
v_cvt_pk_bf16_f32 v246, v60, v61
v_cvt_pk_bf16_f32 v247, v62, v63
v_accvgpr_write_b32 a176, v240
v_accvgpr_write_b32 a177, v241
v_accvgpr_write_b32 a178, v242
v_accvgpr_write_b32 a179, v243
v_accvgpr_write_b32 a180, v244
v_accvgpr_write_b32 a181, v245
v_accvgpr_write_b32 a182, v246
v_accvgpr_write_b32 a183, v247
s_add_u32 m0, s21, 25344
s_nop 0
buffer_load_dwordx4 v3, s[8:11], s26 offen offset:0 nt lds
buffer_load_dwordx4 v3, s[8:11], s26 offen offset:1024 nt lds
v_lshlrev_b32 v56, 16, v248
v_and_b32 v57, s32, v248
v_lshlrev_b32 v58, 16, v249
v_and_b32 v59, s32, v249
v_lshlrev_b32 v60, 16, v250
v_and_b32 v61, s32, v250
v_lshlrev_b32 v62, 16, v251
v_and_b32 v63, s32, v251
v_pk_mul_f32 v[56:57], v[56:57], s[30:31]
v_pk_mul_f32 v[58:59], v[58:59], s[30:31]
v_pk_mul_f32 v[60:61], v[60:61], s[30:31]
v_pk_mul_f32 v[62:63], v[62:63], s[30:31]
v_cvt_pk_bf16_f32 v248, v56, v57
v_cvt_pk_bf16_f32 v249, v58, v59
v_cvt_pk_bf16_f32 v250, v60, v61
v_cvt_pk_bf16_f32 v251, v62, v63
v_lshlrev_b32 v56, 16, v252
v_and_b32 v57, s32, v252
v_lshlrev_b32 v58, 16, v253
v_and_b32 v59, s32, v253
v_lshlrev_b32 v60, 16, v254
v_and_b32 v61, s32, v254
v_lshlrev_b32 v62, 16, v255
v_and_b32 v63, s32, v255
v_pk_mul_f32 v[56:57], v[56:57], s[30:31]
v_pk_mul_f32 v[58:59], v[58:59], s[30:31]
v_pk_mul_f32 v[60:61], v[60:61], s[30:31]
v_pk_mul_f32 v[62:63], v[62:63], s[30:31]
v_cvt_pk_bf16_f32 v252, v56, v57
v_cvt_pk_bf16_f32 v253, v58, v59
v_cvt_pk_bf16_f32 v254, v60, v61
v_cvt_pk_bf16_f32 v255, v62, v63
v_accvgpr_write_b32 a184, v248
v_accvgpr_write_b32 a185, v249
v_accvgpr_write_b32 a186, v250
v_accvgpr_write_b32 a187, v251
v_accvgpr_write_b32 a188, v252
v_accvgpr_write_b32 a189, v253
v_accvgpr_write_b32 a190, v254
v_accvgpr_write_b32 a191, v255
s_waitcnt vmcnt(6)
s_barrier
s_add_u32 m0, s22, 25344
s_nop 0
buffer_load_dwordx4 v4, s[12:15], s26 offen offset:0 nt lds
s_sub_u32 m0, m0, 1016
s_nop 0
buffer_load_dwordx4 v4, s[12:15], s26 offen offset:2048 nt lds
s_add_u32 s26, s26, 8192
v_mfma_f32_16x16x32_bf16 v[40:43], a[192:195], a[176:179], 0
s_add_u32 m0, s21, 33792
v_exp_f32 v32, v32
v_mfma_f32_16x16x32_bf16 v[40:43], a[196:199], a[180:183], v[40:43]
ds_read_b128 a[192:195], v1 offset:8448
ds_read_b128 a[196:199], v1 offset:8512
v_mfma_f32_16x16x32_bf16 v[40:43], a[200:203], a[184:187], v[40:43]
v_exp_f32 v33, v33
v_mfma_f32_16x16x32_bf16 v[40:43], a[204:207], a[188:191], v[40:43]
ds_read_b128 a[200:203], v1 offset:8576
ds_read_b128 a[204:207], v1 offset:8640
v_smfmac_f32_16x16x64_bf16 v[16:19], v[24:27], v[48:55], v28
buffer_load_dwordx4 v3, s[8:11], s26 offen offset:0 nt lds
v_mfma_f32_16x16x32_bf16 v[64:67], a[224:227], v[52:55], 0
v_exp_f32 v34, v34
v_mfma_f32_16x16x32_bf16 v[68:71], a[228:231], v[52:55], 0
v_mfma_f32_16x16x32_bf16 v[72:75], a[232:235], v[52:55], 0
v_exp_f32 v35, v35
v_mfma_f32_16x16x32_bf16 v[76:79], a[236:239], v[52:55], 0
v_cvt_pk_bf16_f32 v48, v32, v33
v_cvt_pk_bf16_f32 v49, v34, v35
v_mfma_f32_16x16x32_bf16 v[44:47], a[208:211], a[176:179], 0
v_exp_f32 v36, v36
v_mfma_f32_16x16x32_bf16 v[44:47], a[212:215], a[180:183], v[44:47]
ds_read_b128 a[208:211], v1 offset:9472
ds_read_b128 a[212:215], v1 offset:9536
v_mfma_f32_16x16x32_bf16 v[44:47], a[216:219], a[184:187], v[44:47]
v_exp_f32 v37, v37
v_mfma_f32_16x16x32_bf16 v[44:47], a[220:223], a[188:191], v[44:47]
ds_read_b128 a[216:219], v1 offset:9600
ds_read_b128 a[220:223], v1 offset:9664
v_mfma_f32_16x16x32_bf16 v[80:83], a[240:243], v[52:55], 0
v_exp_f32 v38, v38
v_mfma_f32_16x16x32_bf16 v[84:87], a[244:247], v[52:55], 0
buffer_load_dwordx4 v3, s[8:11], s26 offen offset:1024 nt lds
v_mfma_f32_16x16x32_bf16 v[88:91], a[248:251], v[52:55], 0
s_add_u32 m0, s22, 33792
v_exp_f32 v39, v39
v_mfma_f32_16x16x32_bf16 v[92:95], a[252:255], v[52:55], 0
s_waitcnt lgkmcnt(4)
v_cvt_pk_bf16_f32 v50, v36, v37
v_cvt_pk_bf16_f32 v51, v38, v39
v_mfma_f32_16x16x32_bf16 v[32:35], a[192:195], a[96:99], 0
v_exp_f32 v40, v40
v_mfma_f32_16x16x32_bf16 v[32:35], a[196:199], a[100:103], v[32:35]
buffer_load_dwordx4 v4, s[12:15], s26 offen offset:0 nt lds
v_mfma_f32_16x16x32_bf16 v[32:35], a[200:203], a[104:107], v[32:35]
s_sub_u32 m0, m0, 1016
v_exp_f32 v41, v41
v_mfma_f32_16x16x32_bf16 v[32:35], a[204:207], a[108:111], v[32:35]
buffer_load_dwordx4 v4, s[12:15], s26 offen offset:2048 nt lds
v_mfma_f32_16x16x32_bf16 v[96:99], a[224:227], v[48:51], 0
s_add_u32 s26, s26, 8192
v_exp_f32 v42, v42
v_mfma_f32_16x16x32_bf16 v[100:103], a[228:231], v[48:51], 0
s_add_u32 s28, s25, 0
v_mfma_f32_16x16x32_bf16 v[104:107], a[232:235], v[48:51], 0
s_add_u32 m0, s51, 0
v_exp_f32 v43, v43
v_mfma_f32_16x16x32_bf16 v[108:111], a[236:239], v[48:51], 0
s_waitcnt lgkmcnt(0)
v_cvt_pk_bf16_f32 v52, v40, v41
v_cvt_pk_bf16_f32 v53, v42, v43
v_mfma_f32_16x16x32_bf16 v[36:39], a[208:211], a[96:99], 0
v_exp_f32 v44, v44
v_mfma_f32_16x16x32_bf16 v[36:39], a[212:215], a[100:103], v[36:39]
buffer_load_dwordx4 v5, s[4:7], s28 offen offset:0 nt lds
v_mfma_f32_16x16x32_bf16 v[36:39], a[216:219], a[104:107], v[36:39]
v_exp_f32 v45, v45
v_mfma_f32_16x16x32_bf16 v[36:39], a[220:223], a[108:111], v[36:39]
v_mfma_f32_16x16x32_bf16 v[112:115], a[240:243], v[48:51], 0
v_exp_f32 v46, v46
v_mfma_f32_16x16x32_bf16 v[116:119], a[244:247], v[48:51], 0
buffer_load_dwordx4 v5, s[4:7], s28 offen offset:2048 nt lds
v_mfma_f32_16x16x32_bf16 v[120:123], a[248:251], v[48:51], 0
s_add_u32 m0, s51, 896
v_exp_f32 v47, v47
v_mfma_f32_16x16x32_bf16 v[124:127], a[252:255], v[48:51], 0
v_cvt_pk_bf16_f32 v54, v44, v45
v_cvt_pk_bf16_f32 v55, v46, v47
v_mfma_f32_16x16x32_bf16 v[40:43], a[192:195], a[112:115], 0
v_exp_f32 v32, v32
v_mfma_f32_16x16x32_bf16 v[40:43], a[196:199], a[116:119], v[40:43]
v_exp_f32 v33, v33
v_mfma_f32_16x16x32_bf16 v[40:43], a[200:203], a[120:123], v[40:43]
v_exp_f32 v34, v34
v_mfma_f32_16x16x32_bf16 v[40:43], a[204:207], a[124:127], v[40:43]
v_exp_f32 v35, v35
v_smfmac_f32_16x16x64_bf16 v[20:23], v[24:27], v[48:55], v28
v_exp_f32 v36, v36
v_mfma_f32_16x16x32_bf16 v[128:131], a[224:227], v[52:55], 0
ds_read_b64_tr_b16 a[224:225], v2 offset:8448
ds_read_b64_tr_b16 a[226:227], v2 offset:8704
v_mfma_f32_16x16x32_bf16 v[132:135], a[228:231], v[52:55], 0
v_cvt_pk_bf16_f32 v48, v32, v33
v_cvt_pk_bf16_f32 v49, v34, v35
v_mfma_f32_16x16x32_bf16 v[136:139], a[232:235], v[52:55], 0
ds_read_b64_tr_b16 a[228:229], v2 offset:8456
ds_read_b64_tr_b16 a[230:231], v2 offset:8712
v_mfma_f32_16x16x32_bf16 v[140:143], a[236:239], v[52:55], 0
v_exp_f32 v37, v37
v_mfma_f32_16x16x32_bf16 v[44:47], a[208:211], a[112:115], 0
ds_read_b64_tr_b16 a[232:233], v2 offset:8512
ds_read_b64_tr_b16 a[234:235], v2 offset:8768
v_mfma_f32_16x16x32_bf16 v[44:47], a[212:215], a[116:119], v[44:47]
v_exp_f32 v38, v38
v_mfma_f32_16x16x32_bf16 v[44:47], a[216:219], a[120:123], v[44:47]
ds_read_b64_tr_b16 a[236:237], v2 offset:8520
ds_read_b64_tr_b16 a[238:239], v2 offset:8776
v_mfma_f32_16x16x32_bf16 v[44:47], a[220:223], a[124:127], v[44:47]
v_exp_f32 v39, v39
v_mfma_f32_16x16x32_bf16 v[144:147], a[240:243], v[52:55], 0
ds_read_b64_tr_b16 a[240:241], v2 offset:8576
ds_read_b64_tr_b16 a[242:243], v2 offset:8832
v_mfma_f32_16x16x32_bf16 v[148:151], a[244:247], v[52:55], 0
buffer_load_dwordx4 v5, s[4:7], s28 offen offset:128 nt lds
v_mfma_f32_16x16x32_bf16 v[152:155], a[248:251], v[52:55], 0
ds_read_b64_tr_b16 a[244:245], v2 offset:8584
ds_read_b64_tr_b16 a[246:247], v2 offset:8840
v_mfma_f32_16x16x32_bf16 v[156:159], a[252:255], v[52:55], 0
v_cvt_pk_bf16_f32 v50, v36, v37
v_cvt_pk_bf16_f32 v51, v38, v39
v_mfma_f32_16x16x32_bf16 v[32:35], a[192:195], a[128:131], 0
v_exp_f32 v40, v40
v_mfma_f32_16x16x32_bf16 v[32:35], a[196:199], a[132:135], v[32:35]
ds_read_b64_tr_b16 a[248:249], v2 offset:8640
ds_read_b64_tr_b16 a[250:251], v2 offset:8896
v_mfma_f32_16x16x32_bf16 v[32:35], a[200:203], a[136:139], v[32:35]
v_exp_f32 v41, v41
v_mfma_f32_16x16x32_bf16 v[32:35], a[204:207], a[140:143], v[32:35]
s_waitcnt lgkmcnt(6)
ds_read_b64_tr_b16 a[252:253], v2 offset:8648
ds_read_b64_tr_b16 a[254:255], v2 offset:8904
v_mfma_f32_16x16x32_bf16 a[0:3], a[224:227], v[48:51], a[0:3]
v_exp_f32 v42, v42
v_mfma_f32_16x16x32_bf16 a[4:7], a[228:231], v[48:51], a[4:7]
buffer_load_dwordx4 v5, s[4:7], s28 offen offset:2176 nt lds
v_mfma_f32_16x16x32_bf16 a[8:11], a[232:235], v[48:51], a[8:11]
s_add_u32 s28, s25, 4096
v_exp_f32 v43, v43
v_mfma_f32_16x16x32_bf16 a[12:15], a[236:239], v[48:51], a[12:15]
s_add_u32 m0, s51, 4096
v_cvt_pk_bf16_f32 v52, v40, v41
v_cvt_pk_bf16_f32 v53, v42, v43
v_mfma_f32_16x16x32_bf16 v[36:39], a[208:211], a[128:131], 0
v_exp_f32 v44, v44
v_mfma_f32_16x16x32_bf16 v[36:39], a[212:215], a[132:135], v[36:39]
buffer_load_dwordx4 v5, s[4:7], s28 offen offset:0 nt lds
v_mfma_f32_16x16x32_bf16 v[36:39], a[216:219], a[136:139], v[36:39]
v_exp_f32 v45, v45
v_mfma_f32_16x16x32_bf16 v[36:39], a[220:223], a[140:143], v[36:39]
s_waitcnt lgkmcnt(0)
v_mfma_f32_16x16x32_bf16 a[16:19], a[240:243], v[48:51], a[16:19]
v_exp_f32 v46, v46
v_mfma_f32_16x16x32_bf16 a[20:23], a[244:247], v[48:51], a[20:23]
buffer_load_dwordx4 v5, s[4:7], s28 offen offset:2048 nt lds
v_mfma_f32_16x16x32_bf16 a[24:27], a[248:251], v[48:51], a[24:27]
s_add_u32 m0, s21, 42240
v_exp_f32 v47, v47
v_mfma_f32_16x16x32_bf16 a[28:31], a[252:255], v[48:51], a[28:31]
v_cvt_pk_bf16_f32 v54, v44, v45
v_cvt_pk_bf16_f32 v55, v46, v47
v_mfma_f32_16x16x32_bf16 v[40:43], a[192:195], a[144:147], 0
v_exp_f32 v32, v32
v_mfma_f32_16x16x32_bf16 v[40:43], a[196:199], a[148:151], v[40:43]
buffer_load_dwordx4 v3, s[8:11], s26 offen offset:0 nt lds
v_mfma_f32_16x16x32_bf16 v[40:43], a[200:203], a[152:155], v[40:43]
v_exp_f32 v33, v33
v_mfma_f32_16x16x32_bf16 v[40:43], a[204:207], a[156:159], v[40:43]
v_smfmac_f32_16x16x64_bf16 v[12:15], v[24:27], v[48:55], v28
v_mfma_f32_16x16x32_bf16 a[32:35], a[224:227], v[52:55], a[32:35]
v_exp_f32 v34, v34
v_mfma_f32_16x16x32_bf16 a[36:39], a[228:231], v[52:55], a[36:39]
buffer_load_dwordx4 v3, s[8:11], s26 offen offset:1024 nt lds
v_mfma_f32_16x16x32_bf16 a[40:43], a[232:235], v[52:55], a[40:43]
s_add_u32 m0, s22, 42240
v_exp_f32 v35, v35
v_mfma_f32_16x16x32_bf16 a[44:47], a[236:239], v[52:55], a[44:47]
v_cvt_pk_bf16_f32 v48, v32, v33
v_cvt_pk_bf16_f32 v49, v34, v35
v_mfma_f32_16x16x32_bf16 v[44:47], a[208:211], a[144:147], 0
v_exp_f32 v36, v36
v_mfma_f32_16x16x32_bf16 v[44:47], a[212:215], a[148:151], v[44:47]
buffer_load_dwordx4 v4, s[12:15], s26 offen offset:0 nt lds
v_mfma_f32_16x16x32_bf16 v[44:47], a[216:219], a[152:155], v[44:47]
s_sub_u32 m0, m0, 1016
v_exp_f32 v37, v37
v_mfma_f32_16x16x32_bf16 v[44:47], a[220:223], a[156:159], v[44:47]
buffer_load_dwordx4 v4, s[12:15], s26 offen offset:2048 nt lds
v_mfma_f32_16x16x32_bf16 a[48:51], a[240:243], v[52:55], a[48:51]
s_add_u32 s26, s26, 8192
v_exp_f32 v38, v38
v_mfma_f32_16x16x32_bf16 a[52:55], a[244:247], v[52:55], a[52:55]
s_add_u32 m0, s21, 50688
v_mfma_f32_16x16x32_bf16 a[56:59], a[248:251], v[52:55], a[56:59]
v_exp_f32 v39, v39
v_mfma_f32_16x16x32_bf16 a[60:63], a[252:255], v[52:55], a[60:63]
v_cvt_pk_bf16_f32 v50, v36, v37
v_cvt_pk_bf16_f32 v51, v38, v39
v_mfma_f32_16x16x32_bf16 v[32:35], a[192:195], a[160:163], 0
v_exp_f32 v40, v40
v_mfma_f32_16x16x32_bf16 v[32:35], a[196:199], a[164:167], v[32:35]
buffer_load_dwordx4 v3, s[8:11], s26 offen offset:0 nt lds
v_mfma_f32_16x16x32_bf16 v[32:35], a[200:203], a[168:171], v[32:35]
v_exp_f32 v41, v41
v_mfma_f32_16x16x32_bf16 v[32:35], a[204:207], a[172:175], v[32:35]
v_mfma_f32_16x16x32_bf16 a[64:67], a[224:227], v[48:51], a[64:67]
v_exp_f32 v42, v42
v_mfma_f32_16x16x32_bf16 a[68:71], a[228:231], v[48:51], a[68:71]
buffer_load_dwordx4 v3, s[8:11], s26 offen offset:1024 nt lds
v_mfma_f32_16x16x32_bf16 a[72:75], a[232:235], v[48:51], a[72:75]
s_add_u32 m0, s22, 50688
v_exp_f32 v43, v43
v_mfma_f32_16x16x32_bf16 a[76:79], a[236:239], v[48:51], a[76:79]
v_cvt_pk_bf16_f32 v52, v40, v41
v_cvt_pk_bf16_f32 v53, v42, v43
v_mfma_f32_16x16x32_bf16 v[36:39], a[208:211], a[160:163], 0
v_exp_f32 v44, v44
v_mfma_f32_16x16x32_bf16 v[36:39], a[212:215], a[164:167], v[36:39]
buffer_load_dwordx4 v4, s[12:15], s26 offen offset:0 nt lds
v_mfma_f32_16x16x32_bf16 v[36:39], a[216:219], a[168:171], v[36:39]
s_sub_u32 m0, m0, 1016
v_exp_f32 v45, v45
v_mfma_f32_16x16x32_bf16 v[36:39], a[220:223], a[172:175], v[36:39]
buffer_load_dwordx4 v4, s[12:15], s26 offen offset:2048 nt lds
v_mfma_f32_16x16x32_bf16 a[80:83], a[240:243], v[48:51], a[80:83]
s_add_u32 s26, s26, 8192
v_exp_f32 v46, v46
v_mfma_f32_16x16x32_bf16 a[84:87], a[244:247], v[48:51], a[84:87]
s_add_u32 m0, s21, 59136
v_mfma_f32_16x16x32_bf16 a[88:91], a[248:251], v[48:51], a[88:91]
v_exp_f32 v47, v47
v_mfma_f32_16x16x32_bf16 a[92:95], a[252:255], v[48:51], a[92:95]
v_cvt_pk_bf16_f32 v54, v44, v45
v_cvt_pk_bf16_f32 v55, v46, v47
s_waitcnt vmcnt(22)
s_barrier
v_mfma_f32_16x16x32_bf16 v[40:43], a[192:195], a[176:179], 0
v_exp_f32 v32, v32
v_mfma_f32_16x16x32_bf16 v[40:43], a[196:199], a[180:183], v[40:43]
ds_read_b128 a[192:195], v1 offset:16896
ds_read_b128 a[196:199], v1 offset:16960
v_mfma_f32_16x16x32_bf16 v[40:43], a[200:203], a[184:187], v[40:43]
v_exp_f32 v33, v33
v_mfma_f32_16x16x32_bf16 v[40:43], a[204:207], a[188:191], v[40:43]
ds_read_b128 a[200:203], v1 offset:17024
ds_read_b128 a[204:207], v1 offset:17088
v_smfmac_f32_16x16x64_bf16 v[16:19], v[24:27], v[48:55], v28
buffer_load_dwordx4 v3, s[8:11], s26 offen offset:0 nt lds
v_mfma_f32_16x16x32_bf16 v[64:67], a[224:227], v[52:55], v[64:67]
v_exp_f32 v34, v34
v_mfma_f32_16x16x32_bf16 v[68:71], a[228:231], v[52:55], v[68:71]
v_mfma_f32_16x16x32_bf16 v[72:75], a[232:235], v[52:55], v[72:75]
v_exp_f32 v35, v35
v_mfma_f32_16x16x32_bf16 v[76:79], a[236:239], v[52:55], v[76:79]
v_cvt_pk_bf16_f32 v48, v32, v33
v_cvt_pk_bf16_f32 v49, v34, v35
v_mfma_f32_16x16x32_bf16 v[44:47], a[208:211], a[176:179], 0
v_exp_f32 v36, v36
v_mfma_f32_16x16x32_bf16 v[44:47], a[212:215], a[180:183], v[44:47]
ds_read_b128 a[208:211], v1 offset:17920
ds_read_b128 a[212:215], v1 offset:17984
v_mfma_f32_16x16x32_bf16 v[44:47], a[216:219], a[184:187], v[44:47]
v_exp_f32 v37, v37
v_mfma_f32_16x16x32_bf16 v[44:47], a[220:223], a[188:191], v[44:47]
ds_read_b128 a[216:219], v1 offset:18048
ds_read_b128 a[220:223], v1 offset:18112
v_mfma_f32_16x16x32_bf16 v[80:83], a[240:243], v[52:55], v[80:83]
v_exp_f32 v38, v38
v_mfma_f32_16x16x32_bf16 v[84:87], a[244:247], v[52:55], v[84:87]
buffer_load_dwordx4 v3, s[8:11], s26 offen offset:1024 nt lds
v_mfma_f32_16x16x32_bf16 v[88:91], a[248:251], v[52:55], v[88:91]
s_add_u32 m0, s22, 59136
v_exp_f32 v39, v39
v_mfma_f32_16x16x32_bf16 v[92:95], a[252:255], v[52:55], v[92:95]
s_waitcnt lgkmcnt(4)
v_cvt_pk_bf16_f32 v50, v36, v37
v_cvt_pk_bf16_f32 v51, v38, v39
v_mfma_f32_16x16x32_bf16 v[32:35], a[192:195], a[96:99], 0
v_exp_f32 v40, v40
v_mfma_f32_16x16x32_bf16 v[32:35], a[196:199], a[100:103], v[32:35]
buffer_load_dwordx4 v4, s[12:15], s26 offen offset:0 nt lds
v_mfma_f32_16x16x32_bf16 v[32:35], a[200:203], a[104:107], v[32:35]
s_sub_u32 m0, m0, 1016
v_exp_f32 v41, v41
v_mfma_f32_16x16x32_bf16 v[32:35], a[204:207], a[108:111], v[32:35]
buffer_load_dwordx4 v4, s[12:15], s26 offen offset:2048 nt lds
v_mfma_f32_16x16x32_bf16 v[96:99], a[224:227], v[48:51], v[96:99]
s_add_u32 s26, s26, 8192
v_exp_f32 v42, v42
v_mfma_f32_16x16x32_bf16 v[100:103], a[228:231], v[48:51], v[100:103]
s_add_u32 m0, s21, 0
v_mfma_f32_16x16x32_bf16 v[104:107], a[232:235], v[48:51], v[104:107]
v_exp_f32 v43, v43
v_mfma_f32_16x16x32_bf16 v[108:111], a[236:239], v[48:51], v[108:111]
s_waitcnt lgkmcnt(0)
v_cvt_pk_bf16_f32 v52, v40, v41
v_cvt_pk_bf16_f32 v53, v42, v43
v_mfma_f32_16x16x32_bf16 v[36:39], a[208:211], a[96:99], 0
v_exp_f32 v44, v44
v_mfma_f32_16x16x32_bf16 v[36:39], a[212:215], a[100:103], v[36:39]
buffer_load_dwordx4 v3, s[8:11], s26 offen offset:0 nt lds
v_mfma_f32_16x16x32_bf16 v[36:39], a[216:219], a[104:107], v[36:39]
v_exp_f32 v45, v45
v_mfma_f32_16x16x32_bf16 v[36:39], a[220:223], a[108:111], v[36:39]
v_mfma_f32_16x16x32_bf16 v[112:115], a[240:243], v[48:51], v[112:115]
v_exp_f32 v46, v46
v_mfma_f32_16x16x32_bf16 v[116:119], a[244:247], v[48:51], v[116:119]
buffer_load_dwordx4 v3, s[8:11], s26 offen offset:1024 nt lds
v_mfma_f32_16x16x32_bf16 v[120:123], a[248:251], v[48:51], v[120:123]
s_add_u32 m0, s22, 0
v_exp_f32 v47, v47
v_mfma_f32_16x16x32_bf16 v[124:127], a[252:255], v[48:51], v[124:127]
v_cvt_pk_bf16_f32 v54, v44, v45
v_cvt_pk_bf16_f32 v55, v46, v47
v_mfma_f32_16x16x32_bf16 v[40:43], a[192:195], a[112:115], 0
v_exp_f32 v32, v32
v_mfma_f32_16x16x32_bf16 v[40:43], a[196:199], a[116:119], v[40:43]
v_exp_f32 v33, v33
v_mfma_f32_16x16x32_bf16 v[40:43], a[200:203], a[120:123], v[40:43]
v_exp_f32 v34, v34
v_mfma_f32_16x16x32_bf16 v[40:43], a[204:207], a[124:127], v[40:43]
v_exp_f32 v35, v35
v_smfmac_f32_16x16x64_bf16 v[20:23], v[24:27], v[48:55], v28
v_exp_f32 v36, v36
v_mfma_f32_16x16x32_bf16 v[128:131], a[224:227], v[52:55], v[128:131]
ds_read_b64_tr_b16 a[224:225], v2 offset:16896
ds_read_b64_tr_b16 a[226:227], v2 offset:17152
v_mfma_f32_16x16x32_bf16 v[132:135], a[228:231], v[52:55], v[132:135]
v_cvt_pk_bf16_f32 v48, v32, v33
v_cvt_pk_bf16_f32 v49, v34, v35
v_mfma_f32_16x16x32_bf16 v[136:139], a[232:235], v[52:55], v[136:139]
ds_read_b64_tr_b16 a[228:229], v2 offset:16904
ds_read_b64_tr_b16 a[230:231], v2 offset:17160
v_mfma_f32_16x16x32_bf16 v[140:143], a[236:239], v[52:55], v[140:143]
v_exp_f32 v37, v37
v_mfma_f32_16x16x32_bf16 v[44:47], a[208:211], a[112:115], 0
ds_read_b64_tr_b16 a[232:233], v2 offset:16960
ds_read_b64_tr_b16 a[234:235], v2 offset:17216
v_mfma_f32_16x16x32_bf16 v[44:47], a[212:215], a[116:119], v[44:47]
v_exp_f32 v38, v38
v_mfma_f32_16x16x32_bf16 v[44:47], a[216:219], a[120:123], v[44:47]
ds_read_b64_tr_b16 a[236:237], v2 offset:16968
ds_read_b64_tr_b16 a[238:239], v2 offset:17224
v_mfma_f32_16x16x32_bf16 v[44:47], a[220:223], a[124:127], v[44:47]
v_exp_f32 v39, v39
v_mfma_f32_16x16x32_bf16 v[144:147], a[240:243], v[52:55], v[144:147]
ds_read_b64_tr_b16 a[240:241], v2 offset:17024
ds_read_b64_tr_b16 a[242:243], v2 offset:17280
v_mfma_f32_16x16x32_bf16 v[148:151], a[244:247], v[52:55], v[148:151]
buffer_load_dwordx4 v4, s[12:15], s26 offen offset:0 nt lds
v_mfma_f32_16x16x32_bf16 v[152:155], a[248:251], v[52:55], v[152:155]
s_sub_u32 m0, m0, 1016
ds_read_b64_tr_b16 a[244:245], v2 offset:17032
ds_read_b64_tr_b16 a[246:247], v2 offset:17288
ds_read_b64_tr_b16 a[248:249], v2 offset:17088
v_mfma_f32_16x16x32_bf16 v[156:159], a[252:255], v[52:55], v[156:159]
ds_read_b64_tr_b16 a[250:251], v2 offset:17344
ds_read_b64_tr_b16 a[252:253], v2 offset:17096
ds_read_b64_tr_b16 a[254:255], v2 offset:17352
buffer_load_dwordx4 v4, s[12:15], s26 offen offset:2048 nt lds
v_cvt_pk_bf16_f32 v50, v36, v37
v_cvt_pk_bf16_f32 v51, v38, v39
s_add_u32 s26, s26, 8192
.p2align 6
Litem:
v_mfma_f32_16x16x32_bf16 v[32:35], a[192:195], a[128:131], 0
s_waitcnt vmcnt(20)
v_exp_f32 v40, v40
v_mfma_f32_16x16x32_bf16 v[32:35], a[196:199], a[132:135], v[32:35]
ds_read_b128 v[160:163], v8 offset:0
ds_read_b128 v[164:167], v8 offset:64
v_mfma_f32_16x16x32_bf16 v[32:35], a[200:203], a[136:139], v[32:35]
v_exp_f32 v41, v41
v_mfma_f32_16x16x32_bf16 v[32:35], a[204:207], a[140:143], v[32:35]
s_waitcnt lgkmcnt(10)
v_mfma_f32_16x16x32_bf16 a[0:3], a[224:227], v[48:51], a[0:3]
v_exp_f32 v42, v42
v_mfma_f32_16x16x32_bf16 a[4:7], a[228:231], v[48:51], a[4:7]
v_mfma_f32_16x16x32_bf16 a[8:11], a[232:235], v[48:51], a[8:11]
v_exp_f32 v43, v43
v_mfma_f32_16x16x32_bf16 a[12:15], a[236:239], v[48:51], a[12:15]
v_cvt_pk_bf16_f32 v52, v40, v41
v_cvt_pk_bf16_f32 v53, v42, v43
v_mfma_f32_16x16x32_bf16 v[36:39], a[208:211], a[128:131], 0
s_waitcnt lgkmcnt(0)
v_exp_f32 v44, v44
v_mfma_f32_16x16x32_bf16 v[36:39], a[212:215], a[132:135], v[36:39]
v_lshlrev_b32 v56, 16, v160
v_and_b32 v57, s32, v160
v_mfma_f32_16x16x32_bf16 v[36:39], a[216:219], a[136:139], v[36:39]
v_exp_f32 v45, v45
v_mfma_f32_16x16x32_bf16 v[36:39], a[220:223], a[140:143], v[36:39]
v_mul_f32 v56, s30, v56
v_mul_f32 v57, s30, v57
v_mfma_f32_16x16x32_bf16 a[16:19], a[240:243], v[48:51], a[16:19]
v_exp_f32 v46, v46
v_mfma_f32_16x16x32_bf16 a[20:23], a[244:247], v[48:51], a[20:23]
v_cvt_pk_bf16_f32 v160, v56, v57
v_lshlrev_b32 v58, 16, v161
v_mfma_f32_16x16x32_bf16 a[24:27], a[248:251], v[48:51], a[24:27]
v_exp_f32 v47, v47
v_mfma_f32_16x16x32_bf16 a[28:31], a[252:255], v[48:51], a[28:31]
v_cvt_pk_bf16_f32 v54, v44, v45
v_cvt_pk_bf16_f32 v55, v46, v47
v_mfma_f32_16x16x32_bf16 v[40:43], a[192:195], a[144:147], 0
s_sub_u32 m0, s51, 128
v_exp_f32 v32, v32
v_mfma_f32_16x16x32_bf16 v[40:43], a[196:199], a[148:151], v[40:43]
buffer_load_dwordx4 v5, s[4:7], s28 offen offset:128 nt lds
v_mfma_f32_16x16x32_bf16 v[40:43], a[200:203], a[152:155], v[40:43]
v_exp_f32 v33, v33
v_mfma_f32_16x16x32_bf16 v[40:43], a[204:207], a[156:159], v[40:43]
v_and_b32 v59, s32, v161
v_mul_f32 v58, s30, v58
v_smfmac_f32_16x16x64_bf16 v[12:15], v[24:27], v[48:55], v28
v_mul_f32 v59, s30, v59
v_cvt_pk_bf16_f32 v161, v58, v59
v_mfma_f32_16x16x32_bf16 a[32:35], a[224:227], v[52:55], a[32:35]
v_exp_f32 v34, v34
v_mfma_f32_16x16x32_bf16 a[36:39], a[228:231], v[52:55], a[36:39]
buffer_load_dwordx4 v5, s[4:7], s28 offen offset:2176 nt lds
v_mfma_f32_16x16x32_bf16 a[40:43], a[232:235], v[52:55], a[40:43]
v_exp_f32 v35, v35
v_mfma_f32_16x16x32_bf16 a[44:47], a[236:239], v[52:55], a[44:47]
v_cvt_pk_bf16_f32 v48, v32, v33
v_cvt_pk_bf16_f32 v49, v34, v35
v_mfma_f32_16x16x32_bf16 v[44:47], a[208:211], a[144:147], 0
v_exp_f32 v36, v36
v_mfma_f32_16x16x32_bf16 v[44:47], a[212:215], a[148:151], v[44:47]
v_lshlrev_b32 v56, 16, v162
v_and_b32 v57, s32, v162
v_mfma_f32_16x16x32_bf16 v[44:47], a[216:219], a[152:155], v[44:47]
v_exp_f32 v37, v37
v_mfma_f32_16x16x32_bf16 v[44:47], a[220:223], a[156:159], v[44:47]
v_mul_f32 v56, s30, v56
v_mul_f32 v57, s30, v57
v_mfma_f32_16x16x32_bf16 a[48:51], a[240:243], v[52:55], a[48:51]
v_exp_f32 v38, v38
v_mfma_f32_16x16x32_bf16 a[52:55], a[244:247], v[52:55], a[52:55]
v_cvt_pk_bf16_f32 v162, v56, v57
v_lshlrev_b32 v58, 16, v163
v_mfma_f32_16x16x32_bf16 a[56:59], a[248:251], v[52:55], a[56:59]
v_exp_f32 v39, v39
v_mfma_f32_16x16x32_bf16 a[60:63], a[252:255], v[52:55], a[60:63]
s_barrier
v_cvt_pk_bf16_f32 v50, v36, v37
v_cvt_pk_bf16_f32 v51, v38, v39
v_mfma_f32_16x16x32_bf16 v[32:35], a[192:195], a[160:163], 0
s_add_u32 m0, s21, 8448
v_exp_f32 v40, v40
v_mfma_f32_16x16x32_bf16 v[32:35], a[196:199], a[164:167], v[32:35]
buffer_load_dwordx4 v3, s[8:11], s26 offen offset:0 nt lds
v_mfma_f32_16x16x32_bf16 v[32:35], a[200:203], a[168:171], v[32:35]
v_exp_f32 v41, v41
v_mfma_f32_16x16x32_bf16 v[32:35], a[204:207], a[172:175], v[32:35]
v_and_b32 v59, s32, v163
v_mul_f32 v58, s30, v58
v_mfma_f32_16x16x32_bf16 a[64:67], a[224:227], v[48:51], a[64:67]
v_exp_f32 v42, v42
v_mfma_f32_16x16x32_bf16 a[68:71], a[228:231], v[48:51], a[68:71]
buffer_load_dwordx4 v3, s[8:11], s26 offen offset:1024 nt lds
v_mfma_f32_16x16x32_bf16 a[72:75], a[232:235], v[48:51], a[72:75]
v_exp_f32 v43, v43
v_mfma_f32_16x16x32_bf16 a[76:79], a[236:239], v[48:51], a[76:79]
v_cvt_pk_bf16_f32 v52, v40, v41
v_cvt_pk_bf16_f32 v53, v42, v43
v_mfma_f32_16x16x32_bf16 v[36:39], a[208:211], a[160:163], 0
v_exp_f32 v44, v44
v_mfma_f32_16x16x32_bf16 v[36:39], a[212:215], a[164:167], v[36:39]
v_mul_f32 v59, s30, v59
v_cvt_pk_bf16_f32 v163, v58, v59
v_mfma_f32_16x16x32_bf16 v[36:39], a[216:219], a[168:171], v[36:39]
v_exp_f32 v45, v45
v_mfma_f32_16x16x32_bf16 v[36:39], a[220:223], a[172:175], v[36:39]
v_lshlrev_b32 v56, 16, v164
v_and_b32 v57, s32, v164
v_mfma_f32_16x16x32_bf16 a[80:83], a[240:243], v[48:51], a[80:83]
v_exp_f32 v46, v46
v_mfma_f32_16x16x32_bf16 a[84:87], a[244:247], v[48:51], a[84:87]
v_mul_f32 v56, s30, v56
v_mul_f32 v57, s30, v57
v_mfma_f32_16x16x32_bf16 a[88:91], a[248:251], v[48:51], a[88:91]
v_exp_f32 v47, v47
v_mfma_f32_16x16x32_bf16 a[92:95], a[252:255], v[48:51], a[92:95]
v_cvt_pk_bf16_f32 v54, v44, v45
v_cvt_pk_bf16_f32 v55, v46, v47
v_mfma_f32_16x16x32_bf16 v[40:43], a[192:195], a[176:179], 0
s_add_u32 s50, s39, 4096
v_exp_f32 v32, v32
v_mfma_f32_16x16x32_bf16 v[40:43], a[196:199], a[180:183], v[40:43]
ds_read_b128 a[192:195], v1 offset:25344
ds_read_b128 a[196:199], v1 offset:25408
v_mfma_f32_16x16x32_bf16 v[40:43], a[200:203], a[184:187], v[40:43]
v_exp_f32 v33, v33
v_mfma_f32_16x16x32_bf16 v[40:43], a[204:207], a[188:191], v[40:43]
ds_read_b128 a[200:203], v1 offset:25472
ds_read_b128 a[204:207], v1 offset:25536
v_smfmac_f32_16x16x64_bf16 v[16:19], v[24:27], v[48:55], v28
v_cndmask_b32_dpp v60, v176, v180, vcc row_ror:8 row_mask:0xf bank_mask:0xf
v_cndmask_b32_dpp v61, v177, v181, vcc row_ror:8 row_mask:0xf bank_mask:0xf
v_mfma_f32_16x16x32_bf16 v[64:67], a[224:227], v[52:55], v[64:67]
v_exp_f32 v34, v34
v_mfma_f32_16x16x32_bf16 v[68:71], a[228:231], v[52:55], v[68:71]
v_cndmask_b32_dpp v62, v178, v182, vcc row_ror:8 row_mask:0xf bank_mask:0xf
v_cndmask_b32_dpp v63, v179, v183, vcc row_ror:8 row_mask:0xf bank_mask:0xf
v_mfma_f32_16x16x32_bf16 v[72:75], a[232:235], v[52:55], v[72:75]
v_exp_f32 v35, v35
v_mfma_f32_16x16x32_bf16 v[76:79], a[236:239], v[52:55], v[76:79]
v_cvt_pk_bf16_f32 v48, v32, v33
v_cvt_pk_bf16_f32 v49, v34, v35
v_mfma_f32_16x16x32_bf16 v[44:47], a[208:211], a[176:179], 0
v_exp_f32 v36, v36
v_mfma_f32_16x16x32_bf16 v[44:47], a[212:215], a[180:183], v[44:47]
ds_read_b128 a[208:211], v1 offset:26368
ds_read_b128 a[212:215], v1 offset:26432
v_mfma_f32_16x16x32_bf16 v[44:47], a[216:219], a[184:187], v[44:47]
v_exp_f32 v37, v37
v_mfma_f32_16x16x32_bf16 v[44:47], a[220:223], a[188:191], v[44:47]
ds_read_b128 a[216:219], v1 offset:26496
ds_read_b128 a[220:223], v1 offset:26560
v_mfma_f32_16x16x32_bf16 v[80:83], a[240:243], v[52:55], v[80:83]
v_exp_f32 v38, v38
v_mfma_f32_16x16x32_bf16 v[84:87], a[244:247], v[52:55], v[84:87]
v_mov_b32_dpp v176, v180 row_ror:8 row_mask:0xf bank_mask:0xc
v_mov_b32_dpp v177, v181 row_ror:8 row_mask:0xf bank_mask:0xc
v_mfma_f32_16x16x32_bf16 v[88:91], a[248:251], v[52:55], v[88:91]
v_exp_f32 v39, v39
v_mfma_f32_16x16x32_bf16 v[92:95], a[252:255], v[52:55], v[92:95]
s_waitcnt lgkmcnt(4)
v_cvt_pk_bf16_f32 v50, v36, v37
v_cvt_pk_bf16_f32 v51, v38, v39
v_mfma_f32_16x16x32_bf16 v[32:35], a[192:195], a[96:99], 0
v_exp_f32 v40, v40
v_mfma_f32_16x16x32_bf16 v[32:35], a[196:199], a[100:103], v[32:35]
v_mov_b32_dpp v178, v182 row_ror:8 row_mask:0xf bank_mask:0xc
v_mov_b32_dpp v179, v183 row_ror:8 row_mask:0xf bank_mask:0xc
v_mfma_f32_16x16x32_bf16 v[32:35], a[200:203], a[104:107], v[32:35]
buffer_store_dwordx4 v[176:179], v6, s[16:19], s50 offen offset:0 nt
v_exp_f32 v41, v41
v_cvt_pk_bf16_f32 v164, v56, v57
v_mfma_f32_16x16x32_bf16 v[32:35], a[204:207], a[108:111], v[32:35]
v_lshlrev_b32 v58, 16, v165
v_and_b32 v59, s32, v165
v_mfma_f32_16x16x32_bf16 v[96:99], a[224:227], v[48:51], v[96:99]
v_exp_f32 v42, v42
v_mfma_f32_16x16x32_bf16 v[100:103], a[228:231], v[48:51], v[100:103]
v_mul_f32 v58, s30, v58
v_mul_f32 v59, s30, v59
v_mfma_f32_16x16x32_bf16 v[104:107], a[232:235], v[48:51], v[104:107]
buffer_store_dwordx4 v[60:63], v6, s[16:19], s50 offen offset:2048 nt
v_exp_f32 v43, v43
v_cvt_pk_bf16_f32 v165, v58, v59
v_mfma_f32_16x16x32_bf16 v[108:111], a[236:239], v[48:51], v[108:111]
s_waitcnt lgkmcnt(0)
v_cvt_pk_bf16_f32 v52, v40, v41
v_cvt_pk_bf16_f32 v53, v42, v43
v_mfma_f32_16x16x32_bf16 v[36:39], a[208:211], a[96:99], 0
v_exp_f32 v44, v44
v_mfma_f32_16x16x32_bf16 v[36:39], a[212:215], a[100:103], v[36:39]
v_lshlrev_b32 v56, 16, v166
v_and_b32 v57, s32, v166
v_mfma_f32_16x16x32_bf16 v[36:39], a[216:219], a[104:107], v[36:39]
v_exp_f32 v45, v45
v_mfma_f32_16x16x32_bf16 v[36:39], a[220:223], a[108:111], v[36:39]
v_mul_f32 v56, s30, v56
v_mul_f32 v57, s30, v57
v_mfma_f32_16x16x32_bf16 v[112:115], a[240:243], v[48:51], v[112:115]
v_exp_f32 v46, v46
v_mfma_f32_16x16x32_bf16 v[116:119], a[244:247], v[48:51], v[116:119]
v_cvt_pk_bf16_f32 v166, v56, v57
v_lshlrev_b32 v58, 16, v167
v_mfma_f32_16x16x32_bf16 v[120:123], a[248:251], v[48:51], v[120:123]
v_exp_f32 v47, v47
v_mfma_f32_16x16x32_bf16 v[124:127], a[252:255], v[48:51], v[124:127]
v_cvt_pk_bf16_f32 v54, v44, v45
v_cvt_pk_bf16_f32 v55, v46, v47
v_mfma_f32_16x16x32_bf16 v[40:43], a[192:195], a[112:115], 0
s_waitcnt vmcnt(24)
v_exp_f32 v32, v32
v_mfma_f32_16x16x32_bf16 v[40:43], a[196:199], a[116:119], v[40:43]
v_exp_f32 v33, v33
v_mfma_f32_16x16x32_bf16 v[40:43], a[200:203], a[120:123], v[40:43]
v_exp_f32 v34, v34
v_mfma_f32_16x16x32_bf16 v[40:43], a[204:207], a[124:127], v[40:43]
v_exp_f32 v35, v35
v_smfmac_f32_16x16x64_bf16 v[20:23], v[24:27], v[48:55], v28
v_exp_f32 v36, v36
v_mfma_f32_16x16x32_bf16 v[128:131], a[224:227], v[52:55], v[128:131]
ds_read_b64_tr_b16 a[224:225], v2 offset:25344
ds_read_b64_tr_b16 a[226:227], v2 offset:25600
v_mfma_f32_16x16x32_bf16 v[132:135], a[228:231], v[52:55], v[132:135]
v_cvt_pk_bf16_f32 v48, v32, v33
v_cvt_pk_bf16_f32 v49, v34, v35
v_mfma_f32_16x16x32_bf16 v[136:139], a[232:235], v[52:55], v[136:139]
ds_read_b64_tr_b16 a[228:229], v2 offset:25352
ds_read_b64_tr_b16 a[230:231], v2 offset:25608
v_mfma_f32_16x16x32_bf16 v[140:143], a[236:239], v[52:55], v[140:143]
v_exp_f32 v37, v37
v_mfma_f32_16x16x32_bf16 v[44:47], a[208:211], a[112:115], 0
ds_read_b64_tr_b16 a[232:233], v2 offset:25408
ds_read_b64_tr_b16 a[234:235], v2 offset:25664
v_mfma_f32_16x16x32_bf16 v[44:47], a[212:215], a[116:119], v[44:47]
v_exp_f32 v38, v38
v_mfma_f32_16x16x32_bf16 v[44:47], a[216:219], a[120:123], v[44:47]
ds_read_b64_tr_b16 a[236:237], v2 offset:25416
ds_read_b64_tr_b16 a[238:239], v2 offset:25672
v_mfma_f32_16x16x32_bf16 v[44:47], a[220:223], a[124:127], v[44:47]
v_exp_f32 v39, v39
v_mfma_f32_16x16x32_bf16 v[144:147], a[240:243], v[52:55], v[144:147]
ds_read_b64_tr_b16 a[240:241], v2 offset:25472
ds_read_b64_tr_b16 a[242:243], v2 offset:25728
v_mfma_f32_16x16x32_bf16 v[148:151], a[244:247], v[52:55], v[148:151]
v_and_b32 v59, s32, v167
v_mul_f32 v58, s30, v58
v_mfma_f32_16x16x32_bf16 v[152:155], a[248:251], v[52:55], v[152:155]
ds_read_b64_tr_b16 a[244:245], v2 offset:25480
ds_read_b64_tr_b16 a[246:247], v2 offset:25736
v_mfma_f32_16x16x32_bf16 v[156:159], a[252:255], v[52:55], v[156:159]
v_cvt_pk_bf16_f32 v50, v36, v37
v_cvt_pk_bf16_f32 v51, v38, v39
v_mfma_f32_16x16x32_bf16 v[32:35], a[192:195], a[128:131], 0
s_add_u32 m0, s22, 8448
v_exp_f32 v40, v40
v_mfma_f32_16x16x32_bf16 v[32:35], a[196:199], a[132:135], v[32:35]
ds_read_b64_tr_b16 a[248:249], v2 offset:25536
ds_read_b64_tr_b16 a[250:251], v2 offset:25792
v_mfma_f32_16x16x32_bf16 v[32:35], a[200:203], a[136:139], v[32:35]
v_exp_f32 v41, v41
v_mfma_f32_16x16x32_bf16 v[32:35], a[204:207], a[140:143], v[32:35]
s_waitcnt lgkmcnt(6)
ds_read_b64_tr_b16 a[252:253], v2 offset:25544
ds_read_b64_tr_b16 a[254:255], v2 offset:25800
v_mfma_f32_16x16x32_bf16 a[0:3], a[224:227], v[48:51], a[0:3]
v_exp_f32 v42, v42
v_mfma_f32_16x16x32_bf16 a[4:7], a[228:231], v[48:51], a[4:7]
ds_read_b128 v[168:171], v8 offset:1024
ds_read_b128 v[172:175], v8 offset:1088
v_mfma_f32_16x16x32_bf16 a[8:11], a[232:235], v[48:51], a[8:11]
v_exp_f32 v43, v43
v_mfma_f32_16x16x32_bf16 a[12:15], a[236:239], v[48:51], a[12:15]
v_cvt_pk_bf16_f32 v52, v40, v41
v_cvt_pk_bf16_f32 v53, v42, v43
v_mfma_f32_16x16x32_bf16 v[36:39], a[208:211], a[128:131], 0
v_exp_f32 v44, v44
v_mfma_f32_16x16x32_bf16 v[36:39], a[212:215], a[132:135], v[36:39]
buffer_load_dwordx4 v4, s[12:15], s26 offen offset:0 nt lds
v_mfma_f32_16x16x32_bf16 v[36:39], a[216:219], a[136:139], v[36:39]
s_sub_u32 m0, m0, 1016
v_exp_f32 v45, v45
v_mfma_f32_16x16x32_bf16 v[36:39], a[220:223], a[140:143], v[36:39]
s_waitcnt lgkmcnt(2)
buffer_load_dwordx4 v4, s[12:15], s26 offen offset:2048 nt lds
v_mfma_f32_16x16x32_bf16 a[16:19], a[240:243], v[48:51], a[16:19]
s_add_u32 s26, s26, 8192
v_exp_f32 v46, v46
v_mfma_f32_16x16x32_bf16 a[20:23], a[244:247], v[48:51], a[20:23]
s_waitcnt lgkmcnt(0)
v_mul_f32 v59, s30, v59
v_cvt_pk_bf16_f32 v167, v58, v59
v_mfma_f32_16x16x32_bf16 a[24:27], a[248:251], v[48:51], a[24:27]
v_exp_f32 v47, v47
v_mfma_f32_16x16x32_bf16 a[28:31], a[252:255], v[48:51], a[28:31]
v_cvt_pk_bf16_f32 v54, v44, v45
v_cvt_pk_bf16_f32 v55, v46, v47
v_mfma_f32_16x16x32_bf16 v[40:43], a[192:195], a[144:147], 0
s_add_u32 m0, s21, 16896
v_exp_f32 v32, v32
v_mfma_f32_16x16x32_bf16 v[40:43], a[196:199], a[148:151], v[40:43]
buffer_load_dwordx4 v3, s[8:11], s26 offen offset:0 nt lds
v_mfma_f32_16x16x32_bf16 v[40:43], a[200:203], a[152:155], v[40:43]
v_exp_f32 v33, v33
v_mfma_f32_16x16x32_bf16 v[40:43], a[204:207], a[156:159], v[40:43]
v_lshlrev_b32 v56, 16, v168
v_and_b32 v57, s32, v168
v_smfmac_f32_16x16x64_bf16 v[12:15], v[24:27], v[48:55], v28
v_mul_f32 v56, s30, v56
v_mul_f32 v57, s30, v57
v_mfma_f32_16x16x32_bf16 a[32:35], a[224:227], v[52:55], a[32:35]
v_exp_f32 v34, v34
v_mfma_f32_16x16x32_bf16 a[36:39], a[228:231], v[52:55], a[36:39]
buffer_load_dwordx4 v3, s[8:11], s26 offen offset:1024 nt lds
v_mfma_f32_16x16x32_bf16 a[40:43], a[232:235], v[52:55], a[40:43]
v_exp_f32 v35, v35
v_mfma_f32_16x16x32_bf16 a[44:47], a[236:239], v[52:55], a[44:47]
v_cvt_pk_bf16_f32 v48, v32, v33
v_cvt_pk_bf16_f32 v49, v34, v35
v_mfma_f32_16x16x32_bf16 v[44:47], a[208:211], a[144:147], 0
v_exp_f32 v36, v36
v_mfma_f32_16x16x32_bf16 v[44:47], a[212:215], a[148:151], v[44:47]
v_cvt_pk_bf16_f32 v168, v56, v57
v_lshlrev_b32 v58, 16, v169
v_mfma_f32_16x16x32_bf16 v[44:47], a[216:219], a[152:155], v[44:47]
v_exp_f32 v37, v37
v_mfma_f32_16x16x32_bf16 v[44:47], a[220:223], a[156:159], v[44:47]
v_and_b32 v59, s32, v169
v_mul_f32 v58, s30, v58
v_mfma_f32_16x16x32_bf16 a[48:51], a[240:243], v[52:55], a[48:51]
v_exp_f32 v38, v38
v_mfma_f32_16x16x32_bf16 a[52:55], a[244:247], v[52:55], a[52:55]
v_mul_f32 v59, s30, v59
v_cvt_pk_bf16_f32 v169, v58, v59
v_mfma_f32_16x16x32_bf16 a[56:59], a[248:251], v[52:55], a[56:59]
v_exp_f32 v39, v39
v_mfma_f32_16x16x32_bf16 a[60:63], a[252:255], v[52:55], a[60:63]
v_cvt_pk_bf16_f32 v50, v36, v37
v_cvt_pk_bf16_f32 v51, v38, v39
v_mfma_f32_16x16x32_bf16 v[32:35], a[192:195], a[160:163], 0
s_add_u32 s28, s25, 8192
v_exp_f32 v40, v40
v_mfma_f32_16x16x32_bf16 v[32:35], a[196:199], a[164:167], v[32:35]
s_add_u32 m0, s51, 1024
v_lshlrev_b32 v56, 16, v170
v_and_b32 v57, s32, v170
v_mfma_f32_16x16x32_bf16 v[32:35], a[200:203], a[168:171], v[32:35]
v_exp_f32 v41, v41
v_mfma_f32_16x16x32_bf16 v[32:35], a[204:207], a[172:175], v[32:35]
buffer_load_dwordx4 v5, s[4:7], s28 offen offset:0 nt lds
v_mfma_f32_16x16x32_bf16 a[64:67], a[224:227], v[48:51], a[64:67]
v_exp_f32 v42, v42
v_mfma_f32_16x16x32_bf16 a[68:71], a[228:231], v[48:51], a[68:71]
v_mul_f32 v56, s30, v56
v_mul_f32 v57, s30, v57
v_mfma_f32_16x16x32_bf16 a[72:75], a[232:235], v[48:51], a[72:75]
v_exp_f32 v43, v43
v_mfma_f32_16x16x32_bf16 a[76:79], a[236:239], v[48:51], a[76:79]
v_cvt_pk_bf16_f32 v52, v40, v41
v_cvt_pk_bf16_f32 v53, v42, v43
v_mfma_f32_16x16x32_bf16 v[36:39], a[208:211], a[160:163], 0
v_exp_f32 v44, v44
v_mfma_f32_16x16x32_bf16 v[36:39], a[212:215], a[164:167], v[36:39]
buffer_load_dwordx4 v5, s[4:7], s28 offen offset:2048 nt lds
v_mfma_f32_16x16x32_bf16 v[36:39], a[216:219], a[168:171], v[36:39]
v_exp_f32 v45, v45
v_mfma_f32_16x16x32_bf16 v[36:39], a[220:223], a[172:175], v[36:39]
v_cvt_pk_bf16_f32 v170, v56, v57
v_lshlrev_b32 v58, 16, v171
v_mfma_f32_16x16x32_bf16 a[80:83], a[240:243], v[48:51], a[80:83]
v_exp_f32 v46, v46
v_mfma_f32_16x16x32_bf16 a[84:87], a[244:247], v[48:51], a[84:87]
v_and_b32 v59, s32, v171
v_mul_f32 v58, s30, v58
v_mfma_f32_16x16x32_bf16 a[88:91], a[248:251], v[48:51], a[88:91]
v_exp_f32 v47, v47
v_mfma_f32_16x16x32_bf16 a[92:95], a[252:255], v[48:51], a[92:95]
v_cvt_pk_bf16_f32 v54, v44, v45
v_cvt_pk_bf16_f32 v55, v46, v47
v_mfma_f32_16x16x32_bf16 v[40:43], a[192:195], a[176:179], 0
v_exp_f32 v32, v32
v_mfma_f32_16x16x32_bf16 v[40:43], a[196:199], a[180:183], v[40:43]
ds_read_b128 a[192:195], v1 offset:33792
ds_read_b128 a[196:199], v1 offset:33856
v_mfma_f32_16x16x32_bf16 v[40:43], a[200:203], a[184:187], v[40:43]
v_exp_f32 v33, v33
v_mfma_f32_16x16x32_bf16 v[40:43], a[204:207], a[188:191], v[40:43]
ds_read_b128 a[200:203], v1 offset:33920
ds_read_b128 a[204:207], v1 offset:33984
v_smfmac_f32_16x16x64_bf16 v[16:19], v[24:27], v[48:55], v28
v_mul_f32 v59, s30, v59
v_cvt_pk_bf16_f32 v171, v58, v59
v_mfma_f32_16x16x32_bf16 v[64:67], a[224:227], v[52:55], v[64:67]
v_exp_f32 v34, v34
v_mfma_f32_16x16x32_bf16 v[68:71], a[228:231], v[52:55], v[68:71]
v_lshlrev_b32 v56, 16, v172
v_and_b32 v57, s32, v172
v_mfma_f32_16x16x32_bf16 v[72:75], a[232:235], v[52:55], v[72:75]
v_exp_f32 v35, v35
v_mfma_f32_16x16x32_bf16 v[76:79], a[236:239], v[52:55], v[76:79]
v_cvt_pk_bf16_f32 v48, v32, v33
v_cvt_pk_bf16_f32 v49, v34, v35
v_mfma_f32_16x16x32_bf16 v[44:47], a[208:211], a[176:179], 0
v_exp_f32 v36, v36
v_mfma_f32_16x16x32_bf16 v[44:47], a[212:215], a[180:183], v[44:47]
ds_read_b128 a[208:211], v1 offset:34816
ds_read_b128 a[212:215], v1 offset:34880
v_mfma_f32_16x16x32_bf16 v[44:47], a[216:219], a[184:187], v[44:47]
v_exp_f32 v37, v37
v_mfma_f32_16x16x32_bf16 v[44:47], a[220:223], a[188:191], v[44:47]
ds_read_b128 a[216:219], v1 offset:34944
ds_read_b128 a[220:223], v1 offset:35008
v_mfma_f32_16x16x32_bf16 v[80:83], a[240:243], v[52:55], v[80:83]
v_exp_f32 v38, v38
v_mfma_f32_16x16x32_bf16 v[84:87], a[244:247], v[52:55], v[84:87]
v_mul_f32 v56, s30, v56
v_mul_f32 v57, s30, v57
v_mfma_f32_16x16x32_bf16 v[88:91], a[248:251], v[52:55], v[88:91]
v_exp_f32 v39, v39
v_mfma_f32_16x16x32_bf16 v[92:95], a[252:255], v[52:55], v[92:95]
s_waitcnt lgkmcnt(4)
v_cvt_pk_bf16_f32 v50, v36, v37
v_cvt_pk_bf16_f32 v51, v38, v39
v_mfma_f32_16x16x32_bf16 v[32:35], a[192:195], a[96:99], 0
v_exp_f32 v40, v40
v_mfma_f32_16x16x32_bf16 v[32:35], a[196:199], a[100:103], v[32:35]
v_cvt_pk_bf16_f32 v172, v56, v57
v_lshlrev_b32 v58, 16, v173
v_mfma_f32_16x16x32_bf16 v[32:35], a[200:203], a[104:107], v[32:35]
v_exp_f32 v41, v41
v_mfma_f32_16x16x32_bf16 v[32:35], a[204:207], a[108:111], v[32:35]
v_and_b32 v59, s32, v173
v_mul_f32 v58, s30, v58
v_mfma_f32_16x16x32_bf16 v[96:99], a[224:227], v[48:51], v[96:99]
v_exp_f32 v42, v42
v_mfma_f32_16x16x32_bf16 v[100:103], a[228:231], v[48:51], v[100:103]
v_mul_f32 v59, s30, v59
v_cvt_pk_bf16_f32 v173, v58, v59
v_mfma_f32_16x16x32_bf16 v[104:107], a[232:235], v[48:51], v[104:107]
v_exp_f32 v43, v43
v_mfma_f32_16x16x32_bf16 v[108:111], a[236:239], v[48:51], v[108:111]
s_waitcnt lgkmcnt(0)
v_cvt_pk_bf16_f32 v52, v40, v41
v_cvt_pk_bf16_f32 v53, v42, v43
v_mfma_f32_16x16x32_bf16 v[36:39], a[208:211], a[96:99], 0
v_exp_f32 v44, v44
v_mfma_f32_16x16x32_bf16 v[36:39], a[212:215], a[100:103], v[36:39]
v_lshlrev_b32 v56, 16, v174
v_and_b32 v57, s32, v174
v_mfma_f32_16x16x32_bf16 v[36:39], a[216:219], a[104:107], v[36:39]
v_exp_f32 v45, v45
v_mfma_f32_16x16x32_bf16 v[36:39], a[220:223], a[108:111], v[36:39]
v_mul_f32 v56, s30, v56
v_mul_f32 v57, s30, v57
v_mfma_f32_16x16x32_bf16 v[112:115], a[240:243], v[48:51], v[112:115]
v_exp_f32 v46, v46
v_mfma_f32_16x16x32_bf16 v[116:119], a[244:247], v[48:51], v[116:119]
v_cvt_pk_bf16_f32 v174, v56, v57
v_lshlrev_b32 v58, 16, v175
v_mfma_f32_16x16x32_bf16 v[120:123], a[248:251], v[48:51], v[120:123]
v_exp_f32 v47, v47
v_mfma_f32_16x16x32_bf16 v[124:127], a[252:255], v[48:51], v[124:127]
v_cvt_pk_bf16_f32 v54, v44, v45
v_cvt_pk_bf16_f32 v55, v46, v47
v_mfma_f32_16x16x32_bf16 v[40:43], a[192:195], a[112:115], 0
s_add_u32 s50, s39, 4096
v_exp_f32 v32, v32
v_mfma_f32_16x16x32_bf16 v[40:43], a[196:199], a[116:119], v[40:43]
v_exp_f32 v33, v33
v_mfma_f32_16x16x32_bf16 v[40:43], a[200:203], a[120:123], v[40:43]
v_exp_f32 v34, v34
v_mfma_f32_16x16x32_bf16 v[40:43], a[204:207], a[124:127], v[40:43]
v_exp_f32 v35, v35
v_smfmac_f32_16x16x64_bf16 v[20:23], v[24:27], v[48:55], v28
v_exp_f32 v36, v36
v_mfma_f32_16x16x32_bf16 v[128:131], a[224:227], v[52:55], v[128:131]
ds_read_b64_tr_b16 a[224:225], v2 offset:33792
ds_read_b64_tr_b16 a[226:227], v2 offset:34048
v_mfma_f32_16x16x32_bf16 v[132:135], a[228:231], v[52:55], v[132:135]
v_cvt_pk_bf16_f32 v48, v32, v33
v_cvt_pk_bf16_f32 v49, v34, v35
v_mfma_f32_16x16x32_bf16 v[136:139], a[232:235], v[52:55], v[136:139]
ds_read_b64_tr_b16 a[228:229], v2 offset:33800
ds_read_b64_tr_b16 a[230:231], v2 offset:34056
v_mfma_f32_16x16x32_bf16 v[140:143], a[236:239], v[52:55], v[140:143]
v_exp_f32 v37, v37
v_mfma_f32_16x16x32_bf16 v[44:47], a[208:211], a[112:115], 0
ds_read_b64_tr_b16 a[232:233], v2 offset:33856
ds_read_b64_tr_b16 a[234:235], v2 offset:34112
v_mfma_f32_16x16x32_bf16 v[44:47], a[212:215], a[116:119], v[44:47]
v_exp_f32 v38, v38
v_mfma_f32_16x16x32_bf16 v[44:47], a[216:219], a[120:123], v[44:47]
ds_read_b64_tr_b16 a[236:237], v2 offset:33864
ds_read_b64_tr_b16 a[238:239], v2 offset:34120
v_mfma_f32_16x16x32_bf16 v[44:47], a[220:223], a[124:127], v[44:47]
v_exp_f32 v39, v39
v_mfma_f32_16x16x32_bf16 v[144:147], a[240:243], v[52:55], v[144:147]
ds_read_b64_tr_b16 a[240:241], v2 offset:33920
ds_read_b64_tr_b16 a[242:243], v2 offset:34176
v_mfma_f32_16x16x32_bf16 v[148:151], a[244:247], v[52:55], v[148:151]
v_cndmask_b32_dpp v60, v184, v188, vcc row_ror:8 row_mask:0xf bank_mask:0xf
v_cndmask_b32_dpp v61, v185, v189, vcc row_ror:8 row_mask:0xf bank_mask:0xf
v_mfma_f32_16x16x32_bf16 v[152:155], a[248:251], v[52:55], v[152:155]
ds_read_b64_tr_b16 a[244:245], v2 offset:33928
ds_read_b64_tr_b16 a[246:247], v2 offset:34184
v_mfma_f32_16x16x32_bf16 v[156:159], a[252:255], v[52:55], v[156:159]
v_cvt_pk_bf16_f32 v50, v36, v37
v_cvt_pk_bf16_f32 v51, v38, v39
v_mfma_f32_16x16x32_bf16 v[32:35], a[192:195], a[128:131], 0
s_waitcnt vmcnt(20)
v_exp_f32 v40, v40
v_mfma_f32_16x16x32_bf16 v[32:35], a[196:199], a[132:135], v[32:35]
ds_read_b64_tr_b16 a[248:249], v2 offset:33984
ds_read_b64_tr_b16 a[250:251], v2 offset:34240
v_mfma_f32_16x16x32_bf16 v[32:35], a[200:203], a[136:139], v[32:35]
v_exp_f32 v41, v41
v_mfma_f32_16x16x32_bf16 v[32:35], a[204:207], a[140:143], v[32:35]
s_waitcnt lgkmcnt(6)
ds_read_b64_tr_b16 a[252:253], v2 offset:33992
ds_read_b64_tr_b16 a[254:255], v2 offset:34248
v_mfma_f32_16x16x32_bf16 a[0:3], a[224:227], v[48:51], a[0:3]
v_exp_f32 v42, v42
v_mfma_f32_16x16x32_bf16 a[4:7], a[228:231], v[48:51], a[4:7]
ds_read_b128 v[176:179], v8 offset:4096
ds_read_b128 v[180:183], v8 offset:4160
v_mfma_f32_16x16x32_bf16 a[8:11], a[232:235], v[48:51], a[8:11]
v_exp_f32 v43, v43
v_mfma_f32_16x16x32_bf16 a[12:15], a[236:239], v[48:51], a[12:15]
v_cvt_pk_bf16_f32 v52, v40, v41
v_cvt_pk_bf16_f32 v53, v42, v43
v_mfma_f32_16x16x32_bf16 v[36:39], a[208:211], a[128:131], 0
v_exp_f32 v44, v44
v_mfma_f32_16x16x32_bf16 v[36:39], a[212:215], a[132:135], v[36:39]
v_cndmask_b32_dpp v62, v186, v190, vcc row_ror:8 row_mask:0xf bank_mask:0xf
v_cndmask_b32_dpp v63, v187, v191, vcc row_ror:8 row_mask:0xf bank_mask:0xf
v_mfma_f32_16x16x32_bf16 v[36:39], a[216:219], a[136:139], v[36:39]
v_exp_f32 v45, v45
v_mfma_f32_16x16x32_bf16 v[36:39], a[220:223], a[140:143], v[36:39]
s_waitcnt lgkmcnt(2)
v_mov_b32_dpp v184, v188 row_ror:8 row_mask:0xf bank_mask:0xc
v_mov_b32_dpp v185, v189 row_ror:8 row_mask:0xf bank_mask:0xc
v_mfma_f32_16x16x32_bf16 a[16:19], a[240:243], v[48:51], a[16:19]
v_exp_f32 v46, v46
v_mfma_f32_16x16x32_bf16 a[20:23], a[244:247], v[48:51], a[20:23]
s_waitcnt lgkmcnt(0)
v_mov_b32_dpp v186, v190 row_ror:8 row_mask:0xf bank_mask:0xc
v_mov_b32_dpp v187, v191 row_ror:8 row_mask:0xf bank_mask:0xc
v_mfma_f32_16x16x32_bf16 a[24:27], a[248:251], v[48:51], a[24:27]
buffer_store_dwordx4 v[184:187], v6, s[16:19], s50 offen offset:128 nt
v_exp_f32 v47, v47
v_and_b32 v59, s32, v175
v_mfma_f32_16x16x32_bf16 a[28:31], a[252:255], v[48:51], a[28:31]
v_cvt_pk_bf16_f32 v54, v44, v45
v_cvt_pk_bf16_f32 v55, v46, v47
v_mfma_f32_16x16x32_bf16 v[40:43], a[192:195], a[144:147], 0
v_exp_f32 v32, v32
v_mfma_f32_16x16x32_bf16 v[40:43], a[196:199], a[148:151], v[40:43]
v_mul_f32 v58, s30, v58
v_mul_f32 v59, s30, v59
v_mfma_f32_16x16x32_bf16 v[40:43], a[200:203], a[152:155], v[40:43]
buffer_store_dwordx4 v[60:63], v6, s[16:19], s50 offen offset:2176 nt
v_exp_f32 v33, v33
v_cvt_pk_bf16_f32 v175, v58, v59
v_mfma_f32_16x16x32_bf16 v[40:43], a[204:207], a[156:159], v[40:43]
v_lshlrev_b32 v56, 16, v176
v_and_b32 v57, s32, v176
v_smfmac_f32_16x16x64_bf16 v[12:15], v[24:27], v[48:55], v28
v_mul_f32 v56, s30, v56
v_mul_f32 v57, s30, v57
v_mfma_f32_16x16x32_bf16 a[32:35], a[224:227], v[52:55], a[32:35]
v_exp_f32 v34, v34
v_mfma_f32_16x16x32_bf16 a[36:39], a[228:231], v[52:55], a[36:39]
v_cvt_pk_bf16_f32 v176, v56, v57
v_lshlrev_b32 v58, 16, v177
v_mfma_f32_16x16x32_bf16 a[40:43], a[232:235], v[52:55], a[40:43]
v_exp_f32 v35, v35
v_mfma_f32_16x16x32_bf16 a[44:47], a[236:239], v[52:55], a[44:47]
v_cvt_pk_bf16_f32 v48, v32, v33
v_cvt_pk_bf16_f32 v49, v34, v35
v_mfma_f32_16x16x32_bf16 v[44:47], a[208:211], a[144:147], 0
v_exp_f32 v36, v36
v_mfma_f32_16x16x32_bf16 v[44:47], a[212:215], a[148:151], v[44:47]
v_and_b32 v59, s32, v177
v_mul_f32 v58, s30, v58
v_mfma_f32_16x16x32_bf16 v[44:47], a[216:219], a[152:155], v[44:47]
v_exp_f32 v37, v37
v_mfma_f32_16x16x32_bf16 v[44:47], a[220:223], a[156:159], v[44:47]
v_mul_f32 v59, s30, v59
v_cvt_pk_bf16_f32 v177, v58, v59
v_mfma_f32_16x16x32_bf16 a[48:51], a[240:243], v[52:55], a[48:51]
v_exp_f32 v38, v38
v_mfma_f32_16x16x32_bf16 a[52:55], a[244:247], v[52:55], a[52:55]
v_lshlrev_b32 v56, 16, v178
v_and_b32 v57, s32, v178
v_mfma_f32_16x16x32_bf16 a[56:59], a[248:251], v[52:55], a[56:59]
v_exp_f32 v39, v39
v_mfma_f32_16x16x32_bf16 a[60:63], a[252:255], v[52:55], a[60:63]
s_barrier
v_cvt_pk_bf16_f32 v50, v36, v37
v_cvt_pk_bf16_f32 v51, v38, v39
v_mfma_f32_16x16x32_bf16 v[32:35], a[192:195], a[160:163], 0
s_add_u32 m0, s22, 16896
v_exp_f32 v40, v40
v_mfma_f32_16x16x32_bf16 v[32:35], a[196:199], a[164:167], v[32:35]
buffer_load_dwordx4 v4, s[12:15], s26 offen offset:0 nt lds
v_mfma_f32_16x16x32_bf16 v[32:35], a[200:203], a[168:171], v[32:35]
s_sub_u32 m0, m0, 1016
v_exp_f32 v41, v41
v_mfma_f32_16x16x32_bf16 v[32:35], a[204:207], a[172:175], v[32:35]
buffer_load_dwordx4 v4, s[12:15], s26 offen offset:2048 nt lds
v_mfma_f32_16x16x32_bf16 a[64:67], a[224:227], v[48:51], a[64:67]
s_add_u32 s26, s26, 8192
v_exp_f32 v42, v42
v_mfma_f32_16x16x32_bf16 a[68:71], a[228:231], v[48:51], a[68:71]
v_mul_f32 v56, s30, v56
v_mul_f32 v57, s30, v57
v_mfma_f32_16x16x32_bf16 a[72:75], a[232:235], v[48:51], a[72:75]
v_exp_f32 v43, v43
v_mfma_f32_16x16x32_bf16 a[76:79], a[236:239], v[48:51], a[76:79]
v_cvt_pk_bf16_f32 v52, v40, v41
v_cvt_pk_bf16_f32 v53, v42, v43
v_mfma_f32_16x16x32_bf16 v[36:39], a[208:211], a[160:163], 0
v_exp_f32 v44, v44
v_mfma_f32_16x16x32_bf16 v[36:39], a[212:215], a[164:167], v[36:39]
v_cvt_pk_bf16_f32 v178, v56, v57
v_lshlrev_b32 v58, 16, v179
v_mfma_f32_16x16x32_bf16 v[36:39], a[216:219], a[168:171], v[36:39]
v_exp_f32 v45, v45
v_mfma_f32_16x16x32_bf16 v[36:39], a[220:223], a[172:175], v[36:39]
v_and_b32 v59, s32, v179
v_mul_f32 v58, s30, v58
v_mfma_f32_16x16x32_bf16 a[80:83], a[240:243], v[48:51], a[80:83]
v_exp_f32 v46, v46
v_mfma_f32_16x16x32_bf16 a[84:87], a[244:247], v[48:51], a[84:87]
v_mul_f32 v59, s30, v59
v_cvt_pk_bf16_f32 v179, v58, v59
v_mfma_f32_16x16x32_bf16 a[88:91], a[248:251], v[48:51], a[88:91]
v_exp_f32 v47, v47
v_mfma_f32_16x16x32_bf16 a[92:95], a[252:255], v[48:51], a[92:95]
v_cvt_pk_bf16_f32 v54, v44, v45
v_cvt_pk_bf16_f32 v55, v46, v47
v_mfma_f32_16x16x32_bf16 v[40:43], a[192:195], a[176:179], 0
s_add_u32 m0, s51, 3968
v_exp_f32 v32, v32
v_mfma_f32_16x16x32_bf16 v[40:43], a[196:199], a[180:183], v[40:43]
ds_read_b128 a[192:195], v1 offset:42240
ds_read_b128 a[196:199], v1 offset:42304
v_mfma_f32_16x16x32_bf16 v[40:43], a[200:203], a[184:187], v[40:43]
v_exp_f32 v33, v33
v_mfma_f32_16x16x32_bf16 v[40:43], a[204:207], a[188:191], v[40:43]
ds_read_b128 a[200:203], v1 offset:42368
ds_read_b128 a[204:207], v1 offset:42432
v_smfmac_f32_16x16x64_bf16 v[16:19], v[24:27], v[48:55], v28
buffer_load_dwordx4 v5, s[4:7], s28 offen offset:128 nt lds
v_mfma_f32_16x16x32_bf16 v[64:67], a[224:227], v[52:55], v[64:67]
v_exp_f32 v34, v34
v_mfma_f32_16x16x32_bf16 v[68:71], a[228:231], v[52:55], v[68:71]
v_lshlrev_b32 v56, 16, v180
v_and_b32 v57, s32, v180
v_mfma_f32_16x16x32_bf16 v[72:75], a[232:235], v[52:55], v[72:75]
v_exp_f32 v35, v35
v_mfma_f32_16x16x32_bf16 v[76:79], a[236:239], v[52:55], v[76:79]
v_cvt_pk_bf16_f32 v48, v32, v33
v_cvt_pk_bf16_f32 v49, v34, v35
v_mfma_f32_16x16x32_bf16 v[44:47], a[208:211], a[176:179], 0
v_exp_f32 v36, v36
v_mfma_f32_16x16x32_bf16 v[44:47], a[212:215], a[180:183], v[44:47]
ds_read_b128 a[208:211], v1 offset:43264
ds_read_b128 a[212:215], v1 offset:43328
v_mfma_f32_16x16x32_bf16 v[44:47], a[216:219], a[184:187], v[44:47]
v_exp_f32 v37, v37
v_mfma_f32_16x16x32_bf16 v[44:47], a[220:223], a[188:191], v[44:47]
ds_read_b128 a[216:219], v1 offset:43392
ds_read_b128 a[220:223], v1 offset:43456
v_mfma_f32_16x16x32_bf16 v[80:83], a[240:243], v[52:55], v[80:83]
v_exp_f32 v38, v38
v_mfma_f32_16x16x32_bf16 v[84:87], a[244:247], v[52:55], v[84:87]
buffer_load_dwordx4 v5, s[4:7], s28 offen offset:2176 nt lds
v_mfma_f32_16x16x32_bf16 v[88:91], a[248:251], v[52:55], v[88:91]
v_exp_f32 v39, v39
v_mfma_f32_16x16x32_bf16 v[92:95], a[252:255], v[52:55], v[92:95]
s_waitcnt lgkmcnt(4)
v_cvt_pk_bf16_f32 v50, v36, v37
v_cvt_pk_bf16_f32 v51, v38, v39
v_mfma_f32_16x16x32_bf16 v[32:35], a[192:195], a[96:99], 0
v_exp_f32 v40, v40
v_mfma_f32_16x16x32_bf16 v[32:35], a[196:199], a[100:103], v[32:35]
v_mul_f32 v56, s30, v56
v_mul_f32 v57, s30, v57
v_mfma_f32_16x16x32_bf16 v[32:35], a[200:203], a[104:107], v[32:35]
v_exp_f32 v41, v41
v_mfma_f32_16x16x32_bf16 v[32:35], a[204:207], a[108:111], v[32:35]
v_cvt_pk_bf16_f32 v180, v56, v57
v_lshlrev_b32 v58, 16, v181
v_mfma_f32_16x16x32_bf16 v[96:99], a[224:227], v[48:51], v[96:99]
v_exp_f32 v42, v42
v_mfma_f32_16x16x32_bf16 v[100:103], a[228:231], v[48:51], v[100:103]
v_and_b32 v59, s32, v181
v_mul_f32 v58, s30, v58
v_mfma_f32_16x16x32_bf16 v[104:107], a[232:235], v[48:51], v[104:107]
v_exp_f32 v43, v43
v_mfma_f32_16x16x32_bf16 v[108:111], a[236:239], v[48:51], v[108:111]
s_waitcnt lgkmcnt(0)
v_cvt_pk_bf16_f32 v52, v40, v41
v_cvt_pk_bf16_f32 v53, v42, v43
v_mfma_f32_16x16x32_bf16 v[36:39], a[208:211], a[96:99], 0
v_exp_f32 v44, v44
v_mfma_f32_16x16x32_bf16 v[36:39], a[212:215], a[100:103], v[36:39]
v_mul_f32 v59, s30, v59
v_cvt_pk_bf16_f32 v181, v58, v59
v_mfma_f32_16x16x32_bf16 v[36:39], a[216:219], a[104:107], v[36:39]
v_exp_f32 v45, v45
v_mfma_f32_16x16x32_bf16 v[36:39], a[220:223], a[108:111], v[36:39]
v_lshlrev_b32 v56, 16, v182
v_and_b32 v57, s32, v182
v_mfma_f32_16x16x32_bf16 v[112:115], a[240:243], v[48:51], v[112:115]
v_exp_f32 v46, v46
v_mfma_f32_16x16x32_bf16 v[116:119], a[244:247], v[48:51], v[116:119]
v_mul_f32 v56, s30, v56
v_mul_f32 v57, s30, v57
v_mfma_f32_16x16x32_bf16 v[120:123], a[248:251], v[48:51], v[120:123]
v_exp_f32 v47, v47
v_mfma_f32_16x16x32_bf16 v[124:127], a[252:255], v[48:51], v[124:127]
v_cvt_pk_bf16_f32 v54, v44, v45
v_cvt_pk_bf16_f32 v55, v46, v47
v_mfma_f32_16x16x32_bf16 v[40:43], a[192:195], a[112:115], 0
s_add_u32 m0, s21, 25344
v_exp_f32 v32, v32
v_mfma_f32_16x16x32_bf16 v[40:43], a[196:199], a[116:119], v[40:43]
v_exp_f32 v33, v33
v_mfma_f32_16x16x32_bf16 v[40:43], a[200:203], a[120:123], v[40:43]
v_exp_f32 v34, v34
v_mfma_f32_16x16x32_bf16 v[40:43], a[204:207], a[124:127], v[40:43]
v_exp_f32 v35, v35
v_smfmac_f32_16x16x64_bf16 v[20:23], v[24:27], v[48:55], v28
v_exp_f32 v36, v36
v_mfma_f32_16x16x32_bf16 v[128:131], a[224:227], v[52:55], v[128:131]
ds_read_b64_tr_b16 a[224:225], v2 offset:42240
ds_read_b64_tr_b16 a[226:227], v2 offset:42496
v_mfma_f32_16x16x32_bf16 v[132:135], a[228:231], v[52:55], v[132:135]
v_cvt_pk_bf16_f32 v48, v32, v33
v_cvt_pk_bf16_f32 v49, v34, v35
v_mfma_f32_16x16x32_bf16 v[136:139], a[232:235], v[52:55], v[136:139]
ds_read_b64_tr_b16 a[228:229], v2 offset:42248
ds_read_b64_tr_b16 a[230:231], v2 offset:42504
v_mfma_f32_16x16x32_bf16 v[140:143], a[236:239], v[52:55], v[140:143]
v_exp_f32 v37, v37
v_mfma_f32_16x16x32_bf16 v[44:47], a[208:211], a[112:115], 0
ds_read_b64_tr_b16 a[232:233], v2 offset:42304
ds_read_b64_tr_b16 a[234:235], v2 offset:42560
v_mfma_f32_16x16x32_bf16 v[44:47], a[212:215], a[116:119], v[44:47]
v_exp_f32 v38, v38
v_mfma_f32_16x16x32_bf16 v[44:47], a[216:219], a[120:123], v[44:47]
ds_read_b64_tr_b16 a[236:237], v2 offset:42312
ds_read_b64_tr_b16 a[238:239], v2 offset:42568
v_mfma_f32_16x16x32_bf16 v[44:47], a[220:223], a[124:127], v[44:47]
v_exp_f32 v39, v39
v_mfma_f32_16x16x32_bf16 v[144:147], a[240:243], v[52:55], v[144:147]
ds_read_b64_tr_b16 a[240:241], v2 offset:42368
ds_read_b64_tr_b16 a[242:243], v2 offset:42624
v_mfma_f32_16x16x32_bf16 v[148:151], a[244:247], v[52:55], v[148:151]
buffer_load_dwordx4 v3, s[8:11], s26 offen offset:0 nt lds
v_mfma_f32_16x16x32_bf16 v[152:155], a[248:251], v[52:55], v[152:155]
ds_read_b64_tr_b16 a[244:245], v2 offset:42376
ds_read_b64_tr_b16 a[246:247], v2 offset:42632
v_mfma_f32_16x16x32_bf16 v[156:159], a[252:255], v[52:55], v[156:159]
v_cvt_pk_bf16_f32 v50, v36, v37
v_cvt_pk_bf16_f32 v51, v38, v39
v_mfma_f32_16x16x32_bf16 v[32:35], a[192:195], a[128:131], 0
v_exp_f32 v40, v40
v_mfma_f32_16x16x32_bf16 v[32:35], a[196:199], a[132:135], v[32:35]
ds_read_b64_tr_b16 a[248:249], v2 offset:42432
ds_read_b64_tr_b16 a[250:251], v2 offset:42688
v_mfma_f32_16x16x32_bf16 v[32:35], a[200:203], a[136:139], v[32:35]
v_exp_f32 v41, v41
v_mfma_f32_16x16x32_bf16 v[32:35], a[204:207], a[140:143], v[32:35]
s_waitcnt lgkmcnt(6)
ds_read_b64_tr_b16 a[252:253], v2 offset:42440
ds_read_b64_tr_b16 a[254:255], v2 offset:42696
v_mfma_f32_16x16x32_bf16 a[0:3], a[224:227], v[48:51], a[0:3]
v_exp_f32 v42, v42
v_mfma_f32_16x16x32_bf16 a[4:7], a[228:231], v[48:51], a[4:7]
buffer_load_dwordx4 v3, s[8:11], s26 offen offset:1024 nt lds
v_mfma_f32_16x16x32_bf16 a[8:11], a[232:235], v[48:51], a[8:11]
v_exp_f32 v43, v43
v_mfma_f32_16x16x32_bf16 a[12:15], a[236:239], v[48:51], a[12:15]
v_cvt_pk_bf16_f32 v52, v40, v41
v_cvt_pk_bf16_f32 v53, v42, v43
v_mfma_f32_16x16x32_bf16 v[36:39], a[208:211], a[128:131], 0
v_exp_f32 v44, v44
v_mfma_f32_16x16x32_bf16 v[36:39], a[212:215], a[132:135], v[36:39]
v_cvt_pk_bf16_f32 v182, v56, v57
v_lshlrev_b32 v58, 16, v183
v_mfma_f32_16x16x32_bf16 v[36:39], a[216:219], a[136:139], v[36:39]
v_exp_f32 v45, v45
v_mfma_f32_16x16x32_bf16 v[36:39], a[220:223], a[140:143], v[36:39]
s_waitcnt lgkmcnt(0)
v_and_b32 v59, s32, v183
v_mul_f32 v58, s30, v58
v_mfma_f32_16x16x32_bf16 a[16:19], a[240:243], v[48:51], a[16:19]
v_exp_f32 v46, v46
v_mfma_f32_16x16x32_bf16 a[20:23], a[244:247], v[48:51], a[20:23]
v_mul_f32 v59, s30, v59
v_cvt_pk_bf16_f32 v183, v58, v59
v_mfma_f32_16x16x32_bf16 a[24:27], a[248:251], v[48:51], a[24:27]
v_exp_f32 v47, v47
v_mfma_f32_16x16x32_bf16 a[28:31], a[252:255], v[48:51], a[28:31]
v_cvt_pk_bf16_f32 v54, v44, v45
v_cvt_pk_bf16_f32 v55, v46, v47
v_mfma_f32_16x16x32_bf16 v[40:43], a[192:195], a[144:147], 0
s_add_u32 s50, s39, 8192
v_exp_f32 v32, v32
v_mfma_f32_16x16x32_bf16 v[40:43], a[196:199], a[148:151], v[40:43]
v_cndmask_b32_dpp v60, v192, v196, vcc row_ror:8 row_mask:0xf bank_mask:0xf
v_cndmask_b32_dpp v61, v193, v197, vcc row_ror:8 row_mask:0xf bank_mask:0xf
v_mfma_f32_16x16x32_bf16 v[40:43], a[200:203], a[152:155], v[40:43]
v_exp_f32 v33, v33
v_mfma_f32_16x16x32_bf16 v[40:43], a[204:207], a[156:159], v[40:43]
v_cndmask_b32_dpp v62, v194, v198, vcc row_ror:8 row_mask:0xf bank_mask:0xf
v_cndmask_b32_dpp v63, v195, v199, vcc row_ror:8 row_mask:0xf bank_mask:0xf
v_smfmac_f32_16x16x64_bf16 v[12:15], v[24:27], v[48:55], v28
v_mov_b32_dpp v192, v196 row_ror:8 row_mask:0xf bank_mask:0xc
v_mov_b32_dpp v193, v197 row_ror:8 row_mask:0xf bank_mask:0xc
v_mfma_f32_16x16x32_bf16 a[32:35], a[224:227], v[52:55], a[32:35]
v_exp_f32 v34, v34
v_mfma_f32_16x16x32_bf16 a[36:39], a[228:231], v[52:55], a[36:39]
v_mov_b32_dpp v194, v198 row_ror:8 row_mask:0xf bank_mask:0xc
v_mov_b32_dpp v195, v199 row_ror:8 row_mask:0xf bank_mask:0xc
v_mfma_f32_16x16x32_bf16 a[40:43], a[232:235], v[52:55], a[40:43]
buffer_store_dwordx4 v[192:195], v6, s[16:19], s50 offen offset:0 nt
v_exp_f32 v35, v35
v_mfma_f32_16x16x32_bf16 a[44:47], a[236:239], v[52:55], a[44:47]
v_cvt_pk_bf16_f32 v48, v32, v33
v_cvt_pk_bf16_f32 v49, v34, v35
v_mfma_f32_16x16x32_bf16 v[44:47], a[208:211], a[144:147], 0
v_exp_f32 v36, v36
v_mfma_f32_16x16x32_bf16 v[44:47], a[212:215], a[148:151], v[44:47]
v_mfma_f32_16x16x32_bf16 v[44:47], a[216:219], a[152:155], v[44:47]
buffer_store_dwordx4 v[60:63], v6, s[16:19], s50 offen offset:2048 nt
v_exp_f32 v37, v37
v_mfma_f32_16x16x32_bf16 v[44:47], a[220:223], a[156:159], v[44:47]
v_mfma_f32_16x16x32_bf16 a[48:51], a[240:243], v[52:55], a[48:51]
v_exp_f32 v38, v38
v_mfma_f32_16x16x32_bf16 a[52:55], a[244:247], v[52:55], a[52:55]
v_mfma_f32_16x16x32_bf16 a[56:59], a[248:251], v[52:55], a[56:59]
v_exp_f32 v39, v39
v_mfma_f32_16x16x32_bf16 a[60:63], a[252:255], v[52:55], a[60:63]
v_cvt_pk_bf16_f32 v50, v36, v37
v_cvt_pk_bf16_f32 v51, v38, v39
v_mfma_f32_16x16x32_bf16 v[32:35], a[192:195], a[160:163], 0
v_exp_f32 v40, v40
v_mfma_f32_16x16x32_bf16 v[32:35], a[196:199], a[164:167], v[32:35]
v_mfma_f32_16x16x32_bf16 v[32:35], a[200:203], a[168:171], v[32:35]
v_exp_f32 v41, v41
v_mfma_f32_16x16x32_bf16 v[32:35], a[204:207], a[172:175], v[32:35]
v_mfma_f32_16x16x32_bf16 a[64:67], a[224:227], v[48:51], a[64:67]
v_exp_f32 v42, v42
v_mfma_f32_16x16x32_bf16 a[68:71], a[228:231], v[48:51], a[68:71]
v_mfma_f32_16x16x32_bf16 a[72:75], a[232:235], v[48:51], a[72:75]
v_exp_f32 v43, v43
v_mfma_f32_16x16x32_bf16 a[76:79], a[236:239], v[48:51], a[76:79]
v_cvt_pk_bf16_f32 v52, v40, v41
v_cvt_pk_bf16_f32 v53, v42, v43
v_mfma_f32_16x16x32_bf16 v[36:39], a[208:211], a[160:163], 0
v_exp_f32 v44, v44
v_mfma_f32_16x16x32_bf16 v[36:39], a[212:215], a[164:167], v[36:39]
v_mfma_f32_16x16x32_bf16 v[36:39], a[216:219], a[168:171], v[36:39]
v_exp_f32 v45, v45
v_mfma_f32_16x16x32_bf16 v[36:39], a[220:223], a[172:175], v[36:39]
v_mfma_f32_16x16x32_bf16 a[80:83], a[240:243], v[48:51], a[80:83]
v_exp_f32 v46, v46
v_mfma_f32_16x16x32_bf16 a[84:87], a[244:247], v[48:51], a[84:87]
v_mfma_f32_16x16x32_bf16 a[88:91], a[248:251], v[48:51], a[88:91]
v_exp_f32 v47, v47
v_mfma_f32_16x16x32_bf16 a[92:95], a[252:255], v[48:51], a[92:95]
v_cvt_pk_bf16_f32 v54, v44, v45
v_cvt_pk_bf16_f32 v55, v46, v47
v_mfma_f32_16x16x32_bf16 v[40:43], a[192:195], a[176:179], 0
s_waitcnt vmcnt(20)
v_exp_f32 v32, v32
v_mfma_f32_16x16x32_bf16 v[40:43], a[196:199], a[180:183], v[40:43]
s_add_u32 m0, s22, 25344
ds_read_b128 a[192:195], v1 offset:50688
ds_read_b128 a[196:199], v1 offset:50752
v_mfma_f32_16x16x32_bf16 v[40:43], a[200:203], a[184:187], v[40:43]
v_exp_f32 v33, v33
v_mfma_f32_16x16x32_bf16 v[40:43], a[204:207], a[188:191], v[40:43]
ds_read_b128 a[200:203], v1 offset:50816
ds_read_b128 a[204:207], v1 offset:50880
v_smfmac_f32_16x16x64_bf16 v[16:19], v[24:27], v[48:55], v28
buffer_load_dwordx4 v4, s[12:15], s26 offen offset:0 nt lds
v_mfma_f32_16x16x32_bf16 v[64:67], a[224:227], v[52:55], v[64:67]
s_sub_u32 m0, m0, 1016
v_exp_f32 v34, v34
v_mfma_f32_16x16x32_bf16 v[68:71], a[228:231], v[52:55], v[68:71]
ds_read_b128 v[184:187], v8 offset:0
ds_read_b128 v[188:191], v8 offset:64
v_mfma_f32_16x16x32_bf16 v[72:75], a[232:235], v[52:55], v[72:75]
v_exp_f32 v35, v35
v_mfma_f32_16x16x32_bf16 v[76:79], a[236:239], v[52:55], v[76:79]
v_cvt_pk_bf16_f32 v48, v32, v33
v_cvt_pk_bf16_f32 v49, v34, v35
v_mfma_f32_16x16x32_bf16 v[44:47], a[208:211], a[176:179], 0
v_exp_f32 v36, v36
v_mfma_f32_16x16x32_bf16 v[44:47], a[212:215], a[180:183], v[44:47]
ds_read_b128 a[208:211], v1 offset:51712
ds_read_b128 a[212:215], v1 offset:51776
v_mfma_f32_16x16x32_bf16 v[44:47], a[216:219], a[184:187], v[44:47]
v_exp_f32 v37, v37
v_mfma_f32_16x16x32_bf16 v[44:47], a[220:223], a[188:191], v[44:47]
ds_read_b128 a[216:219], v1 offset:51840
ds_read_b128 a[220:223], v1 offset:51904
v_mfma_f32_16x16x32_bf16 v[80:83], a[240:243], v[52:55], v[80:83]
v_exp_f32 v38, v38
v_mfma_f32_16x16x32_bf16 v[84:87], a[244:247], v[52:55], v[84:87]
s_waitcnt lgkmcnt(4)
buffer_load_dwordx4 v4, s[12:15], s26 offen offset:2048 nt lds
v_mfma_f32_16x16x32_bf16 v[88:91], a[248:251], v[52:55], v[88:91]
s_add_u32 s26, s26, 8192
v_exp_f32 v39, v39
v_mfma_f32_16x16x32_bf16 v[92:95], a[252:255], v[52:55], v[92:95]
v_cvt_pk_bf16_f32 v50, v36, v37
v_cvt_pk_bf16_f32 v51, v38, v39
v_mfma_f32_16x16x32_bf16 v[32:35], a[192:195], a[96:99], 0
v_exp_f32 v40, v40
v_mfma_f32_16x16x32_bf16 v[32:35], a[196:199], a[100:103], v[32:35]
v_lshlrev_b32 v56, 16, v184
v_and_b32 v57, s32, v184
v_mfma_f32_16x16x32_bf16 v[32:35], a[200:203], a[104:107], v[32:35]
v_exp_f32 v41, v41
v_mfma_f32_16x16x32_bf16 v[32:35], a[204:207], a[108:111], v[32:35]
v_mul_f32 v56, s30, v56
v_mul_f32 v57, s30, v57
v_mfma_f32_16x16x32_bf16 v[96:99], a[224:227], v[48:51], v[96:99]
v_exp_f32 v42, v42
v_mfma_f32_16x16x32_bf16 v[100:103], a[228:231], v[48:51], v[100:103]
v_cvt_pk_bf16_f32 v184, v56, v57
v_lshlrev_b32 v58, 16, v185
v_mfma_f32_16x16x32_bf16 v[104:107], a[232:235], v[48:51], v[104:107]
v_exp_f32 v43, v43
v_mfma_f32_16x16x32_bf16 v[108:111], a[236:239], v[48:51], v[108:111]
s_waitcnt lgkmcnt(0)
v_cvt_pk_bf16_f32 v52, v40, v41
v_cvt_pk_bf16_f32 v53, v42, v43
v_mfma_f32_16x16x32_bf16 v[36:39], a[208:211], a[96:99], 0
v_exp_f32 v44, v44
v_mfma_f32_16x16x32_bf16 v[36:39], a[212:215], a[100:103], v[36:39]
v_and_b32 v59, s32, v185
v_mul_f32 v58, s30, v58
v_mfma_f32_16x16x32_bf16 v[36:39], a[216:219], a[104:107], v[36:39]
v_exp_f32 v45, v45
v_mfma_f32_16x16x32_bf16 v[36:39], a[220:223], a[108:111], v[36:39]
v_mul_f32 v59, s30, v59
v_cvt_pk_bf16_f32 v185, v58, v59
v_mfma_f32_16x16x32_bf16 v[112:115], a[240:243], v[48:51], v[112:115]
v_exp_f32 v46, v46
v_mfma_f32_16x16x32_bf16 v[116:119], a[244:247], v[48:51], v[116:119]
v_lshlrev_b32 v56, 16, v186
v_and_b32 v57, s32, v186
v_mfma_f32_16x16x32_bf16 v[120:123], a[248:251], v[48:51], v[120:123]
v_exp_f32 v47, v47
v_mfma_f32_16x16x32_bf16 v[124:127], a[252:255], v[48:51], v[124:127]
v_cvt_pk_bf16_f32 v54, v44, v45
v_cvt_pk_bf16_f32 v55, v46, v47
v_mfma_f32_16x16x32_bf16 v[40:43], a[192:195], a[112:115], 0
s_add_u32 s28, s25, 12288
v_exp_f32 v32, v32
v_mfma_f32_16x16x32_bf16 v[40:43], a[196:199], a[116:119], v[40:43]
s_add_u32 m0, s51, 0
v_exp_f32 v33, v33
v_mfma_f32_16x16x32_bf16 v[40:43], a[200:203], a[120:123], v[40:43]
v_exp_f32 v34, v34
v_mfma_f32_16x16x32_bf16 v[40:43], a[204:207], a[124:127], v[40:43]
v_exp_f32 v35, v35
v_smfmac_f32_16x16x64_bf16 v[20:23], v[24:27], v[48:55], v28
v_exp_f32 v36, v36
v_mfma_f32_16x16x32_bf16 v[128:131], a[224:227], v[52:55], v[128:131]
ds_read_b64_tr_b16 a[224:225], v2 offset:50688
ds_read_b64_tr_b16 a[226:227], v2 offset:50944
v_mfma_f32_16x16x32_bf16 v[132:135], a[228:231], v[52:55], v[132:135]
v_cvt_pk_bf16_f32 v48, v32, v33
v_cvt_pk_bf16_f32 v49, v34, v35
v_mfma_f32_16x16x32_bf16 v[136:139], a[232:235], v[52:55], v[136:139]
ds_read_b64_tr_b16 a[228:229], v2 offset:50696
ds_read_b64_tr_b16 a[230:231], v2 offset:50952
v_mfma_f32_16x16x32_bf16 v[140:143], a[236:239], v[52:55], v[140:143]
v_exp_f32 v37, v37
v_mfma_f32_16x16x32_bf16 v[44:47], a[208:211], a[112:115], 0
ds_read_b64_tr_b16 a[232:233], v2 offset:50752
ds_read_b64_tr_b16 a[234:235], v2 offset:51008
v_mfma_f32_16x16x32_bf16 v[44:47], a[212:215], a[116:119], v[44:47]
v_exp_f32 v38, v38
v_mfma_f32_16x16x32_bf16 v[44:47], a[216:219], a[120:123], v[44:47]
ds_read_b64_tr_b16 a[236:237], v2 offset:50760
ds_read_b64_tr_b16 a[238:239], v2 offset:51016
v_mfma_f32_16x16x32_bf16 v[44:47], a[220:223], a[124:127], v[44:47]
v_exp_f32 v39, v39
v_mfma_f32_16x16x32_bf16 v[144:147], a[240:243], v[52:55], v[144:147]
ds_read_b64_tr_b16 a[240:241], v2 offset:50816
ds_read_b64_tr_b16 a[242:243], v2 offset:51072
v_mfma_f32_16x16x32_bf16 v[148:151], a[244:247], v[52:55], v[148:151]
buffer_load_dwordx4 v5, s[4:7], s28 offen offset:0 nt lds
v_mfma_f32_16x16x32_bf16 v[152:155], a[248:251], v[52:55], v[152:155]
ds_read_b64_tr_b16 a[244:245], v2 offset:50824
ds_read_b64_tr_b16 a[246:247], v2 offset:51080
v_mfma_f32_16x16x32_bf16 v[156:159], a[252:255], v[52:55], v[156:159]
v_cvt_pk_bf16_f32 v50, v36, v37
v_cvt_pk_bf16_f32 v51, v38, v39
v_mfma_f32_16x16x32_bf16 v[32:35], a[192:195], a[128:131], 0
v_exp_f32 v40, v40
v_mfma_f32_16x16x32_bf16 v[32:35], a[196:199], a[132:135], v[32:35]
ds_read_b64_tr_b16 a[248:249], v2 offset:50880
ds_read_b64_tr_b16 a[250:251], v2 offset:51136
v_mfma_f32_16x16x32_bf16 v[32:35], a[200:203], a[136:139], v[32:35]
v_exp_f32 v41, v41
v_mfma_f32_16x16x32_bf16 v[32:35], a[204:207], a[140:143], v[32:35]
s_waitcnt lgkmcnt(6)
ds_read_b64_tr_b16 a[252:253], v2 offset:50888
ds_read_b64_tr_b16 a[254:255], v2 offset:51144
v_mfma_f32_16x16x32_bf16 a[0:3], a[224:227], v[48:51], a[0:3]
v_exp_f32 v42, v42
v_mfma_f32_16x16x32_bf16 a[4:7], a[228:231], v[48:51], a[4:7]
buffer_load_dwordx4 v5, s[4:7], s28 offen offset:2048 nt lds
v_mfma_f32_16x16x32_bf16 a[8:11], a[232:235], v[48:51], a[8:11]
v_exp_f32 v43, v43
v_mfma_f32_16x16x32_bf16 a[12:15], a[236:239], v[48:51], a[12:15]
v_cvt_pk_bf16_f32 v52, v40, v41
v_cvt_pk_bf16_f32 v53, v42, v43
v_mfma_f32_16x16x32_bf16 v[36:39], a[208:211], a[128:131], 0
v_exp_f32 v44, v44
v_mfma_f32_16x16x32_bf16 v[36:39], a[212:215], a[132:135], v[36:39]
v_mul_f32 v56, s30, v56
v_mul_f32 v57, s30, v57
v_mfma_f32_16x16x32_bf16 v[36:39], a[216:219], a[136:139], v[36:39]
v_exp_f32 v45, v45
v_mfma_f32_16x16x32_bf16 v[36:39], a[220:223], a[140:143], v[36:39]
s_waitcnt lgkmcnt(0)
v_cvt_pk_bf16_f32 v186, v56, v57
v_lshlrev_b32 v58, 16, v187
v_mfma_f32_16x16x32_bf16 a[16:19], a[240:243], v[48:51], a[16:19]
v_exp_f32 v46, v46
v_mfma_f32_16x16x32_bf16 a[20:23], a[244:247], v[48:51], a[20:23]
v_and_b32 v59, s32, v187
v_mul_f32 v58, s30, v58
v_mfma_f32_16x16x32_bf16 a[24:27], a[248:251], v[48:51], a[24:27]
v_exp_f32 v47, v47
v_mfma_f32_16x16x32_bf16 a[28:31], a[252:255], v[48:51], a[28:31]
v_cvt_pk_bf16_f32 v54, v44, v45
v_cvt_pk_bf16_f32 v55, v46, v47
v_mfma_f32_16x16x32_bf16 v[40:43], a[192:195], a[144:147], 0
s_add_u32 m0, s21, 33792
v_exp_f32 v32, v32
v_mfma_f32_16x16x32_bf16 v[40:43], a[196:199], a[148:151], v[40:43]
buffer_load_dwordx4 v3, s[8:11], s26 offen offset:0 nt lds
v_mfma_f32_16x16x32_bf16 v[40:43], a[200:203], a[152:155], v[40:43]
v_exp_f32 v33, v33
v_mfma_f32_16x16x32_bf16 v[40:43], a[204:207], a[156:159], v[40:43]
v_mul_f32 v59, s30, v59
v_cvt_pk_bf16_f32 v187, v58, v59
v_smfmac_f32_16x16x64_bf16 v[12:15], v[24:27], v[48:55], v28
v_lshlrev_b32 v56, 16, v188
v_and_b32 v57, s32, v188
v_mfma_f32_16x16x32_bf16 a[32:35], a[224:227], v[52:55], a[32:35]
v_exp_f32 v34, v34
v_mfma_f32_16x16x32_bf16 a[36:39], a[228:231], v[52:55], a[36:39]
buffer_load_dwordx4 v3, s[8:11], s26 offen offset:1024 nt lds
v_mfma_f32_16x16x32_bf16 a[40:43], a[232:235], v[52:55], a[40:43]
v_exp_f32 v35, v35
v_mfma_f32_16x16x32_bf16 a[44:47], a[236:239], v[52:55], a[44:47]
v_cvt_pk_bf16_f32 v48, v32, v33
v_cvt_pk_bf16_f32 v49, v34, v35
v_mfma_f32_16x16x32_bf16 v[44:47], a[208:211], a[144:147], 0
v_exp_f32 v36, v36
v_mfma_f32_16x16x32_bf16 v[44:47], a[212:215], a[148:151], v[44:47]
v_mul_f32 v56, s30, v56
v_mul_f32 v57, s30, v57
v_mfma_f32_16x16x32_bf16 v[44:47], a[216:219], a[152:155], v[44:47]
v_exp_f32 v37, v37
v_mfma_f32_16x16x32_bf16 v[44:47], a[220:223], a[156:159], v[44:47]
v_cvt_pk_bf16_f32 v188, v56, v57
v_lshlrev_b32 v58, 16, v189
v_mfma_f32_16x16x32_bf16 a[48:51], a[240:243], v[52:55], a[48:51]
v_exp_f32 v38, v38
v_mfma_f32_16x16x32_bf16 a[52:55], a[244:247], v[52:55], a[52:55]
v_and_b32 v59, s32, v189
v_mul_f32 v58, s30, v58
v_mfma_f32_16x16x32_bf16 a[56:59], a[248:251], v[52:55], a[56:59]
v_exp_f32 v39, v39
v_mfma_f32_16x16x32_bf16 a[60:63], a[252:255], v[52:55], a[60:63]
s_barrier
v_cvt_pk_bf16_f32 v50, v36, v37
v_cvt_pk_bf16_f32 v51, v38, v39
v_mfma_f32_16x16x32_bf16 v[32:35], a[192:195], a[160:163], 0
s_add_u32 s50, s39, 8192
v_exp_f32 v40, v40
v_mfma_f32_16x16x32_bf16 v[32:35], a[196:199], a[164:167], v[32:35]
v_cndmask_b32_dpp v60, v200, v204, vcc row_ror:8 row_mask:0xf bank_mask:0xf
v_cndmask_b32_dpp v61, v201, v205, vcc row_ror:8 row_mask:0xf bank_mask:0xf
v_mfma_f32_16x16x32_bf16 v[32:35], a[200:203], a[168:171], v[32:35]
v_exp_f32 v41, v41
v_mfma_f32_16x16x32_bf16 v[32:35], a[204:207], a[172:175], v[32:35]
v_cndmask_b32_dpp v62, v202, v206, vcc row_ror:8 row_mask:0xf bank_mask:0xf
v_cndmask_b32_dpp v63, v203, v207, vcc row_ror:8 row_mask:0xf bank_mask:0xf
v_mfma_f32_16x16x32_bf16 a[64:67], a[224:227], v[48:51], a[64:67]
v_exp_f32 v42, v42
v_mfma_f32_16x16x32_bf16 a[68:71], a[228:231], v[48:51], a[68:71]
v_mov_b32_dpp v200, v204 row_ror:8 row_mask:0xf bank_mask:0xc
v_mov_b32_dpp v201, v205 row_ror:8 row_mask:0xf bank_mask:0xc
v_mfma_f32_16x16x32_bf16 a[72:75], a[232:235], v[48:51], a[72:75]
v_exp_f32 v43, v43
v_mfma_f32_16x16x32_bf16 a[76:79], a[236:239], v[48:51], a[76:79]
v_cvt_pk_bf16_f32 v52, v40, v41
v_cvt_pk_bf16_f32 v53, v42, v43
v_mfma_f32_16x16x32_bf16 v[36:39], a[208:211], a[160:163], 0
v_exp_f32 v44, v44
v_mfma_f32_16x16x32_bf16 v[36:39], a[212:215], a[164:167], v[36:39]
v_mov_b32_dpp v202, v206 row_ror:8 row_mask:0xf bank_mask:0xc
v_mov_b32_dpp v203, v207 row_ror:8 row_mask:0xf bank_mask:0xc
v_mfma_f32_16x16x32_bf16 v[36:39], a[216:219], a[168:171], v[36:39]
buffer_store_dwordx4 v[200:203], v6, s[16:19], s50 offen offset:128 nt
v_exp_f32 v45, v45
v_mul_f32 v59, s30, v59
v_mfma_f32_16x16x32_bf16 v[36:39], a[220:223], a[172:175], v[36:39]
v_cvt_pk_bf16_f32 v189, v58, v59
v_lshlrev_b32 v56, 16, v190
v_mfma_f32_16x16x32_bf16 a[80:83], a[240:243], v[48:51], a[80:83]
v_exp_f32 v46, v46
v_mfma_f32_16x16x32_bf16 a[84:87], a[244:247], v[48:51], a[84:87]
v_and_b32 v57, s32, v190
v_mul_f32 v56, s30, v56
v_mfma_f32_16x16x32_bf16 a[88:91], a[248:251], v[48:51], a[88:91]
buffer_store_dwordx4 v[60:63], v6, s[16:19], s50 offen offset:2176 nt
v_exp_f32 v47, v47
v_mul_f32 v57, s30, v57
v_mfma_f32_16x16x32_bf16 a[92:95], a[252:255], v[48:51], a[92:95]
v_cvt_pk_bf16_f32 v54, v44, v45
v_cvt_pk_bf16_f32 v55, v46, v47
v_mfma_f32_16x16x32_bf16 v[40:43], a[192:195], a[176:179], 0
v_exp_f32 v32, v32
v_mfma_f32_16x16x32_bf16 v[40:43], a[196:199], a[180:183], v[40:43]
ds_read_b128 a[192:195], v1 offset:59136
ds_read_b128 a[196:199], v1 offset:59200
v_mfma_f32_16x16x32_bf16 v[40:43], a[200:203], a[184:187], v[40:43]
v_exp_f32 v33, v33
v_mfma_f32_16x16x32_bf16 v[40:43], a[204:207], a[188:191], v[40:43]
ds_read_b128 a[200:203], v1 offset:59264
ds_read_b128 a[204:207], v1 offset:59328
v_smfmac_f32_16x16x64_bf16 v[16:19], v[24:27], v[48:55], v28
v_cvt_pk_bf16_f32 v190, v56, v57
v_lshlrev_b32 v58, 16, v191
v_mfma_f32_16x16x32_bf16 v[64:67], a[224:227], v[52:55], v[64:67]
v_exp_f32 v34, v34
v_mfma_f32_16x16x32_bf16 v[68:71], a[228:231], v[52:55], v[68:71]
v_and_b32 v59, s32, v191
v_mul_f32 v58, s30, v58
v_mfma_f32_16x16x32_bf16 v[72:75], a[232:235], v[52:55], v[72:75]
v_exp_f32 v35, v35
v_mfma_f32_16x16x32_bf16 v[76:79], a[236:239], v[52:55], v[76:79]
v_cvt_pk_bf16_f32 v48, v32, v33
v_cvt_pk_bf16_f32 v49, v34, v35
v_mfma_f32_16x16x32_bf16 v[44:47], a[208:211], a[176:179], 0
v_exp_f32 v36, v36
v_mfma_f32_16x16x32_bf16 v[44:47], a[212:215], a[180:183], v[44:47]
ds_read_b128 a[208:211], v1 offset:60160
ds_read_b128 a[212:215], v1 offset:60224
v_mfma_f32_16x16x32_bf16 v[44:47], a[216:219], a[184:187], v[44:47]
v_exp_f32 v37, v37
v_mfma_f32_16x16x32_bf16 v[44:47], a[220:223], a[188:191], v[44:47]
ds_read_b128 a[216:219], v1 offset:60288
ds_read_b128 a[220:223], v1 offset:60352
v_mfma_f32_16x16x32_bf16 v[80:83], a[240:243], v[52:55], v[80:83]
v_exp_f32 v38, v38
v_mfma_f32_16x16x32_bf16 v[84:87], a[244:247], v[52:55], v[84:87]
v_mul_f32 v59, s30, v59
v_cvt_pk_bf16_f32 v191, v58, v59
v_mfma_f32_16x16x32_bf16 v[88:91], a[248:251], v[52:55], v[88:91]
v_exp_f32 v39, v39
v_mfma_f32_16x16x32_bf16 v[92:95], a[252:255], v[52:55], v[92:95]
s_waitcnt lgkmcnt(4)
v_cvt_pk_bf16_f32 v50, v36, v37
v_cvt_pk_bf16_f32 v51, v38, v39
v_mfma_f32_16x16x32_bf16 v[32:35], a[192:195], a[96:99], 0
s_waitcnt vmcnt(18)
v_exp_f32 v40, v40
v_mfma_f32_16x16x32_bf16 v[32:35], a[196:199], a[100:103], v[32:35]
ds_read_b128 v[192:195], v8 offset:1024
ds_read_b128 v[196:199], v8 offset:1088
v_mfma_f32_16x16x32_bf16 v[32:35], a[200:203], a[104:107], v[32:35]
v_exp_f32 v41, v41
v_mfma_f32_16x16x32_bf16 v[32:35], a[204:207], a[108:111], v[32:35]
v_mfma_f32_16x16x32_bf16 v[96:99], a[224:227], v[48:51], v[96:99]
v_exp_f32 v42, v42
v_mfma_f32_16x16x32_bf16 v[100:103], a[228:231], v[48:51], v[100:103]
v_mfma_f32_16x16x32_bf16 v[104:107], a[232:235], v[48:51], v[104:107]
v_exp_f32 v43, v43
v_mfma_f32_16x16x32_bf16 v[108:111], a[236:239], v[48:51], v[108:111]
s_waitcnt lgkmcnt(2)
v_cvt_pk_bf16_f32 v52, v40, v41
v_cvt_pk_bf16_f32 v53, v42, v43
v_mfma_f32_16x16x32_bf16 v[36:39], a[208:211], a[96:99], 0
s_waitcnt lgkmcnt(0)
v_exp_f32 v44, v44
v_mfma_f32_16x16x32_bf16 v[36:39], a[212:215], a[100:103], v[36:39]
v_lshlrev_b32 v56, 16, v192
v_and_b32 v57, s32, v192
v_mfma_f32_16x16x32_bf16 v[36:39], a[216:219], a[104:107], v[36:39]
v_exp_f32 v45, v45
v_mfma_f32_16x16x32_bf16 v[36:39], a[220:223], a[108:111], v[36:39]
v_mul_f32 v56, s30, v56
v_mul_f32 v57, s30, v57
v_mfma_f32_16x16x32_bf16 v[112:115], a[240:243], v[48:51], v[112:115]
v_exp_f32 v46, v46
v_mfma_f32_16x16x32_bf16 v[116:119], a[244:247], v[48:51], v[116:119]
v_cvt_pk_bf16_f32 v192, v56, v57
v_lshlrev_b32 v58, 16, v193
v_mfma_f32_16x16x32_bf16 v[120:123], a[248:251], v[48:51], v[120:123]
v_exp_f32 v47, v47
v_mfma_f32_16x16x32_bf16 v[124:127], a[252:255], v[48:51], v[124:127]
v_cvt_pk_bf16_f32 v54, v44, v45
v_cvt_pk_bf16_f32 v55, v46, v47
v_mfma_f32_16x16x32_bf16 v[40:43], a[192:195], a[112:115], 0
s_add_u32 m0, s22, 33792
v_exp_f32 v32, v32
v_mfma_f32_16x16x32_bf16 v[40:43], a[196:199], a[116:119], v[40:43]
v_exp_f32 v33, v33
v_mfma_f32_16x16x32_bf16 v[40:43], a[200:203], a[120:123], v[40:43]
v_exp_f32 v34, v34
v_mfma_f32_16x16x32_bf16 v[40:43], a[204:207], a[124:127], v[40:43]
v_exp_f32 v35, v35
v_smfmac_f32_16x16x64_bf16 v[20:23], v[24:27], v[48:55], v28
v_exp_f32 v36, v36
v_mfma_f32_16x16x32_bf16 v[128:131], a[224:227], v[52:55], v[128:131]
ds_read_b64_tr_b16 a[224:225], v2 offset:59136
ds_read_b64_tr_b16 a[226:227], v2 offset:59392
v_mfma_f32_16x16x32_bf16 v[132:135], a[228:231], v[52:55], v[132:135]
v_cvt_pk_bf16_f32 v48, v32, v33
v_cvt_pk_bf16_f32 v49, v34, v35
v_mfma_f32_16x16x32_bf16 v[136:139], a[232:235], v[52:55], v[136:139]
ds_read_b64_tr_b16 a[228:229], v2 offset:59144
ds_read_b64_tr_b16 a[230:231], v2 offset:59400
v_mfma_f32_16x16x32_bf16 v[140:143], a[236:239], v[52:55], v[140:143]
v_exp_f32 v37, v37
v_mfma_f32_16x16x32_bf16 v[44:47], a[208:211], a[112:115], 0
ds_read_b64_tr_b16 a[232:233], v2 offset:59200
ds_read_b64_tr_b16 a[234:235], v2 offset:59456
v_mfma_f32_16x16x32_bf16 v[44:47], a[212:215], a[116:119], v[44:47]
v_exp_f32 v38, v38
v_mfma_f32_16x16x32_bf16 v[44:47], a[216:219], a[120:123], v[44:47]
ds_read_b64_tr_b16 a[236:237], v2 offset:59208
ds_read_b64_tr_b16 a[238:239], v2 offset:59464
v_mfma_f32_16x16x32_bf16 v[44:47], a[220:223], a[124:127], v[44:47]
v_exp_f32 v39, v39
v_mfma_f32_16x16x32_bf16 v[144:147], a[240:243], v[52:55], v[144:147]
ds_read_b64_tr_b16 a[240:241], v2 offset:59264
ds_read_b64_tr_b16 a[242:243], v2 offset:59520
v_mfma_f32_16x16x32_bf16 v[148:151], a[244:247], v[52:55], v[148:151]
buffer_load_dwordx4 v4, s[12:15], s26 offen offset:0 nt lds
v_mfma_f32_16x16x32_bf16 v[152:155], a[248:251], v[52:55], v[152:155]
s_sub_u32 m0, m0, 1016
ds_read_b64_tr_b16 a[244:245], v2 offset:59272
ds_read_b64_tr_b16 a[246:247], v2 offset:59528
v_mfma_f32_16x16x32_bf16 v[156:159], a[252:255], v[52:55], v[156:159]
v_cvt_pk_bf16_f32 v50, v36, v37
v_cvt_pk_bf16_f32 v51, v38, v39
v_mfma_f32_16x16x32_bf16 v[32:35], a[192:195], a[128:131], 0
v_exp_f32 v40, v40
v_mfma_f32_16x16x32_bf16 v[32:35], a[196:199], a[132:135], v[32:35]
ds_read_b64_tr_b16 a[248:249], v2 offset:59328
ds_read_b64_tr_b16 a[250:251], v2 offset:59584
v_mfma_f32_16x16x32_bf16 v[32:35], a[200:203], a[136:139], v[32:35]
v_exp_f32 v41, v41
v_mfma_f32_16x16x32_bf16 v[32:35], a[204:207], a[140:143], v[32:35]
s_waitcnt lgkmcnt(6)
ds_read_b64_tr_b16 a[252:253], v2 offset:59336
ds_read_b64_tr_b16 a[254:255], v2 offset:59592
v_mfma_f32_16x16x32_bf16 a[0:3], a[224:227], v[48:51], a[0:3]
v_exp_f32 v42, v42
v_mfma_f32_16x16x32_bf16 a[4:7], a[228:231], v[48:51], a[4:7]
buffer_load_dwordx4 v4, s[12:15], s26 offen offset:2048 nt lds
v_mfma_f32_16x16x32_bf16 a[8:11], a[232:235], v[48:51], a[8:11]
s_add_u32 s26, s26, 8192
v_exp_f32 v43, v43
v_mfma_f32_16x16x32_bf16 a[12:15], a[236:239], v[48:51], a[12:15]
s_add_u32 m0, s51, 896
v_cvt_pk_bf16_f32 v52, v40, v41
v_cvt_pk_bf16_f32 v53, v42, v43
v_mfma_f32_16x16x32_bf16 v[36:39], a[208:211], a[128:131], 0
v_exp_f32 v44, v44
v_mfma_f32_16x16x32_bf16 v[36:39], a[212:215], a[132:135], v[36:39]
buffer_load_dwordx4 v5, s[4:7], s28 offen offset:128 nt lds
v_mfma_f32_16x16x32_bf16 v[36:39], a[216:219], a[136:139], v[36:39]
v_exp_f32 v45, v45
v_mfma_f32_16x16x32_bf16 v[36:39], a[220:223], a[140:143], v[36:39]
s_waitcnt lgkmcnt(0)
v_and_b32 v59, s32, v193
v_mul_f32 v58, s30, v58
v_mfma_f32_16x16x32_bf16 a[16:19], a[240:243], v[48:51], a[16:19]
v_exp_f32 v46, v46
v_mfma_f32_16x16x32_bf16 a[20:23], a[244:247], v[48:51], a[20:23]
buffer_load_dwordx4 v5, s[4:7], s28 offen offset:2176 nt lds
v_mfma_f32_16x16x32_bf16 a[24:27], a[248:251], v[48:51], a[24:27]
v_exp_f32 v47, v47
v_mfma_f32_16x16x32_bf16 a[28:31], a[252:255], v[48:51], a[28:31]
v_cvt_pk_bf16_f32 v54, v44, v45
v_cvt_pk_bf16_f32 v55, v46, v47
v_mfma_f32_16x16x32_bf16 v[40:43], a[192:195], a[144:147], 0
v_exp_f32 v32, v32
v_mfma_f32_16x16x32_bf16 v[40:43], a[196:199], a[148:151], v[40:43]
v_mul_f32 v59, s30, v59
v_cvt_pk_bf16_f32 v193, v58, v59
v_mfma_f32_16x16x32_bf16 v[40:43], a[200:203], a[152:155], v[40:43]
v_exp_f32 v33, v33
v_mfma_f32_16x16x32_bf16 v[40:43], a[204:207], a[156:159], v[40:43]
v_lshlrev_b32 v56, 16, v194
v_and_b32 v57, s32, v194
v_smfmac_f32_16x16x64_bf16 v[12:15], v[24:27], v[48:55], v28
v_mul_f32 v56, s30, v56
v_mul_f32 v57, s30, v57
v_mfma_f32_16x16x32_bf16 a[32:35], a[224:227], v[52:55], a[32:35]
v_exp_f32 v34, v34
v_mfma_f32_16x16x32_bf16 a[36:39], a[228:231], v[52:55], a[36:39]
v_cvt_pk_bf16_f32 v194, v56, v57
v_lshlrev_b32 v58, 16, v195
v_mfma_f32_16x16x32_bf16 a[40:43], a[232:235], v[52:55], a[40:43]
v_exp_f32 v35, v35
v_mfma_f32_16x16x32_bf16 a[44:47], a[236:239], v[52:55], a[44:47]
v_cvt_pk_bf16_f32 v48, v32, v33
v_cvt_pk_bf16_f32 v49, v34, v35
v_mfma_f32_16x16x32_bf16 v[44:47], a[208:211], a[144:147], 0
v_exp_f32 v36, v36
v_mfma_f32_16x16x32_bf16 v[44:47], a[212:215], a[148:151], v[44:47]
v_and_b32 v59, s32, v195
v_mul_f32 v58, s30, v58
v_mfma_f32_16x16x32_bf16 v[44:47], a[216:219], a[152:155], v[44:47]
v_exp_f32 v37, v37
v_mfma_f32_16x16x32_bf16 v[44:47], a[220:223], a[156:159], v[44:47]
v_mul_f32 v59, s30, v59
v_cvt_pk_bf16_f32 v195, v58, v59
v_mfma_f32_16x16x32_bf16 a[48:51], a[240:243], v[52:55], a[48:51]
v_exp_f32 v38, v38
v_mfma_f32_16x16x32_bf16 a[52:55], a[244:247], v[52:55], a[52:55]
v_lshlrev_b32 v56, 16, v196
v_and_b32 v57, s32, v196
v_mfma_f32_16x16x32_bf16 a[56:59], a[248:251], v[52:55], a[56:59]
v_exp_f32 v39, v39
v_mfma_f32_16x16x32_bf16 a[60:63], a[252:255], v[52:55], a[60:63]
v_cvt_pk_bf16_f32 v50, v36, v37
v_cvt_pk_bf16_f32 v51, v38, v39
v_mfma_f32_16x16x32_bf16 v[32:35], a[192:195], a[160:163], 0
v_exp_f32 v40, v40
v_mfma_f32_16x16x32_bf16 v[32:35], a[196:199], a[164:167], v[32:35]
v_mul_f32 v56, s30, v56
v_mul_f32 v57, s30, v57
v_mfma_f32_16x16x32_bf16 v[32:35], a[200:203], a[168:171], v[32:35]
v_exp_f32 v41, v41
v_mfma_f32_16x16x32_bf16 v[32:35], a[204:207], a[172:175], v[32:35]
v_cvt_pk_bf16_f32 v196, v56, v57
v_lshlrev_b32 v58, 16, v197
v_mfma_f32_16x16x32_bf16 a[64:67], a[224:227], v[48:51], a[64:67]
v_exp_f32 v42, v42
v_mfma_f32_16x16x32_bf16 a[68:71], a[228:231], v[48:51], a[68:71]
v_and_b32 v59, s32, v197
v_mul_f32 v58, s30, v58
v_mfma_f32_16x16x32_bf16 a[72:75], a[232:235], v[48:51], a[72:75]
v_exp_f32 v43, v43
v_mfma_f32_16x16x32_bf16 a[76:79], a[236:239], v[48:51], a[76:79]
v_cvt_pk_bf16_f32 v52, v40, v41
v_cvt_pk_bf16_f32 v53, v42, v43
v_mfma_f32_16x16x32_bf16 v[36:39], a[208:211], a[160:163], 0
v_exp_f32 v44, v44
v_mfma_f32_16x16x32_bf16 v[36:39], a[212:215], a[164:167], v[36:39]
v_mul_f32 v59, s30, v59
v_cvt_pk_bf16_f32 v197, v58, v59
v_mfma_f32_16x16x32_bf16 v[36:39], a[216:219], a[168:171], v[36:39]
v_exp_f32 v45, v45
v_mfma_f32_16x16x32_bf16 v[36:39], a[220:223], a[172:175], v[36:39]
v_lshlrev_b32 v56, 16, v198
v_and_b32 v57, s32, v198
v_mfma_f32_16x16x32_bf16 a[80:83], a[240:243], v[48:51], a[80:83]
v_exp_f32 v46, v46
v_mfma_f32_16x16x32_bf16 a[84:87], a[244:247], v[48:51], a[84:87]
v_mul_f32 v56, s30, v56
v_mul_f32 v57, s30, v57
v_mfma_f32_16x16x32_bf16 a[88:91], a[248:251], v[48:51], a[88:91]
v_exp_f32 v47, v47
v_mfma_f32_16x16x32_bf16 a[92:95], a[252:255], v[48:51], a[92:95]
v_cvt_pk_bf16_f32 v54, v44, v45
v_cvt_pk_bf16_f32 v55, v46, v47
v_mfma_f32_16x16x32_bf16 v[40:43], a[192:195], a[176:179], 0
s_add_u32 m0, s21, 42240
v_exp_f32 v32, v32
v_mfma_f32_16x16x32_bf16 v[40:43], a[196:199], a[180:183], v[40:43]
ds_read_b128 a[192:195], v1 offset:0
ds_read_b128 a[196:199], v1 offset:64
v_mfma_f32_16x16x32_bf16 v[40:43], a[200:203], a[184:187], v[40:43]
v_exp_f32 v33, v33
v_mfma_f32_16x16x32_bf16 v[40:43], a[204:207], a[188:191], v[40:43]
ds_read_b128 a[200:203], v1 offset:128
ds_read_b128 a[204:207], v1 offset:192
v_smfmac_f32_16x16x64_bf16 v[16:19], v[24:27], v[48:55], v28
buffer_load_dwordx4 v3, s[8:11], s26 offen offset:0 nt lds
v_mfma_f32_16x16x32_bf16 v[64:67], a[224:227], v[52:55], v[64:67]
v_exp_f32 v34, v34
v_mfma_f32_16x16x32_bf16 v[68:71], a[228:231], v[52:55], v[68:71]
v_cvt_pk_bf16_f32 v198, v56, v57
v_lshlrev_b32 v58, 16, v199
v_mfma_f32_16x16x32_bf16 v[72:75], a[232:235], v[52:55], v[72:75]
v_exp_f32 v35, v35
v_mfma_f32_16x16x32_bf16 v[76:79], a[236:239], v[52:55], v[76:79]
v_cvt_pk_bf16_f32 v48, v32, v33
v_cvt_pk_bf16_f32 v49, v34, v35
v_mfma_f32_16x16x32_bf16 v[44:47], a[208:211], a[176:179], 0
v_exp_f32 v36, v36
v_mfma_f32_16x16x32_bf16 v[44:47], a[212:215], a[180:183], v[44:47]
ds_read_b128 a[208:211], v1 offset:1024
ds_read_b128 a[212:215], v1 offset:1088
v_mfma_f32_16x16x32_bf16 v[44:47], a[216:219], a[184:187], v[44:47]
v_exp_f32 v37, v37
v_mfma_f32_16x16x32_bf16 v[44:47], a[220:223], a[188:191], v[44:47]
ds_read_b128 a[216:219], v1 offset:1152
ds_read_b128 a[220:223], v1 offset:1216
v_mfma_f32_16x16x32_bf16 v[80:83], a[240:243], v[52:55], v[80:83]
v_exp_f32 v38, v38
v_mfma_f32_16x16x32_bf16 v[84:87], a[244:247], v[52:55], v[84:87]
buffer_load_dwordx4 v3, s[8:11], s26 offen offset:1024 nt lds
v_mfma_f32_16x16x32_bf16 v[88:91], a[248:251], v[52:55], v[88:91]
v_exp_f32 v39, v39
v_mfma_f32_16x16x32_bf16 v[92:95], a[252:255], v[52:55], v[92:95]
s_waitcnt lgkmcnt(4)
v_cvt_pk_bf16_f32 v50, v36, v37
v_cvt_pk_bf16_f32 v51, v38, v39
v_mfma_f32_16x16x32_bf16 v[32:35], a[192:195], a[96:99], 0
s_add_u32 s50, s39, 12288
v_exp_f32 v40, v40
v_mfma_f32_16x16x32_bf16 v[32:35], a[196:199], a[100:103], v[32:35]
v_cndmask_b32_dpp v60, v208, v212, vcc row_ror:8 row_mask:0xf bank_mask:0xf
v_cndmask_b32_dpp v61, v209, v213, vcc row_ror:8 row_mask:0xf bank_mask:0xf
v_mfma_f32_16x16x32_bf16 v[32:35], a[200:203], a[104:107], v[32:35]
v_exp_f32 v41, v41
v_mfma_f32_16x16x32_bf16 v[32:35], a[204:207], a[108:111], v[32:35]
v_cndmask_b32_dpp v62, v210, v214, vcc row_ror:8 row_mask:0xf bank_mask:0xf
v_cndmask_b32_dpp v63, v211, v215, vcc row_ror:8 row_mask:0xf bank_mask:0xf
v_mfma_f32_16x16x32_bf16 v[96:99], a[224:227], v[48:51], v[96:99]
v_exp_f32 v42, v42
v_mfma_f32_16x16x32_bf16 v[100:103], a[228:231], v[48:51], v[100:103]
v_mov_b32_dpp v208, v212 row_ror:8 row_mask:0xf bank_mask:0xc
v_mov_b32_dpp v209, v213 row_ror:8 row_mask:0xf bank_mask:0xc
v_mfma_f32_16x16x32_bf16 v[104:107], a[232:235], v[48:51], v[104:107]
v_exp_f32 v43, v43
v_mfma_f32_16x16x32_bf16 v[108:111], a[236:239], v[48:51], v[108:111]
s_waitcnt lgkmcnt(0)
v_cvt_pk_bf16_f32 v52, v40, v41
v_cvt_pk_bf16_f32 v53, v42, v43
v_mfma_f32_16x16x32_bf16 v[36:39], a[208:211], a[96:99], 0
v_exp_f32 v44, v44
v_mfma_f32_16x16x32_bf16 v[36:39], a[212:215], a[100:103], v[36:39]
v_mov_b32_dpp v210, v214 row_ror:8 row_mask:0xf bank_mask:0xc
v_mov_b32_dpp v211, v215 row_ror:8 row_mask:0xf bank_mask:0xc
v_mfma_f32_16x16x32_bf16 v[36:39], a[216:219], a[104:107], v[36:39]
buffer_store_dwordx4 v[208:211], v6, s[16:19], s50 offen offset:0 nt
v_exp_f32 v45, v45
v_and_b32 v59, s32, v199
v_mfma_f32_16x16x32_bf16 v[36:39], a[220:223], a[108:111], v[36:39]
v_mul_f32 v58, s30, v58
v_mul_f32 v59, s30, v59
v_mfma_f32_16x16x32_bf16 v[112:115], a[240:243], v[48:51], v[112:115]
v_exp_f32 v46, v46
v_mfma_f32_16x16x32_bf16 v[116:119], a[244:247], v[48:51], v[116:119]
v_cvt_pk_bf16_f32 v199, v58, v59
v_mfma_f32_16x16x32_bf16 v[120:123], a[248:251], v[48:51], v[120:123]
buffer_store_dwordx4 v[60:63], v6, s[16:19], s50 offen offset:2048 nt
v_exp_f32 v47, v47
v_mfma_f32_16x16x32_bf16 v[124:127], a[252:255], v[48:51], v[124:127]
v_cvt_pk_bf16_f32 v54, v44, v45
v_cvt_pk_bf16_f32 v55, v46, v47
v_mfma_f32_16x16x32_bf16 v[40:43], a[192:195], a[112:115], 0
s_waitcnt vmcnt(20)
v_exp_f32 v32, v32
v_mfma_f32_16x16x32_bf16 v[40:43], a[196:199], a[116:119], v[40:43]
v_exp_f32 v33, v33
v_mfma_f32_16x16x32_bf16 v[40:43], a[200:203], a[120:123], v[40:43]
v_exp_f32 v34, v34
v_mfma_f32_16x16x32_bf16 v[40:43], a[204:207], a[124:127], v[40:43]
v_exp_f32 v35, v35
v_smfmac_f32_16x16x64_bf16 v[20:23], v[24:27], v[48:55], v28
v_exp_f32 v36, v36
v_mfma_f32_16x16x32_bf16 v[128:131], a[224:227], v[52:55], v[128:131]
ds_read_b64_tr_b16 a[224:225], v2 offset:0
ds_read_b64_tr_b16 a[226:227], v2 offset:256
v_mfma_f32_16x16x32_bf16 v[132:135], a[228:231], v[52:55], v[132:135]
v_cvt_pk_bf16_f32 v48, v32, v33
v_cvt_pk_bf16_f32 v49, v34, v35
v_mfma_f32_16x16x32_bf16 v[136:139], a[232:235], v[52:55], v[136:139]
ds_read_b64_tr_b16 a[228:229], v2 offset:8
ds_read_b64_tr_b16 a[230:231], v2 offset:264
v_mfma_f32_16x16x32_bf16 v[140:143], a[236:239], v[52:55], v[140:143]
v_exp_f32 v37, v37
v_mfma_f32_16x16x32_bf16 v[44:47], a[208:211], a[112:115], 0
ds_read_b64_tr_b16 a[232:233], v2 offset:64
ds_read_b64_tr_b16 a[234:235], v2 offset:320
v_mfma_f32_16x16x32_bf16 v[44:47], a[212:215], a[116:119], v[44:47]
v_exp_f32 v38, v38
v_mfma_f32_16x16x32_bf16 v[44:47], a[216:219], a[120:123], v[44:47]
ds_read_b64_tr_b16 a[236:237], v2 offset:72
ds_read_b64_tr_b16 a[238:239], v2 offset:328
v_mfma_f32_16x16x32_bf16 v[44:47], a[220:223], a[124:127], v[44:47]
v_exp_f32 v39, v39
v_mfma_f32_16x16x32_bf16 v[144:147], a[240:243], v[52:55], v[144:147]
ds_read_b64_tr_b16 a[240:241], v2 offset:128
ds_read_b64_tr_b16 a[242:243], v2 offset:384
v_mfma_f32_16x16x32_bf16 v[148:151], a[244:247], v[52:55], v[148:151]
v_mfma_f32_16x16x32_bf16 v[152:155], a[248:251], v[52:55], v[152:155]
ds_read_b64_tr_b16 a[244:245], v2 offset:136
ds_read_b64_tr_b16 a[246:247], v2 offset:392
v_mfma_f32_16x16x32_bf16 v[156:159], a[252:255], v[52:55], v[156:159]
v_cvt_pk_bf16_f32 v50, v36, v37
v_cvt_pk_bf16_f32 v51, v38, v39
v_mfma_f32_16x16x32_bf16 v[32:35], a[192:195], a[128:131], 0
v_exp_f32 v40, v40
v_mfma_f32_16x16x32_bf16 v[32:35], a[196:199], a[132:135], v[32:35]
ds_read_b64_tr_b16 a[248:249], v2 offset:192
ds_read_b64_tr_b16 a[250:251], v2 offset:448
v_mfma_f32_16x16x32_bf16 v[32:35], a[200:203], a[136:139], v[32:35]
v_exp_f32 v41, v41
v_mfma_f32_16x16x32_bf16 v[32:35], a[204:207], a[140:143], v[32:35]
s_waitcnt lgkmcnt(6)
ds_read_b64_tr_b16 a[252:253], v2 offset:200
ds_read_b64_tr_b16 a[254:255], v2 offset:456
v_mfma_f32_16x16x32_bf16 a[0:3], a[224:227], v[48:51], a[0:3]
v_exp_f32 v42, v42
v_mfma_f32_16x16x32_bf16 a[4:7], a[228:231], v[48:51], a[4:7]
ds_read_b128 v[200:203], v8 offset:4096
ds_read_b128 v[204:207], v8 offset:4160
v_mfma_f32_16x16x32_bf16 a[8:11], a[232:235], v[48:51], a[8:11]
v_exp_f32 v43, v43
v_mfma_f32_16x16x32_bf16 a[12:15], a[236:239], v[48:51], a[12:15]
v_cvt_pk_bf16_f32 v52, v40, v41
v_cvt_pk_bf16_f32 v53, v42, v43
v_mfma_f32_16x16x32_bf16 v[36:39], a[208:211], a[128:131], 0
v_exp_f32 v44, v44
v_mfma_f32_16x16x32_bf16 v[36:39], a[212:215], a[132:135], v[36:39]
v_mfma_f32_16x16x32_bf16 v[36:39], a[216:219], a[136:139], v[36:39]
v_exp_f32 v45, v45
v_mfma_f32_16x16x32_bf16 v[36:39], a[220:223], a[140:143], v[36:39]
s_waitcnt lgkmcnt(2)
v_mfma_f32_16x16x32_bf16 a[16:19], a[240:243], v[48:51], a[16:19]
v_exp_f32 v46, v46
v_mfma_f32_16x16x32_bf16 a[20:23], a[244:247], v[48:51], a[20:23]
s_waitcnt lgkmcnt(0)
v_mfma_f32_16x16x32_bf16 a[24:27], a[248:251], v[48:51], a[24:27]
v_exp_f32 v47, v47
v_mfma_f32_16x16x32_bf16 a[28:31], a[252:255], v[48:51], a[28:31]
v_cvt_pk_bf16_f32 v54, v44, v45
v_cvt_pk_bf16_f32 v55, v46, v47
v_mfma_f32_16x16x32_bf16 v[40:43], a[192:195], a[144:147], 0
s_add_u32 s28, s25, 16384
v_exp_f32 v32, v32
v_mfma_f32_16x16x32_bf16 v[40:43], a[196:199], a[148:151], v[40:43]
s_add_u32 m0, s51, 4096
v_lshlrev_b32 v56, 16, v200
v_and_b32 v57, s32, v200
v_mfma_f32_16x16x32_bf16 v[40:43], a[200:203], a[152:155], v[40:43]
v_exp_f32 v33, v33
v_mfma_f32_16x16x32_bf16 v[40:43], a[204:207], a[156:159], v[40:43]
buffer_load_dwordx4 v5, s[4:7], s28 offen offset:0 nt lds
v_smfmac_f32_16x16x64_bf16 v[12:15], v[24:27], v[48:55], v28
v_mul_f32 v56, s30, v56
v_mul_f32 v57, s30, v57
v_mfma_f32_16x16x32_bf16 a[32:35], a[224:227], v[52:55], a[32:35]
v_exp_f32 v34, v34
v_mfma_f32_16x16x32_bf16 a[36:39], a[228:231], v[52:55], a[36:39]
v_cvt_pk_bf16_f32 v200, v56, v57
v_lshlrev_b32 v58, 16, v201
v_mfma_f32_16x16x32_bf16 a[40:43], a[232:235], v[52:55], a[40:43]
v_exp_f32 v35, v35
v_mfma_f32_16x16x32_bf16 a[44:47], a[236:239], v[52:55], a[44:47]
v_cvt_pk_bf16_f32 v48, v32, v33
v_cvt_pk_bf16_f32 v49, v34, v35
v_mfma_f32_16x16x32_bf16 v[44:47], a[208:211], a[144:147], 0
v_exp_f32 v36, v36
v_mfma_f32_16x16x32_bf16 v[44:47], a[212:215], a[148:151], v[44:47]
buffer_load_dwordx4 v5, s[4:7], s28 offen offset:2048 nt lds
v_mfma_f32_16x16x32_bf16 v[44:47], a[216:219], a[152:155], v[44:47]
v_exp_f32 v37, v37
v_mfma_f32_16x16x32_bf16 v[44:47], a[220:223], a[156:159], v[44:47]
v_and_b32 v59, s32, v201
v_mul_f32 v58, s30, v58
v_mfma_f32_16x16x32_bf16 a[48:51], a[240:243], v[52:55], a[48:51]
v_exp_f32 v38, v38
v_mfma_f32_16x16x32_bf16 a[52:55], a[244:247], v[52:55], a[52:55]
v_mul_f32 v59, s30, v59
v_cvt_pk_bf16_f32 v201, v58, v59
v_mfma_f32_16x16x32_bf16 a[56:59], a[248:251], v[52:55], a[56:59]
v_exp_f32 v39, v39
v_mfma_f32_16x16x32_bf16 a[60:63], a[252:255], v[52:55], a[60:63]
s_barrier
v_cvt_pk_bf16_f32 v50, v36, v37
v_cvt_pk_bf16_f32 v51, v38, v39
v_mfma_f32_16x16x32_bf16 v[32:35], a[192:195], a[160:163], 0
v_exp_f32 v40, v40
v_mfma_f32_16x16x32_bf16 v[32:35], a[196:199], a[164:167], v[32:35]
v_lshlrev_b32 v56, 16, v202
v_and_b32 v57, s32, v202
v_mfma_f32_16x16x32_bf16 v[32:35], a[200:203], a[168:171], v[32:35]
v_exp_f32 v41, v41
v_mfma_f32_16x16x32_bf16 v[32:35], a[204:207], a[172:175], v[32:35]
v_mul_f32 v56, s30, v56
v_mul_f32 v57, s30, v57
v_mfma_f32_16x16x32_bf16 a[64:67], a[224:227], v[48:51], a[64:67]
v_exp_f32 v42, v42
v_mfma_f32_16x16x32_bf16 a[68:71], a[228:231], v[48:51], a[68:71]
v_cvt_pk_bf16_f32 v202, v56, v57
v_lshlrev_b32 v58, 16, v203
v_mfma_f32_16x16x32_bf16 a[72:75], a[232:235], v[48:51], a[72:75]
v_exp_f32 v43, v43
v_mfma_f32_16x16x32_bf16 a[76:79], a[236:239], v[48:51], a[76:79]
v_cvt_pk_bf16_f32 v52, v40, v41
v_cvt_pk_bf16_f32 v53, v42, v43
v_mfma_f32_16x16x32_bf16 v[36:39], a[208:211], a[160:163], 0
v_exp_f32 v44, v44
v_mfma_f32_16x16x32_bf16 v[36:39], a[212:215], a[164:167], v[36:39]
v_and_b32 v59, s32, v203
v_mul_f32 v58, s30, v58
v_mfma_f32_16x16x32_bf16 v[36:39], a[216:219], a[168:171], v[36:39]
v_exp_f32 v45, v45
v_mfma_f32_16x16x32_bf16 v[36:39], a[220:223], a[172:175], v[36:39]
v_mul_f32 v59, s30, v59
v_cvt_pk_bf16_f32 v203, v58, v59
v_mfma_f32_16x16x32_bf16 a[80:83], a[240:243], v[48:51], a[80:83]
v_exp_f32 v46, v46
v_mfma_f32_16x16x32_bf16 a[84:87], a[244:247], v[48:51], a[84:87]
v_lshlrev_b32 v56, 16, v204
v_and_b32 v57, s32, v204
v_mfma_f32_16x16x32_bf16 a[88:91], a[248:251], v[48:51], a[88:91]
v_exp_f32 v47, v47
v_mfma_f32_16x16x32_bf16 a[92:95], a[252:255], v[48:51], a[92:95]
v_cvt_pk_bf16_f32 v54, v44, v45
v_cvt_pk_bf16_f32 v55, v46, v47
v_mfma_f32_16x16x32_bf16 v[40:43], a[192:195], a[176:179], 0
s_add_u32 m0, s22, 42240
v_exp_f32 v32, v32
v_mfma_f32_16x16x32_bf16 v[40:43], a[196:199], a[180:183], v[40:43]
ds_read_b128 a[192:195], v1 offset:8448
ds_read_b128 a[196:199], v1 offset:8512
v_mfma_f32_16x16x32_bf16 v[40:43], a[200:203], a[184:187], v[40:43]
v_exp_f32 v33, v33
v_mfma_f32_16x16x32_bf16 v[40:43], a[204:207], a[188:191], v[40:43]
ds_read_b128 a[200:203], v1 offset:8576
ds_read_b128 a[204:207], v1 offset:8640
v_smfmac_f32_16x16x64_bf16 v[16:19], v[24:27], v[48:55], v28
buffer_load_dwordx4 v4, s[12:15], s26 offen offset:0 nt lds
v_mfma_f32_16x16x32_bf16 v[64:67], a[224:227], v[52:55], v[64:67]
s_sub_u32 m0, m0, 1016
v_exp_f32 v34, v34
v_mfma_f32_16x16x32_bf16 v[68:71], a[228:231], v[52:55], v[68:71]
buffer_load_dwordx4 v4, s[12:15], s26 offen offset:2048 nt lds
v_mfma_f32_16x16x32_bf16 v[72:75], a[232:235], v[52:55], v[72:75]
s_add_u32 s26, s26, 8192
v_exp_f32 v35, v35
v_mfma_f32_16x16x32_bf16 v[76:79], a[236:239], v[52:55], v[76:79]
v_cvt_pk_bf16_f32 v48, v32, v33
v_cvt_pk_bf16_f32 v49, v34, v35
v_mfma_f32_16x16x32_bf16 v[44:47], a[208:211], a[176:179], 0
v_exp_f32 v36, v36
v_mfma_f32_16x16x32_bf16 v[44:47], a[212:215], a[180:183], v[44:47]
ds_read_b128 a[208:211], v1 offset:9472
ds_read_b128 a[212:215], v1 offset:9536
v_mfma_f32_16x16x32_bf16 v[44:47], a[216:219], a[184:187], v[44:47]
v_exp_f32 v37, v37
v_mfma_f32_16x16x32_bf16 v[44:47], a[220:223], a[188:191], v[44:47]
ds_read_b128 a[216:219], v1 offset:9600
ds_read_b128 a[220:223], v1 offset:9664
v_mfma_f32_16x16x32_bf16 v[80:83], a[240:243], v[52:55], v[80:83]
v_exp_f32 v38, v38
v_mfma_f32_16x16x32_bf16 v[84:87], a[244:247], v[52:55], v[84:87]
v_mul_f32 v56, s30, v56
v_mul_f32 v57, s30, v57
v_mfma_f32_16x16x32_bf16 v[88:91], a[248:251], v[52:55], v[88:91]
v_exp_f32 v39, v39
v_mfma_f32_16x16x32_bf16 v[92:95], a[252:255], v[52:55], v[92:95]
s_waitcnt lgkmcnt(4)
v_cvt_pk_bf16_f32 v50, v36, v37
v_cvt_pk_bf16_f32 v51, v38, v39
v_mfma_f32_16x16x32_bf16 v[32:35], a[192:195], a[96:99], 0
s_add_u32 m0, s21, 50688
v_exp_f32 v40, v40
v_mfma_f32_16x16x32_bf16 v[32:35], a[196:199], a[100:103], v[32:35]
buffer_load_dwordx4 v3, s[8:11], s26 offen offset:0 nt lds
v_mfma_f32_16x16x32_bf16 v[32:35], a[200:203], a[104:107], v[32:35]
v_exp_f32 v41, v41
v_mfma_f32_16x16x32_bf16 v[32:35], a[204:207], a[108:111], v[32:35]
v_cvt_pk_bf16_f32 v204, v56, v57
v_lshlrev_b32 v58, 16, v205
v_mfma_f32_16x16x32_bf16 v[96:99], a[224:227], v[48:51], v[96:99]
v_exp_f32 v42, v42
v_mfma_f32_16x16x32_bf16 v[100:103], a[228:231], v[48:51], v[100:103]
buffer_load_dwordx4 v3, s[8:11], s26 offen offset:1024 nt lds
v_mfma_f32_16x16x32_bf16 v[104:107], a[232:235], v[48:51], v[104:107]
v_exp_f32 v43, v43
v_mfma_f32_16x16x32_bf16 v[108:111], a[236:239], v[48:51], v[108:111]
s_waitcnt lgkmcnt(0)
v_cvt_pk_bf16_f32 v52, v40, v41
v_cvt_pk_bf16_f32 v53, v42, v43
v_mfma_f32_16x16x32_bf16 v[36:39], a[208:211], a[96:99], 0
v_exp_f32 v44, v44
v_mfma_f32_16x16x32_bf16 v[36:39], a[212:215], a[100:103], v[36:39]
v_and_b32 v59, s32, v205
v_mul_f32 v58, s30, v58
v_mfma_f32_16x16x32_bf16 v[36:39], a[216:219], a[104:107], v[36:39]
v_exp_f32 v45, v45
v_mfma_f32_16x16x32_bf16 v[36:39], a[220:223], a[108:111], v[36:39]
v_mul_f32 v59, s30, v59
v_cvt_pk_bf16_f32 v205, v58, v59
v_mfma_f32_16x16x32_bf16 v[112:115], a[240:243], v[48:51], v[112:115]
v_exp_f32 v46, v46
v_mfma_f32_16x16x32_bf16 v[116:119], a[244:247], v[48:51], v[116:119]
v_lshlrev_b32 v56, 16, v206
v_and_b32 v57, s32, v206
v_mfma_f32_16x16x32_bf16 v[120:123], a[248:251], v[48:51], v[120:123]
v_exp_f32 v47, v47
v_mfma_f32_16x16x32_bf16 v[124:127], a[252:255], v[48:51], v[124:127]
v_cvt_pk_bf16_f32 v54, v44, v45
v_cvt_pk_bf16_f32 v55, v46, v47
v_mfma_f32_16x16x32_bf16 v[40:43], a[192:195], a[112:115], 0
s_add_u32 s50, s39, 12288
v_exp_f32 v32, v32
v_mfma_f32_16x16x32_bf16 v[40:43], a[196:199], a[116:119], v[40:43]
v_exp_f32 v33, v33
v_mfma_f32_16x16x32_bf16 v[40:43], a[200:203], a[120:123], v[40:43]
v_exp_f32 v34, v34
v_mfma_f32_16x16x32_bf16 v[40:43], a[204:207], a[124:127], v[40:43]
v_exp_f32 v35, v35
v_smfmac_f32_16x16x64_bf16 v[20:23], v[24:27], v[48:55], v28
v_exp_f32 v36, v36
v_mfma_f32_16x16x32_bf16 v[128:131], a[224:227], v[52:55], v[128:131]
ds_read_b64_tr_b16 a[224:225], v2 offset:8448
ds_read_b64_tr_b16 a[226:227], v2 offset:8704
v_mfma_f32_16x16x32_bf16 v[132:135], a[228:231], v[52:55], v[132:135]
v_cvt_pk_bf16_f32 v48, v32, v33
v_cvt_pk_bf16_f32 v49, v34, v35
v_mfma_f32_16x16x32_bf16 v[136:139], a[232:235], v[52:55], v[136:139]
ds_read_b64_tr_b16 a[228:229], v2 offset:8456
ds_read_b64_tr_b16 a[230:231], v2 offset:8712
v_mfma_f32_16x16x32_bf16 v[140:143], a[236:239], v[52:55], v[140:143]
v_exp_f32 v37, v37
v_mfma_f32_16x16x32_bf16 v[44:47], a[208:211], a[112:115], 0
ds_read_b64_tr_b16 a[232:233], v2 offset:8512
ds_read_b64_tr_b16 a[234:235], v2 offset:8768
v_mfma_f32_16x16x32_bf16 v[44:47], a[212:215], a[116:119], v[44:47]
v_exp_f32 v38, v38
v_mfma_f32_16x16x32_bf16 v[44:47], a[216:219], a[120:123], v[44:47]
ds_read_b64_tr_b16 a[236:237], v2 offset:8520
ds_read_b64_tr_b16 a[238:239], v2 offset:8776
v_mfma_f32_16x16x32_bf16 v[44:47], a[220:223], a[124:127], v[44:47]
v_exp_f32 v39, v39
v_mfma_f32_16x16x32_bf16 v[144:147], a[240:243], v[52:55], v[144:147]
ds_read_b64_tr_b16 a[240:241], v2 offset:8576
ds_read_b64_tr_b16 a[242:243], v2 offset:8832
v_mfma_f32_16x16x32_bf16 v[148:151], a[244:247], v[52:55], v[148:151]
v_cndmask_b32_dpp v60, v216, v220, vcc row_ror:8 row_mask:0xf bank_mask:0xf
v_cndmask_b32_dpp v61, v217, v221, vcc row_ror:8 row_mask:0xf bank_mask:0xf
v_mfma_f32_16x16x32_bf16 v[152:155], a[248:251], v[52:55], v[152:155]
ds_read_b64_tr_b16 a[244:245], v2 offset:8584
ds_read_b64_tr_b16 a[246:247], v2 offset:8840
v_mfma_f32_16x16x32_bf16 v[156:159], a[252:255], v[52:55], v[156:159]
v_cvt_pk_bf16_f32 v50, v36, v37
v_cvt_pk_bf16_f32 v51, v38, v39
v_mfma_f32_16x16x32_bf16 v[32:35], a[192:195], a[128:131], 0
v_exp_f32 v40, v40
v_mfma_f32_16x16x32_bf16 v[32:35], a[196:199], a[132:135], v[32:35]
ds_read_b64_tr_b16 a[248:249], v2 offset:8640
ds_read_b64_tr_b16 a[250:251], v2 offset:8896
v_mfma_f32_16x16x32_bf16 v[32:35], a[200:203], a[136:139], v[32:35]
v_exp_f32 v41, v41
v_mfma_f32_16x16x32_bf16 v[32:35], a[204:207], a[140:143], v[32:35]
s_waitcnt lgkmcnt(6)
ds_read_b64_tr_b16 a[252:253], v2 offset:8648
ds_read_b64_tr_b16 a[254:255], v2 offset:8904
v_mfma_f32_16x16x32_bf16 a[0:3], a[224:227], v[48:51], a[0:3]
v_exp_f32 v42, v42
v_mfma_f32_16x16x32_bf16 a[4:7], a[228:231], v[48:51], a[4:7]
v_cndmask_b32_dpp v62, v218, v222, vcc row_ror:8 row_mask:0xf bank_mask:0xf
v_cndmask_b32_dpp v63, v219, v223, vcc row_ror:8 row_mask:0xf bank_mask:0xf
v_mfma_f32_16x16x32_bf16 a[8:11], a[232:235], v[48:51], a[8:11]
v_exp_f32 v43, v43
v_mfma_f32_16x16x32_bf16 a[12:15], a[236:239], v[48:51], a[12:15]
v_cvt_pk_bf16_f32 v52, v40, v41
v_cvt_pk_bf16_f32 v53, v42, v43
v_mfma_f32_16x16x32_bf16 v[36:39], a[208:211], a[128:131], 0
v_exp_f32 v44, v44
v_mfma_f32_16x16x32_bf16 v[36:39], a[212:215], a[132:135], v[36:39]
v_mov_b32_dpp v216, v220 row_ror:8 row_mask:0xf bank_mask:0xc
v_mov_b32_dpp v217, v221 row_ror:8 row_mask:0xf bank_mask:0xc
v_mfma_f32_16x16x32_bf16 v[36:39], a[216:219], a[136:139], v[36:39]
v_exp_f32 v45, v45
v_mfma_f32_16x16x32_bf16 v[36:39], a[220:223], a[140:143], v[36:39]
s_waitcnt lgkmcnt(0)
v_mov_b32_dpp v218, v222 row_ror:8 row_mask:0xf bank_mask:0xc
v_mov_b32_dpp v219, v223 row_ror:8 row_mask:0xf bank_mask:0xc
v_mfma_f32_16x16x32_bf16 a[16:19], a[240:243], v[48:51], a[16:19]
buffer_store_dwordx4 v[216:219], v6, s[16:19], s50 offen offset:128 nt
v_exp_f32 v46, v46
v_mul_f32 v56, s30, v56
v_mfma_f32_16x16x32_bf16 a[20:23], a[244:247], v[48:51], a[20:23]
v_mul_f32 v57, s30, v57
v_cvt_pk_bf16_f32 v206, v56, v57
v_mfma_f32_16x16x32_bf16 a[24:27], a[248:251], v[48:51], a[24:27]
v_exp_f32 v47, v47
v_mfma_f32_16x16x32_bf16 a[28:31], a[252:255], v[48:51], a[28:31]
v_cvt_pk_bf16_f32 v54, v44, v45
v_cvt_pk_bf16_f32 v55, v46, v47
v_mfma_f32_16x16x32_bf16 v[40:43], a[192:195], a[144:147], 0
s_waitcnt vmcnt(19)
buffer_store_dwordx4 v[60:63], v6, s[16:19], s50 offen offset:2176 nt
v_exp_f32 v32, v32
v_lshlrev_b32 v58, 16, v207
v_mfma_f32_16x16x32_bf16 v[40:43], a[196:199], a[148:151], v[40:43]
ds_read_b128 v[208:211], v8 offset:0
ds_read_b128 v[212:215], v8 offset:64
v_mfma_f32_16x16x32_bf16 v[40:43], a[200:203], a[152:155], v[40:43]
v_exp_f32 v33, v33
v_mfma_f32_16x16x32_bf16 v[40:43], a[204:207], a[156:159], v[40:43]
v_and_b32 v59, s32, v207
v_mul_f32 v58, s30, v58
v_smfmac_f32_16x16x64_bf16 v[12:15], v[24:27], v[48:55], v28
v_mul_f32 v59, s30, v59
v_cvt_pk_bf16_f32 v207, v58, v59
v_mfma_f32_16x16x32_bf16 a[32:35], a[224:227], v[52:55], a[32:35]
v_exp_f32 v34, v34
v_mfma_f32_16x16x32_bf16 a[36:39], a[228:231], v[52:55], a[36:39]
v_mfma_f32_16x16x32_bf16 a[40:43], a[232:235], v[52:55], a[40:43]
v_exp_f32 v35, v35
v_mfma_f32_16x16x32_bf16 a[44:47], a[236:239], v[52:55], a[44:47]
v_cvt_pk_bf16_f32 v48, v32, v33
v_cvt_pk_bf16_f32 v49, v34, v35
v_mfma_f32_16x16x32_bf16 v[44:47], a[208:211], a[144:147], 0
s_waitcnt lgkmcnt(0)
v_exp_f32 v36, v36
v_mfma_f32_16x16x32_bf16 v[44:47], a[212:215], a[148:151], v[44:47]
v_lshlrev_b32 v56, 16, v208
v_and_b32 v57, s32, v208
v_mfma_f32_16x16x32_bf16 v[44:47], a[216:219], a[152:155], v[44:47]
v_exp_f32 v37, v37
v_mfma_f32_16x16x32_bf16 v[44:47], a[220:223], a[156:159], v[44:47]
v_mul_f32 v56, s30, v56
v_mul_f32 v57, s30, v57
v_mfma_f32_16x16x32_bf16 a[48:51], a[240:243], v[52:55], a[48:51]
v_exp_f32 v38, v38
v_mfma_f32_16x16x32_bf16 a[52:55], a[244:247], v[52:55], a[52:55]
v_cvt_pk_bf16_f32 v208, v56, v57
v_lshlrev_b32 v58, 16, v209
v_mfma_f32_16x16x32_bf16 a[56:59], a[248:251], v[52:55], a[56:59]
v_exp_f32 v39, v39
v_mfma_f32_16x16x32_bf16 a[60:63], a[252:255], v[52:55], a[60:63]
v_cvt_pk_bf16_f32 v50, v36, v37
v_cvt_pk_bf16_f32 v51, v38, v39
v_mfma_f32_16x16x32_bf16 v[32:35], a[192:195], a[160:163], 0
s_add_u32 m0, s22, 50688
v_exp_f32 v40, v40
v_mfma_f32_16x16x32_bf16 v[32:35], a[196:199], a[164:167], v[32:35]
buffer_load_dwordx4 v4, s[12:15], s26 offen offset:0 nt lds
v_mfma_f32_16x16x32_bf16 v[32:35], a[200:203], a[168:171], v[32:35]
s_sub_u32 m0, m0, 1016
v_exp_f32 v41, v41
v_mfma_f32_16x16x32_bf16 v[32:35], a[204:207], a[172:175], v[32:35]
buffer_load_dwordx4 v4, s[12:15], s26 offen offset:2048 nt lds
v_mfma_f32_16x16x32_bf16 a[64:67], a[224:227], v[48:51], a[64:67]
s_add_u32 s26, s26, 8192
v_exp_f32 v42, v42
v_mfma_f32_16x16x32_bf16 a[68:71], a[228:231], v[48:51], a[68:71]
v_and_b32 v59, s32, v209
v_mul_f32 v58, s30, v58
v_mfma_f32_16x16x32_bf16 a[72:75], a[232:235], v[48:51], a[72:75]
v_exp_f32 v43, v43
v_mfma_f32_16x16x32_bf16 a[76:79], a[236:239], v[48:51], a[76:79]
v_cvt_pk_bf16_f32 v52, v40, v41
v_cvt_pk_bf16_f32 v53, v42, v43
v_mfma_f32_16x16x32_bf16 v[36:39], a[208:211], a[160:163], 0
v_exp_f32 v44, v44
v_mfma_f32_16x16x32_bf16 v[36:39], a[212:215], a[164:167], v[36:39]
v_mul_f32 v59, s30, v59
v_cvt_pk_bf16_f32 v209, v58, v59
v_mfma_f32_16x16x32_bf16 v[36:39], a[216:219], a[168:171], v[36:39]
v_exp_f32 v45, v45
v_mfma_f32_16x16x32_bf16 v[36:39], a[220:223], a[172:175], v[36:39]
v_lshlrev_b32 v56, 16, v210
v_and_b32 v57, s32, v210
v_mfma_f32_16x16x32_bf16 a[80:83], a[240:243], v[48:51], a[80:83]
v_exp_f32 v46, v46
v_mfma_f32_16x16x32_bf16 a[84:87], a[244:247], v[48:51], a[84:87]
v_mul_f32 v56, s30, v56
v_mul_f32 v57, s30, v57
v_mfma_f32_16x16x32_bf16 a[88:91], a[248:251], v[48:51], a[88:91]
v_exp_f32 v47, v47
v_mfma_f32_16x16x32_bf16 a[92:95], a[252:255], v[48:51], a[92:95]
v_cvt_pk_bf16_f32 v54, v44, v45
v_cvt_pk_bf16_f32 v55, v46, v47
v_mfma_f32_16x16x32_bf16 v[40:43], a[192:195], a[176:179], 0
s_sub_u32 m0, s51, 128
v_exp_f32 v32, v32
v_mfma_f32_16x16x32_bf16 v[40:43], a[196:199], a[180:183], v[40:43]
ds_read_b128 a[192:195], v1 offset:16896
ds_read_b128 a[196:199], v1 offset:16960
v_mfma_f32_16x16x32_bf16 v[40:43], a[200:203], a[184:187], v[40:43]
v_exp_f32 v33, v33
v_mfma_f32_16x16x32_bf16 v[40:43], a[204:207], a[188:191], v[40:43]
ds_read_b128 a[200:203], v1 offset:17024
ds_read_b128 a[204:207], v1 offset:17088
v_smfmac_f32_16x16x64_bf16 v[16:19], v[24:27], v[48:55], v28
buffer_load_dwordx4 v5, s[4:7], s28 offen offset:128 nt lds
v_mfma_f32_16x16x32_bf16 v[64:67], a[224:227], v[52:55], v[64:67]
v_exp_f32 v34, v34
v_mfma_f32_16x16x32_bf16 v[68:71], a[228:231], v[52:55], v[68:71]
v_cvt_pk_bf16_f32 v210, v56, v57
v_lshlrev_b32 v58, 16, v211
v_mfma_f32_16x16x32_bf16 v[72:75], a[232:235], v[52:55], v[72:75]
v_exp_f32 v35, v35
v_mfma_f32_16x16x32_bf16 v[76:79], a[236:239], v[52:55], v[76:79]
v_cvt_pk_bf16_f32 v48, v32, v33
v_cvt_pk_bf16_f32 v49, v34, v35
v_mfma_f32_16x16x32_bf16 v[44:47], a[208:211], a[176:179], 0
v_exp_f32 v36, v36
v_mfma_f32_16x16x32_bf16 v[44:47], a[212:215], a[180:183], v[44:47]
ds_read_b128 a[208:211], v1 offset:17920
ds_read_b128 a[212:215], v1 offset:17984
v_mfma_f32_16x16x32_bf16 v[44:47], a[216:219], a[184:187], v[44:47]
v_exp_f32 v37, v37
v_mfma_f32_16x16x32_bf16 v[44:47], a[220:223], a[188:191], v[44:47]
ds_read_b128 a[216:219], v1 offset:18048
ds_read_b128 a[220:223], v1 offset:18112
v_mfma_f32_16x16x32_bf16 v[80:83], a[240:243], v[52:55], v[80:83]
v_exp_f32 v38, v38
v_mfma_f32_16x16x32_bf16 v[84:87], a[244:247], v[52:55], v[84:87]
buffer_load_dwordx4 v5, s[4:7], s28 offen offset:2176 nt lds
v_mfma_f32_16x16x32_bf16 v[88:91], a[248:251], v[52:55], v[88:91]
v_exp_f32 v39, v39
v_mfma_f32_16x16x32_bf16 v[92:95], a[252:255], v[52:55], v[92:95]
s_waitcnt lgkmcnt(4)
v_cvt_pk_bf16_f32 v50, v36, v37
v_cvt_pk_bf16_f32 v51, v38, v39
v_mfma_f32_16x16x32_bf16 v[32:35], a[192:195], a[96:99], 0
v_exp_f32 v40, v40
v_mfma_f32_16x16x32_bf16 v[32:35], a[196:199], a[100:103], v[32:35]
v_and_b32 v59, s32, v211
v_mul_f32 v58, s30, v58
v_mfma_f32_16x16x32_bf16 v[32:35], a[200:203], a[104:107], v[32:35]
v_exp_f32 v41, v41
v_mfma_f32_16x16x32_bf16 v[32:35], a[204:207], a[108:111], v[32:35]
v_mul_f32 v59, s30, v59
v_cvt_pk_bf16_f32 v211, v58, v59
v_mfma_f32_16x16x32_bf16 v[96:99], a[224:227], v[48:51], v[96:99]
v_exp_f32 v42, v42
v_mfma_f32_16x16x32_bf16 v[100:103], a[228:231], v[48:51], v[100:103]
v_lshlrev_b32 v56, 16, v212
v_and_b32 v57, s32, v212
v_mfma_f32_16x16x32_bf16 v[104:107], a[232:235], v[48:51], v[104:107]
v_exp_f32 v43, v43
v_mfma_f32_16x16x32_bf16 v[108:111], a[236:239], v[48:51], v[108:111]
s_waitcnt lgkmcnt(0)
v_cvt_pk_bf16_f32 v52, v40, v41
v_cvt_pk_bf16_f32 v53, v42, v43
v_mfma_f32_16x16x32_bf16 v[36:39], a[208:211], a[96:99], 0
v_exp_f32 v44, v44
v_mfma_f32_16x16x32_bf16 v[36:39], a[212:215], a[100:103], v[36:39]
v_mul_f32 v56, s30, v56
v_mul_f32 v57, s30, v57
v_mfma_f32_16x16x32_bf16 v[36:39], a[216:219], a[104:107], v[36:39]
v_exp_f32 v45, v45
v_mfma_f32_16x16x32_bf16 v[36:39], a[220:223], a[108:111], v[36:39]
v_cvt_pk_bf16_f32 v212, v56, v57
v_lshlrev_b32 v58, 16, v213
v_mfma_f32_16x16x32_bf16 v[112:115], a[240:243], v[48:51], v[112:115]
v_exp_f32 v46, v46
v_mfma_f32_16x16x32_bf16 v[116:119], a[244:247], v[48:51], v[116:119]
v_and_b32 v59, s32, v213
v_mul_f32 v58, s30, v58
v_mfma_f32_16x16x32_bf16 v[120:123], a[248:251], v[48:51], v[120:123]
v_exp_f32 v47, v47
v_mfma_f32_16x16x32_bf16 v[124:127], a[252:255], v[48:51], v[124:127]
v_cvt_pk_bf16_f32 v54, v44, v45
v_cvt_pk_bf16_f32 v55, v46, v47
v_mfma_f32_16x16x32_bf16 v[40:43], a[192:195], a[112:115], 0
v_exp_f32 v32, v32
v_mfma_f32_16x16x32_bf16 v[40:43], a[196:199], a[116:119], v[40:43]
v_exp_f32 v33, v33
v_mfma_f32_16x16x32_bf16 v[40:43], a[200:203], a[120:123], v[40:43]
v_exp_f32 v34, v34
v_mfma_f32_16x16x32_bf16 v[40:43], a[204:207], a[124:127], v[40:43]
v_exp_f32 v35, v35
v_smfmac_f32_16x16x64_bf16 v[20:23], v[24:27], v[48:55], v28
v_exp_f32 v36, v36
v_mfma_f32_16x16x32_bf16 v[128:131], a[224:227], v[52:55], v[128:131]
ds_read_b64_tr_b16 a[224:225], v2 offset:16896
ds_read_b64_tr_b16 a[226:227], v2 offset:17152
v_mfma_f32_16x16x32_bf16 v[132:135], a[228:231], v[52:55], v[132:135]
v_cvt_pk_bf16_f32 v48, v32, v33
v_cvt_pk_bf16_f32 v49, v34, v35
v_mfma_f32_16x16x32_bf16 v[136:139], a[232:235], v[52:55], v[136:139]
ds_read_b64_tr_b16 a[228:229], v2 offset:16904
ds_read_b64_tr_b16 a[230:231], v2 offset:17160
v_mfma_f32_16x16x32_bf16 v[140:143], a[236:239], v[52:55], v[140:143]
v_exp_f32 v37, v37
v_mfma_f32_16x16x32_bf16 v[44:47], a[208:211], a[112:115], 0
ds_read_b64_tr_b16 a[232:233], v2 offset:16960
ds_read_b64_tr_b16 a[234:235], v2 offset:17216
v_mfma_f32_16x16x32_bf16 v[44:47], a[212:215], a[116:119], v[44:47]
v_exp_f32 v38, v38
v_mfma_f32_16x16x32_bf16 v[44:47], a[216:219], a[120:123], v[44:47]
ds_read_b64_tr_b16 a[236:237], v2 offset:16968
ds_read_b64_tr_b16 a[238:239], v2 offset:17224
v_mfma_f32_16x16x32_bf16 v[44:47], a[220:223], a[124:127], v[44:47]
v_exp_f32 v39, v39
v_mfma_f32_16x16x32_bf16 v[144:147], a[240:243], v[52:55], v[144:147]
ds_read_b64_tr_b16 a[240:241], v2 offset:17024
ds_read_b64_tr_b16 a[242:243], v2 offset:17280
v_mfma_f32_16x16x32_bf16 v[148:151], a[244:247], v[52:55], v[148:151]
v_mul_f32 v59, s30, v59
v_cvt_pk_bf16_f32 v213, v58, v59
v_mfma_f32_16x16x32_bf16 v[152:155], a[248:251], v[52:55], v[152:155]
ds_read_b64_tr_b16 a[244:245], v2 offset:17032
ds_read_b64_tr_b16 a[246:247], v2 offset:17288
v_mfma_f32_16x16x32_bf16 v[156:159], a[252:255], v[52:55], v[156:159]
v_cvt_pk_bf16_f32 v50, v36, v37
v_cvt_pk_bf16_f32 v51, v38, v39
v_mfma_f32_16x16x32_bf16 v[32:35], a[192:195], a[128:131], 0
s_add_u32 m0, s21, 59136
v_exp_f32 v40, v40
v_mfma_f32_16x16x32_bf16 v[32:35], a[196:199], a[132:135], v[32:35]
ds_read_b64_tr_b16 a[248:249], v2 offset:17088
ds_read_b64_tr_b16 a[250:251], v2 offset:17344
v_mfma_f32_16x16x32_bf16 v[32:35], a[200:203], a[136:139], v[32:35]
v_exp_f32 v41, v41
v_mfma_f32_16x16x32_bf16 v[32:35], a[204:207], a[140:143], v[32:35]
s_waitcnt lgkmcnt(6)
ds_read_b64_tr_b16 a[252:253], v2 offset:17096
ds_read_b64_tr_b16 a[254:255], v2 offset:17352
v_mfma_f32_16x16x32_bf16 a[0:3], a[224:227], v[48:51], a[0:3]
v_exp_f32 v42, v42
v_mfma_f32_16x16x32_bf16 a[4:7], a[228:231], v[48:51], a[4:7]
buffer_load_dwordx4 v3, s[8:11], s26 offen offset:0 nt lds
v_mfma_f32_16x16x32_bf16 a[8:11], a[232:235], v[48:51], a[8:11]
v_exp_f32 v43, v43
v_mfma_f32_16x16x32_bf16 a[12:15], a[236:239], v[48:51], a[12:15]
v_cvt_pk_bf16_f32 v52, v40, v41
v_cvt_pk_bf16_f32 v53, v42, v43
v_mfma_f32_16x16x32_bf16 v[36:39], a[208:211], a[128:131], 0
v_exp_f32 v44, v44
v_mfma_f32_16x16x32_bf16 v[36:39], a[212:215], a[132:135], v[36:39]
buffer_load_dwordx4 v3, s[8:11], s26 offen offset:1024 nt lds
v_mfma_f32_16x16x32_bf16 v[36:39], a[216:219], a[136:139], v[36:39]
v_exp_f32 v45, v45
v_mfma_f32_16x16x32_bf16 v[36:39], a[220:223], a[140:143], v[36:39]
s_waitcnt lgkmcnt(0)
v_lshlrev_b32 v56, 16, v214
v_and_b32 v57, s32, v214
v_mfma_f32_16x16x32_bf16 a[16:19], a[240:243], v[48:51], a[16:19]
v_exp_f32 v46, v46
v_mfma_f32_16x16x32_bf16 a[20:23], a[244:247], v[48:51], a[20:23]
v_mul_f32 v56, s30, v56
v_mul_f32 v57, s30, v57
v_mfma_f32_16x16x32_bf16 a[24:27], a[248:251], v[48:51], a[24:27]
v_exp_f32 v47, v47
v_mfma_f32_16x16x32_bf16 a[28:31], a[252:255], v[48:51], a[28:31]
v_cvt_pk_bf16_f32 v54, v44, v45
v_cvt_pk_bf16_f32 v55, v46, v47
v_mfma_f32_16x16x32_bf16 v[40:43], a[192:195], a[144:147], 0
s_add_u32 s50, s39, 16384
v_exp_f32 v32, v32
v_mfma_f32_16x16x32_bf16 v[40:43], a[196:199], a[148:151], v[40:43]
v_cndmask_b32_dpp v60, v224, v228, vcc row_ror:8 row_mask:0xf bank_mask:0xf
v_cndmask_b32_dpp v61, v225, v229, vcc row_ror:8 row_mask:0xf bank_mask:0xf
v_mfma_f32_16x16x32_bf16 v[40:43], a[200:203], a[152:155], v[40:43]
v_exp_f32 v33, v33
v_mfma_f32_16x16x32_bf16 v[40:43], a[204:207], a[156:159], v[40:43]
v_cndmask_b32_dpp v62, v226, v230, vcc row_ror:8 row_mask:0xf bank_mask:0xf
v_cndmask_b32_dpp v63, v227, v231, vcc row_ror:8 row_mask:0xf bank_mask:0xf
v_smfmac_f32_16x16x64_bf16 v[12:15], v[24:27], v[48:55], v28
v_mov_b32_dpp v224, v228 row_ror:8 row_mask:0xf bank_mask:0xc
v_mov_b32_dpp v225, v229 row_ror:8 row_mask:0xf bank_mask:0xc
v_mfma_f32_16x16x32_bf16 a[32:35], a[224:227], v[52:55], a[32:35]
v_exp_f32 v34, v34
v_mfma_f32_16x16x32_bf16 a[36:39], a[228:231], v[52:55], a[36:39]
v_mov_b32_dpp v226, v230 row_ror:8 row_mask:0xf bank_mask:0xc
v_mov_b32_dpp v227, v231 row_ror:8 row_mask:0xf bank_mask:0xc
v_mfma_f32_16x16x32_bf16 a[40:43], a[232:235], v[52:55], a[40:43]
buffer_store_dwordx4 v[224:227], v6, s[16:19], s50 offen offset:0 nt
v_exp_f32 v35, v35
v_cvt_pk_bf16_f32 v214, v56, v57
v_mfma_f32_16x16x32_bf16 a[44:47], a[236:239], v[52:55], a[44:47]
v_cvt_pk_bf16_f32 v48, v32, v33
v_cvt_pk_bf16_f32 v49, v34, v35
v_mfma_f32_16x16x32_bf16 v[44:47], a[208:211], a[144:147], 0
v_exp_f32 v36, v36
v_mfma_f32_16x16x32_bf16 v[44:47], a[212:215], a[148:151], v[44:47]
v_lshlrev_b32 v58, 16, v215
v_and_b32 v59, s32, v215
v_mfma_f32_16x16x32_bf16 v[44:47], a[216:219], a[152:155], v[44:47]
buffer_store_dwordx4 v[60:63], v6, s[16:19], s50 offen offset:2048 nt
v_exp_f32 v37, v37
v_mul_f32 v58, s30, v58
v_mfma_f32_16x16x32_bf16 v[44:47], a[220:223], a[156:159], v[44:47]
v_mul_f32 v59, s30, v59
v_cvt_pk_bf16_f32 v215, v58, v59
v_mfma_f32_16x16x32_bf16 a[48:51], a[240:243], v[52:55], a[48:51]
v_exp_f32 v38, v38
v_mfma_f32_16x16x32_bf16 a[52:55], a[244:247], v[52:55], a[52:55]
v_mfma_f32_16x16x32_bf16 a[56:59], a[248:251], v[52:55], a[56:59]
s_waitcnt vmcnt(22)
v_exp_f32 v39, v39
v_mfma_f32_16x16x32_bf16 a[60:63], a[252:255], v[52:55], a[60:63]
s_barrier
v_cvt_pk_bf16_f32 v50, v36, v37
v_cvt_pk_bf16_f32 v51, v38, v39
v_mfma_f32_16x16x32_bf16 v[32:35], a[192:195], a[160:163], 0
s_waitcnt vmcnt(20)
v_exp_f32 v40, v40
v_mfma_f32_16x16x32_bf16 v[32:35], a[196:199], a[164:167], v[32:35]
ds_read_b128 v[216:219], v8 offset:1024
ds_read_b128 v[220:223], v8 offset:1088
v_mfma_f32_16x16x32_bf16 v[32:35], a[200:203], a[168:171], v[32:35]
v_exp_f32 v41, v41
v_mfma_f32_16x16x32_bf16 v[32:35], a[204:207], a[172:175], v[32:35]
v_mfma_f32_16x16x32_bf16 a[64:67], a[224:227], v[48:51], a[64:67]
v_exp_f32 v42, v42
v_mfma_f32_16x16x32_bf16 a[68:71], a[228:231], v[48:51], a[68:71]
v_mfma_f32_16x16x32_bf16 a[72:75], a[232:235], v[48:51], a[72:75]
v_exp_f32 v43, v43
v_mfma_f32_16x16x32_bf16 a[76:79], a[236:239], v[48:51], a[76:79]
v_cvt_pk_bf16_f32 v52, v40, v41
v_cvt_pk_bf16_f32 v53, v42, v43
v_mfma_f32_16x16x32_bf16 v[36:39], a[208:211], a[160:163], 0
s_waitcnt lgkmcnt(0)
v_exp_f32 v44, v44
v_mfma_f32_16x16x32_bf16 v[36:39], a[212:215], a[164:167], v[36:39]
v_lshlrev_b32 v56, 16, v216
v_and_b32 v57, s32, v216
v_mfma_f32_16x16x32_bf16 v[36:39], a[216:219], a[168:171], v[36:39]
v_exp_f32 v45, v45
v_mfma_f32_16x16x32_bf16 v[36:39], a[220:223], a[172:175], v[36:39]
v_mul_f32 v56, s30, v56
v_mul_f32 v57, s30, v57
v_mfma_f32_16x16x32_bf16 a[80:83], a[240:243], v[48:51], a[80:83]
v_exp_f32 v46, v46
v_mfma_f32_16x16x32_bf16 a[84:87], a[244:247], v[48:51], a[84:87]
v_cvt_pk_bf16_f32 v216, v56, v57
v_lshlrev_b32 v58, 16, v217
v_mfma_f32_16x16x32_bf16 a[88:91], a[248:251], v[48:51], a[88:91]
v_exp_f32 v47, v47
v_mfma_f32_16x16x32_bf16 a[92:95], a[252:255], v[48:51], a[92:95]
v_cvt_pk_bf16_f32 v54, v44, v45
v_cvt_pk_bf16_f32 v55, v46, v47
v_mfma_f32_16x16x32_bf16 v[40:43], a[192:195], a[176:179], 0
v_exp_f32 v32, v32
v_mfma_f32_16x16x32_bf16 v[40:43], a[196:199], a[180:183], v[40:43]
ds_read_b128 a[192:195], v1 offset:25344
ds_read_b128 a[196:199], v1 offset:25408
v_mfma_f32_16x16x32_bf16 v[40:43], a[200:203], a[184:187], v[40:43]
v_exp_f32 v33, v33
v_mfma_f32_16x16x32_bf16 v[40:43], a[204:207], a[188:191], v[40:43]
ds_read_b128 a[200:203], v1 offset:25472
ds_read_b128 a[204:207], v1 offset:25536
v_smfmac_f32_16x16x64_bf16 v[16:19], v[24:27], v[48:55], v28
v_and_b32 v59, s32, v217
v_mul_f32 v58, s30, v58
v_mfma_f32_16x16x32_bf16 v[64:67], a[224:227], v[52:55], v[64:67]
v_exp_f32 v34, v34
v_mfma_f32_16x16x32_bf16 v[68:71], a[228:231], v[52:55], v[68:71]
v_mul_f32 v59, s30, v59
v_cvt_pk_bf16_f32 v217, v58, v59
v_mfma_f32_16x16x32_bf16 v[72:75], a[232:235], v[52:55], v[72:75]
v_exp_f32 v35, v35
v_mfma_f32_16x16x32_bf16 v[76:79], a[236:239], v[52:55], v[76:79]
v_cvt_pk_bf16_f32 v48, v32, v33
v_cvt_pk_bf16_f32 v49, v34, v35
v_mfma_f32_16x16x32_bf16 v[44:47], a[208:211], a[176:179], 0
v_exp_f32 v36, v36
v_mfma_f32_16x16x32_bf16 v[44:47], a[212:215], a[180:183], v[44:47]
ds_read_b128 a[208:211], v1 offset:26368
ds_read_b128 a[212:215], v1 offset:26432
v_mfma_f32_16x16x32_bf16 v[44:47], a[216:219], a[184:187], v[44:47]
v_exp_f32 v37, v37
v_mfma_f32_16x16x32_bf16 v[44:47], a[220:223], a[188:191], v[44:47]
ds_read_b128 a[216:219], v1 offset:26496
ds_read_b128 a[220:223], v1 offset:26560
v_mfma_f32_16x16x32_bf16 v[80:83], a[240:243], v[52:55], v[80:83]
v_exp_f32 v38, v38
v_mfma_f32_16x16x32_bf16 v[84:87], a[244:247], v[52:55], v[84:87]
v_lshlrev_b32 v56, 16, v218
v_and_b32 v57, s32, v218
v_mfma_f32_16x16x32_bf16 v[88:91], a[248:251], v[52:55], v[88:91]
v_exp_f32 v39, v39
v_mfma_f32_16x16x32_bf16 v[92:95], a[252:255], v[52:55], v[92:95]
s_waitcnt lgkmcnt(4)
v_cvt_pk_bf16_f32 v50, v36, v37
v_cvt_pk_bf16_f32 v51, v38, v39
v_mfma_f32_16x16x32_bf16 v[32:35], a[192:195], a[96:99], 0
s_add_u32 s28, s25, 20480
v_exp_f32 v40, v40
v_mfma_f32_16x16x32_bf16 v[32:35], a[196:199], a[100:103], v[32:35]
s_add_u32 m0, s51, 1024
v_mul_f32 v56, s30, v56
v_mul_f32 v57, s30, v57
v_mfma_f32_16x16x32_bf16 v[32:35], a[200:203], a[104:107], v[32:35]
v_exp_f32 v41, v41
v_mfma_f32_16x16x32_bf16 v[32:35], a[204:207], a[108:111], v[32:35]
buffer_load_dwordx4 v5, s[4:7], s28 offen offset:0 nt lds
v_mfma_f32_16x16x32_bf16 v[96:99], a[224:227], v[48:51], v[96:99]
v_exp_f32 v42, v42
v_mfma_f32_16x16x32_bf16 v[100:103], a[228:231], v[48:51], v[100:103]
v_cvt_pk_bf16_f32 v218, v56, v57
v_lshlrev_b32 v58, 16, v219
v_mfma_f32_16x16x32_bf16 v[104:107], a[232:235], v[48:51], v[104:107]
v_exp_f32 v43, v43
v_mfma_f32_16x16x32_bf16 v[108:111], a[236:239], v[48:51], v[108:111]
s_waitcnt lgkmcnt(0)
v_cvt_pk_bf16_f32 v52, v40, v41
v_cvt_pk_bf16_f32 v53, v42, v43
v_mfma_f32_16x16x32_bf16 v[36:39], a[208:211], a[96:99], 0
v_exp_f32 v44, v44
v_mfma_f32_16x16x32_bf16 v[36:39], a[212:215], a[100:103], v[36:39]
buffer_load_dwordx4 v5, s[4:7], s28 offen offset:2048 nt lds
v_mfma_f32_16x16x32_bf16 v[36:39], a[216:219], a[104:107], v[36:39]
v_exp_f32 v45, v45
v_mfma_f32_16x16x32_bf16 v[36:39], a[220:223], a[108:111], v[36:39]
v_and_b32 v59, s32, v219
v_mul_f32 v58, s30, v58
v_mfma_f32_16x16x32_bf16 v[112:115], a[240:243], v[48:51], v[112:115]
v_exp_f32 v46, v46
v_mfma_f32_16x16x32_bf16 v[116:119], a[244:247], v[48:51], v[116:119]
v_mul_f32 v59, s30, v59
v_cvt_pk_bf16_f32 v219, v58, v59
v_mfma_f32_16x16x32_bf16 v[120:123], a[248:251], v[48:51], v[120:123]
v_exp_f32 v47, v47
v_mfma_f32_16x16x32_bf16 v[124:127], a[252:255], v[48:51], v[124:127]
v_cvt_pk_bf16_f32 v54, v44, v45
v_cvt_pk_bf16_f32 v55, v46, v47
v_mfma_f32_16x16x32_bf16 v[40:43], a[192:195], a[112:115], 0
v_exp_f32 v32, v32
v_mfma_f32_16x16x32_bf16 v[40:43], a[196:199], a[116:119], v[40:43]
v_exp_f32 v33, v33
v_mfma_f32_16x16x32_bf16 v[40:43], a[200:203], a[120:123], v[40:43]
v_exp_f32 v34, v34
v_mfma_f32_16x16x32_bf16 v[40:43], a[204:207], a[124:127], v[40:43]
v_exp_f32 v35, v35
v_smfmac_f32_16x16x64_bf16 v[20:23], v[24:27], v[48:55], v28
v_exp_f32 v36, v36
v_mfma_f32_16x16x32_bf16 v[128:131], a[224:227], v[52:55], v[128:131]
ds_read_b64_tr_b16 a[224:225], v2 offset:25344
ds_read_b64_tr_b16 a[226:227], v2 offset:25600
v_mfma_f32_16x16x32_bf16 v[132:135], a[228:231], v[52:55], v[132:135]
v_cvt_pk_bf16_f32 v48, v32, v33
v_cvt_pk_bf16_f32 v49, v34, v35
v_mfma_f32_16x16x32_bf16 v[136:139], a[232:235], v[52:55], v[136:139]
ds_read_b64_tr_b16 a[228:229], v2 offset:25352
ds_read_b64_tr_b16 a[230:231], v2 offset:25608
v_mfma_f32_16x16x32_bf16 v[140:143], a[236:239], v[52:55], v[140:143]
v_exp_f32 v37, v37
v_mfma_f32_16x16x32_bf16 v[44:47], a[208:211], a[112:115], 0
ds_read_b64_tr_b16 a[232:233], v2 offset:25408
ds_read_b64_tr_b16 a[234:235], v2 offset:25664
v_mfma_f32_16x16x32_bf16 v[44:47], a[212:215], a[116:119], v[44:47]
v_exp_f32 v38, v38
v_mfma_f32_16x16x32_bf16 v[44:47], a[216:219], a[120:123], v[44:47]
ds_read_b64_tr_b16 a[236:237], v2 offset:25416
ds_read_b64_tr_b16 a[238:239], v2 offset:25672
v_mfma_f32_16x16x32_bf16 v[44:47], a[220:223], a[124:127], v[44:47]
v_exp_f32 v39, v39
v_mfma_f32_16x16x32_bf16 v[144:147], a[240:243], v[52:55], v[144:147]
ds_read_b64_tr_b16 a[240:241], v2 offset:25472
ds_read_b64_tr_b16 a[242:243], v2 offset:25728
v_mfma_f32_16x16x32_bf16 v[148:151], a[244:247], v[52:55], v[148:151]
v_lshlrev_b32 v56, 16, v220
v_and_b32 v57, s32, v220
v_mfma_f32_16x16x32_bf16 v[152:155], a[248:251], v[52:55], v[152:155]
ds_read_b64_tr_b16 a[244:245], v2 offset:25480
ds_read_b64_tr_b16 a[246:247], v2 offset:25736
v_mfma_f32_16x16x32_bf16 v[156:159], a[252:255], v[52:55], v[156:159]
v_cvt_pk_bf16_f32 v50, v36, v37
v_cvt_pk_bf16_f32 v51, v38, v39
v_mfma_f32_16x16x32_bf16 v[32:35], a[192:195], a[128:131], 0
s_add_u32 m0, s22, 59136
v_exp_f32 v40, v40
v_mfma_f32_16x16x32_bf16 v[32:35], a[196:199], a[132:135], v[32:35]
ds_read_b64_tr_b16 a[248:249], v2 offset:25536
ds_read_b64_tr_b16 a[250:251], v2 offset:25792
v_mfma_f32_16x16x32_bf16 v[32:35], a[200:203], a[136:139], v[32:35]
v_exp_f32 v41, v41
v_mfma_f32_16x16x32_bf16 v[32:35], a[204:207], a[140:143], v[32:35]
s_waitcnt lgkmcnt(6)
ds_read_b64_tr_b16 a[252:253], v2 offset:25544
ds_read_b64_tr_b16 a[254:255], v2 offset:25800
v_mfma_f32_16x16x32_bf16 a[0:3], a[224:227], v[48:51], a[0:3]
v_exp_f32 v42, v42
v_mfma_f32_16x16x32_bf16 a[4:7], a[228:231], v[48:51], a[4:7]
buffer_load_dwordx4 v4, s[12:15], s26 offen offset:0 nt lds
v_mfma_f32_16x16x32_bf16 a[8:11], a[232:235], v[48:51], a[8:11]
s_sub_u32 m0, m0, 1016
v_exp_f32 v43, v43
v_mfma_f32_16x16x32_bf16 a[12:15], a[236:239], v[48:51], a[12:15]
v_cvt_pk_bf16_f32 v52, v40, v41
v_cvt_pk_bf16_f32 v53, v42, v43
v_mfma_f32_16x16x32_bf16 v[36:39], a[208:211], a[128:131], 0
v_exp_f32 v44, v44
v_mfma_f32_16x16x32_bf16 v[36:39], a[212:215], a[132:135], v[36:39]
buffer_load_dwordx4 v4, s[12:15], s26 offen offset:2048 nt lds
v_mfma_f32_16x16x32_bf16 v[36:39], a[216:219], a[136:139], v[36:39]
s_add_u32 s26, s26, 8192
v_exp_f32 v45, v45
v_mfma_f32_16x16x32_bf16 v[36:39], a[220:223], a[140:143], v[36:39]
s_waitcnt lgkmcnt(0)
v_mul_f32 v56, s30, v56
v_mul_f32 v57, s30, v57
v_mfma_f32_16x16x32_bf16 a[16:19], a[240:243], v[48:51], a[16:19]
v_exp_f32 v46, v46
v_mfma_f32_16x16x32_bf16 a[20:23], a[244:247], v[48:51], a[20:23]
v_cvt_pk_bf16_f32 v220, v56, v57
v_lshlrev_b32 v58, 16, v221
v_mfma_f32_16x16x32_bf16 a[24:27], a[248:251], v[48:51], a[24:27]
v_exp_f32 v47, v47
v_mfma_f32_16x16x32_bf16 a[28:31], a[252:255], v[48:51], a[28:31]
v_cvt_pk_bf16_f32 v54, v44, v45
v_cvt_pk_bf16_f32 v55, v46, v47
v_mfma_f32_16x16x32_bf16 v[40:43], a[192:195], a[144:147], 0
v_exp_f32 v32, v32
v_mfma_f32_16x16x32_bf16 v[40:43], a[196:199], a[148:151], v[40:43]
v_and_b32 v59, s32, v221
v_mul_f32 v58, s30, v58
v_mfma_f32_16x16x32_bf16 v[40:43], a[200:203], a[152:155], v[40:43]
v_exp_f32 v33, v33
v_mfma_f32_16x16x32_bf16 v[40:43], a[204:207], a[156:159], v[40:43]
v_mul_f32 v59, s30, v59
v_cvt_pk_bf16_f32 v221, v58, v59
v_smfmac_f32_16x16x64_bf16 v[12:15], v[24:27], v[48:55], v28
v_lshlrev_b32 v56, 16, v222
v_and_b32 v57, s32, v222
v_mfma_f32_16x16x32_bf16 a[32:35], a[224:227], v[52:55], a[32:35]
v_exp_f32 v34, v34
v_mfma_f32_16x16x32_bf16 a[36:39], a[228:231], v[52:55], a[36:39]
v_mul_f32 v56, s30, v56
v_mul_f32 v57, s30, v57
v_mfma_f32_16x16x32_bf16 a[40:43], a[232:235], v[52:55], a[40:43]
v_exp_f32 v35, v35
v_mfma_f32_16x16x32_bf16 a[44:47], a[236:239], v[52:55], a[44:47]
v_cvt_pk_bf16_f32 v48, v32, v33
v_cvt_pk_bf16_f32 v49, v34, v35
v_mfma_f32_16x16x32_bf16 v[44:47], a[208:211], a[144:147], 0
v_exp_f32 v36, v36
v_mfma_f32_16x16x32_bf16 v[44:47], a[212:215], a[148:151], v[44:47]
v_cvt_pk_bf16_f32 v222, v56, v57
v_lshlrev_b32 v58, 16, v223
v_mfma_f32_16x16x32_bf16 v[44:47], a[216:219], a[152:155], v[44:47]
v_exp_f32 v37, v37
v_mfma_f32_16x16x32_bf16 v[44:47], a[220:223], a[156:159], v[44:47]
v_and_b32 v59, s32, v223
v_mul_f32 v58, s30, v58
v_mfma_f32_16x16x32_bf16 a[48:51], a[240:243], v[52:55], a[48:51]
v_exp_f32 v38, v38
v_mfma_f32_16x16x32_bf16 a[52:55], a[244:247], v[52:55], a[52:55]
v_mul_f32 v59, s30, v59
v_cvt_pk_bf16_f32 v223, v58, v59
v_mfma_f32_16x16x32_bf16 a[56:59], a[248:251], v[52:55], a[56:59]
v_exp_f32 v39, v39
v_mfma_f32_16x16x32_bf16 a[60:63], a[252:255], v[52:55], a[60:63]
v_cvt_pk_bf16_f32 v50, v36, v37
v_cvt_pk_bf16_f32 v51, v38, v39
v_mfma_f32_16x16x32_bf16 v[32:35], a[192:195], a[160:163], 0
s_add_u32 s50, s39, 16384
v_exp_f32 v40, v40
v_mfma_f32_16x16x32_bf16 v[32:35], a[196:199], a[164:167], v[32:35]
v_cndmask_b32_dpp v60, v232, v236, vcc row_ror:8 row_mask:0xf bank_mask:0xf
v_cndmask_b32_dpp v61, v233, v237, vcc row_ror:8 row_mask:0xf bank_mask:0xf
v_mfma_f32_16x16x32_bf16 v[32:35], a[200:203], a[168:171], v[32:35]
v_exp_f32 v41, v41
v_mfma_f32_16x16x32_bf16 v[32:35], a[204:207], a[172:175], v[32:35]
v_cndmask_b32_dpp v62, v234, v238, vcc row_ror:8 row_mask:0xf bank_mask:0xf
v_cndmask_b32_dpp v63, v235, v239, vcc row_ror:8 row_mask:0xf bank_mask:0xf
v_mfma_f32_16x16x32_bf16 a[64:67], a[224:227], v[48:51], a[64:67]
v_exp_f32 v42, v42
v_mfma_f32_16x16x32_bf16 a[68:71], a[228:231], v[48:51], a[68:71]
v_mov_b32_dpp v232, v236 row_ror:8 row_mask:0xf bank_mask:0xc
v_mov_b32_dpp v233, v237 row_ror:8 row_mask:0xf bank_mask:0xc
v_mfma_f32_16x16x32_bf16 a[72:75], a[232:235], v[48:51], a[72:75]
v_exp_f32 v43, v43
v_mfma_f32_16x16x32_bf16 a[76:79], a[236:239], v[48:51], a[76:79]
v_cvt_pk_bf16_f32 v52, v40, v41
v_cvt_pk_bf16_f32 v53, v42, v43
v_mfma_f32_16x16x32_bf16 v[36:39], a[208:211], a[160:163], 0
v_exp_f32 v44, v44
v_mfma_f32_16x16x32_bf16 v[36:39], a[212:215], a[164:167], v[36:39]
v_mov_b32_dpp v234, v238 row_ror:8 row_mask:0xf bank_mask:0xc
v_mov_b32_dpp v235, v239 row_ror:8 row_mask:0xf bank_mask:0xc
v_mfma_f32_16x16x32_bf16 v[36:39], a[216:219], a[168:171], v[36:39]
buffer_store_dwordx4 v[232:235], v6, s[16:19], s50 offen offset:128 nt
v_exp_f32 v45, v45
v_mfma_f32_16x16x32_bf16 v[36:39], a[220:223], a[172:175], v[36:39]
v_mfma_f32_16x16x32_bf16 a[80:83], a[240:243], v[48:51], a[80:83]
v_exp_f32 v46, v46
v_mfma_f32_16x16x32_bf16 a[84:87], a[244:247], v[48:51], a[84:87]
v_mfma_f32_16x16x32_bf16 a[88:91], a[248:251], v[48:51], a[88:91]
buffer_store_dwordx4 v[60:63], v6, s[16:19], s50 offen offset:2176 nt
v_exp_f32 v47, v47
v_mfma_f32_16x16x32_bf16 a[92:95], a[252:255], v[48:51], a[92:95]
v_cvt_pk_bf16_f32 v54, v44, v45
v_cvt_pk_bf16_f32 v55, v46, v47
v_mfma_f32_16x16x32_bf16 v[40:43], a[192:195], a[176:179], 0
s_waitcnt vmcnt(20)
v_exp_f32 v32, v32
v_mfma_f32_16x16x32_bf16 v[40:43], a[196:199], a[180:183], v[40:43]
ds_read_b128 a[192:195], v1 offset:33792
ds_read_b128 a[196:199], v1 offset:33856
v_mfma_f32_16x16x32_bf16 v[40:43], a[200:203], a[184:187], v[40:43]
v_exp_f32 v33, v33
v_mfma_f32_16x16x32_bf16 v[40:43], a[204:207], a[188:191], v[40:43]
ds_read_b128 a[200:203], v1 offset:33920
ds_read_b128 a[204:207], v1 offset:33984
v_smfmac_f32_16x16x64_bf16 v[16:19], v[24:27], v[48:55], v28
v_mfma_f32_16x16x32_bf16 v[64:67], a[224:227], v[52:55], v[64:67]
v_exp_f32 v34, v34
v_mfma_f32_16x16x32_bf16 v[68:71], a[228:231], v[52:55], v[68:71]
ds_read_b128 v[224:227], v8 offset:4096
ds_read_b128 v[228:231], v8 offset:4160
v_mfma_f32_16x16x32_bf16 v[72:75], a[232:235], v[52:55], v[72:75]
v_exp_f32 v35, v35
v_mfma_f32_16x16x32_bf16 v[76:79], a[236:239], v[52:55], v[76:79]
v_cvt_pk_bf16_f32 v48, v32, v33
v_cvt_pk_bf16_f32 v49, v34, v35
v_mfma_f32_16x16x32_bf16 v[44:47], a[208:211], a[176:179], 0
v_exp_f32 v36, v36
v_mfma_f32_16x16x32_bf16 v[44:47], a[212:215], a[180:183], v[44:47]
ds_read_b128 a[208:211], v1 offset:34816
ds_read_b128 a[212:215], v1 offset:34880
v_mfma_f32_16x16x32_bf16 v[44:47], a[216:219], a[184:187], v[44:47]
v_exp_f32 v37, v37
v_mfma_f32_16x16x32_bf16 v[44:47], a[220:223], a[188:191], v[44:47]
ds_read_b128 a[216:219], v1 offset:34944
ds_read_b128 a[220:223], v1 offset:35008
v_mfma_f32_16x16x32_bf16 v[80:83], a[240:243], v[52:55], v[80:83]
v_exp_f32 v38, v38
v_mfma_f32_16x16x32_bf16 v[84:87], a[244:247], v[52:55], v[84:87]
s_waitcnt lgkmcnt(4)
v_mfma_f32_16x16x32_bf16 v[88:91], a[248:251], v[52:55], v[88:91]
v_exp_f32 v39, v39
v_mfma_f32_16x16x32_bf16 v[92:95], a[252:255], v[52:55], v[92:95]
v_cvt_pk_bf16_f32 v50, v36, v37
v_cvt_pk_bf16_f32 v51, v38, v39
v_mfma_f32_16x16x32_bf16 v[32:35], a[192:195], a[96:99], 0
s_mov_b32 s26, s27
v_exp_f32 v40, v40
v_mfma_f32_16x16x32_bf16 v[32:35], a[196:199], a[100:103], v[32:35]
s_cmp_lt_u32 s23, 3
s_cselect_b32 s10, s10, 0
s_cselect_b32 s14, s14, 0
v_mfma_f32_16x16x32_bf16 v[32:35], a[200:203], a[104:107], v[32:35]
s_add_u32 m0, s21, 0
v_exp_f32 v41, v41
v_mfma_f32_16x16x32_bf16 v[32:35], a[204:207], a[108:111], v[32:35]
buffer_load_dwordx4 v3, s[8:11], s26 offen offset:0 nt lds
v_mfma_f32_16x16x32_bf16 v[96:99], a[224:227], v[48:51], v[96:99]
v_exp_f32 v42, v42
v_mfma_f32_16x16x32_bf16 v[100:103], a[228:231], v[48:51], v[100:103]
v_lshlrev_b32 v56, 16, v224
v_and_b32 v57, s32, v224
v_mfma_f32_16x16x32_bf16 v[104:107], a[232:235], v[48:51], v[104:107]
v_exp_f32 v43, v43
v_mfma_f32_16x16x32_bf16 v[108:111], a[236:239], v[48:51], v[108:111]
s_waitcnt lgkmcnt(0)
v_cvt_pk_bf16_f32 v52, v40, v41
v_cvt_pk_bf16_f32 v53, v42, v43
v_mfma_f32_16x16x32_bf16 v[36:39], a[208:211], a[96:99], 0
v_exp_f32 v44, v44
v_mfma_f32_16x16x32_bf16 v[36:39], a[212:215], a[100:103], v[36:39]
buffer_load_dwordx4 v3, s[8:11], s26 offen offset:1024 nt lds
v_mfma_f32_16x16x32_bf16 v[36:39], a[216:219], a[104:107], v[36:39]
v_exp_f32 v45, v45
v_mfma_f32_16x16x32_bf16 v[36:39], a[220:223], a[108:111], v[36:39]
v_mul_f32 v56, s30, v56
v_mul_f32 v57, s30, v57
v_mfma_f32_16x16x32_bf16 v[112:115], a[240:243], v[48:51], v[112:115]
v_exp_f32 v46, v46
v_mfma_f32_16x16x32_bf16 v[116:119], a[244:247], v[48:51], v[116:119]
v_cvt_pk_bf16_f32 v224, v56, v57
v_lshlrev_b32 v58, 16, v225
v_mfma_f32_16x16x32_bf16 v[120:123], a[248:251], v[48:51], v[120:123]
v_exp_f32 v47, v47
v_mfma_f32_16x16x32_bf16 v[124:127], a[252:255], v[48:51], v[124:127]
v_cvt_pk_bf16_f32 v54, v44, v45
v_cvt_pk_bf16_f32 v55, v46, v47
v_mfma_f32_16x16x32_bf16 v[40:43], a[192:195], a[112:115], 0
s_add_u32 m0, s22, 0
v_exp_f32 v32, v32
v_mfma_f32_16x16x32_bf16 v[40:43], a[196:199], a[116:119], v[40:43]
v_exp_f32 v33, v33
v_mfma_f32_16x16x32_bf16 v[40:43], a[200:203], a[120:123], v[40:43]
v_exp_f32 v34, v34
v_mfma_f32_16x16x32_bf16 v[40:43], a[204:207], a[124:127], v[40:43]
v_exp_f32 v35, v35
v_smfmac_f32_16x16x64_bf16 v[20:23], v[24:27], v[48:55], v28
v_exp_f32 v36, v36
v_mfma_f32_16x16x32_bf16 v[128:131], a[224:227], v[52:55], v[128:131]
ds_read_b64_tr_b16 a[224:225], v2 offset:33792
ds_read_b64_tr_b16 a[226:227], v2 offset:34048
v_mfma_f32_16x16x32_bf16 v[132:135], a[228:231], v[52:55], v[132:135]
v_cvt_pk_bf16_f32 v48, v32, v33
v_cvt_pk_bf16_f32 v49, v34, v35
v_mfma_f32_16x16x32_bf16 v[136:139], a[232:235], v[52:55], v[136:139]
ds_read_b64_tr_b16 a[228:229], v2 offset:33800
ds_read_b64_tr_b16 a[230:231], v2 offset:34056
v_mfma_f32_16x16x32_bf16 v[140:143], a[236:239], v[52:55], v[140:143]
v_exp_f32 v37, v37
v_mfma_f32_16x16x32_bf16 v[44:47], a[208:211], a[112:115], 0
ds_read_b64_tr_b16 a[232:233], v2 offset:33856
ds_read_b64_tr_b16 a[234:235], v2 offset:34112
v_mfma_f32_16x16x32_bf16 v[44:47], a[212:215], a[116:119], v[44:47]
v_exp_f32 v38, v38
v_mfma_f32_16x16x32_bf16 v[44:47], a[216:219], a[120:123], v[44:47]
ds_read_b64_tr_b16 a[236:237], v2 offset:33864
ds_read_b64_tr_b16 a[238:239], v2 offset:34120
v_mfma_f32_16x16x32_bf16 v[44:47], a[220:223], a[124:127], v[44:47]
v_exp_f32 v39, v39
v_mfma_f32_16x16x32_bf16 v[144:147], a[240:243], v[52:55], v[144:147]
ds_read_b64_tr_b16 a[240:241], v2 offset:33920
ds_read_b64_tr_b16 a[242:243], v2 offset:34176
v_mfma_f32_16x16x32_bf16 v[148:151], a[244:247], v[52:55], v[148:151]
buffer_load_dwordx4 v4, s[12:15], s26 offen offset:0 nt lds
v_mfma_f32_16x16x32_bf16 v[152:155], a[248:251], v[52:55], v[152:155]
s_sub_u32 m0, m0, 1016
ds_read_b64_tr_b16 a[244:245], v2 offset:33928
ds_read_b64_tr_b16 a[246:247], v2 offset:34184
ds_read_b64_tr_b16 a[248:249], v2 offset:33984
v_mfma_f32_16x16x32_bf16 v[156:159], a[252:255], v[52:55], v[156:159]
ds_read_b64_tr_b16 a[250:251], v2 offset:34240
ds_read_b64_tr_b16 a[252:253], v2 offset:33992
ds_read_b64_tr_b16 a[254:255], v2 offset:34248
buffer_load_dwordx4 v4, s[12:15], s26 offen offset:2048 nt lds
v_cvt_pk_bf16_f32 v50, v36, v37
v_cvt_pk_bf16_f32 v51, v38, v39
s_add_u32 s26, s26, 8192
s_cmp_eq_u32 s23, 3
s_cbranch_scc1 Llast
v_mfma_f32_16x16x32_bf16 v[32:35], a[192:195], a[128:131], 0
s_add_u32 m0, s51, 3968
v_exp_f32 v40, v40
v_mfma_f32_16x16x32_bf16 v[32:35], a[196:199], a[132:135], v[32:35]
buffer_load_dwordx4 v5, s[4:7], s28 offen offset:128 nt lds
v_mfma_f32_16x16x32_bf16 v[32:35], a[200:203], a[136:139], v[32:35]
v_exp_f32 v41, v41
v_mfma_f32_16x16x32_bf16 v[32:35], a[204:207], a[140:143], v[32:35]
s_waitcnt lgkmcnt(8)
v_and_b32 v59, s32, v225
v_mul_f32 v58, s30, v58
v_mfma_f32_16x16x32_bf16 a[0:3], a[224:227], v[48:51], a[0:3]
v_exp_f32 v42, v42
v_mfma_f32_16x16x32_bf16 a[4:7], a[228:231], v[48:51], a[4:7]
buffer_load_dwordx4 v5, s[4:7], s28 offen offset:2176 nt lds
v_mfma_f32_16x16x32_bf16 a[8:11], a[232:235], v[48:51], a[8:11]
v_exp_f32 v43, v43
v_mfma_f32_16x16x32_bf16 a[12:15], a[236:239], v[48:51], a[12:15]
v_cvt_pk_bf16_f32 v52, v40, v41
v_cvt_pk_bf16_f32 v53, v42, v43
v_mfma_f32_16x16x32_bf16 v[36:39], a[208:211], a[128:131], 0
v_exp_f32 v44, v44
v_mfma_f32_16x16x32_bf16 v[36:39], a[212:215], a[132:135], v[36:39]
v_mul_f32 v59, s30, v59
v_cvt_pk_bf16_f32 v225, v58, v59
v_mfma_f32_16x16x32_bf16 v[36:39], a[216:219], a[136:139], v[36:39]
v_exp_f32 v45, v45
v_mfma_f32_16x16x32_bf16 v[36:39], a[220:223], a[140:143], v[36:39]
s_waitcnt lgkmcnt(0)
v_lshlrev_b32 v56, 16, v226
v_and_b32 v57, s32, v226
v_mfma_f32_16x16x32_bf16 a[16:19], a[240:243], v[48:51], a[16:19]
v_exp_f32 v46, v46
v_mfma_f32_16x16x32_bf16 a[20:23], a[244:247], v[48:51], a[20:23]
v_mul_f32 v56, s30, v56
v_mul_f32 v57, s30, v57
v_mfma_f32_16x16x32_bf16 a[24:27], a[248:251], v[48:51], a[24:27]
v_exp_f32 v47, v47
v_mfma_f32_16x16x32_bf16 a[28:31], a[252:255], v[48:51], a[28:31]
v_cvt_pk_bf16_f32 v54, v44, v45
v_cvt_pk_bf16_f32 v55, v46, v47
v_mfma_f32_16x16x32_bf16 v[40:43], a[192:195], a[144:147], 0
v_exp_f32 v32, v32
v_mfma_f32_16x16x32_bf16 v[40:43], a[196:199], a[148:151], v[40:43]
v_cvt_pk_bf16_f32 v226, v56, v57
v_lshlrev_b32 v58, 16, v227
v_mfma_f32_16x16x32_bf16 v[40:43], a[200:203], a[152:155], v[40:43]
v_exp_f32 v33, v33
v_mfma_f32_16x16x32_bf16 v[40:43], a[204:207], a[156:159], v[40:43]
v_and_b32 v59, s32, v227
v_mul_f32 v58, s30, v58
v_smfmac_f32_16x16x64_bf16 v[12:15], v[24:27], v[48:55], v28
v_mul_f32 v59, s30, v59
v_cvt_pk_bf16_f32 v227, v58, v59
v_mfma_f32_16x16x32_bf16 a[32:35], a[224:227], v[52:55], a[32:35]
v_exp_f32 v34, v34
v_mfma_f32_16x16x32_bf16 a[36:39], a[228:231], v[52:55], a[36:39]
v_lshlrev_b32 v56, 16, v228
v_and_b32 v57, s32, v228
v_mfma_f32_16x16x32_bf16 a[40:43], a[232:235], v[52:55], a[40:43]
v_exp_f32 v35, v35
v_mfma_f32_16x16x32_bf16 a[44:47], a[236:239], v[52:55], a[44:47]
v_cvt_pk_bf16_f32 v48, v32, v33
v_cvt_pk_bf16_f32 v49, v34, v35
v_mfma_f32_16x16x32_bf16 v[44:47], a[208:211], a[144:147], 0
v_exp_f32 v36, v36
v_mfma_f32_16x16x32_bf16 v[44:47], a[212:215], a[148:151], v[44:47]
v_mul_f32 v56, s30, v56
v_mul_f32 v57, s30, v57
v_mfma_f32_16x16x32_bf16 v[44:47], a[216:219], a[152:155], v[44:47]
v_exp_f32 v37, v37
v_mfma_f32_16x16x32_bf16 v[44:47], a[220:223], a[156:159], v[44:47]
v_cvt_pk_bf16_f32 v228, v56, v57
v_lshlrev_b32 v58, 16, v229
v_mfma_f32_16x16x32_bf16 a[48:51], a[240:243], v[52:55], a[48:51]
v_exp_f32 v38, v38
v_mfma_f32_16x16x32_bf16 a[52:55], a[244:247], v[52:55], a[52:55]
v_and_b32 v59, s32, v229
v_mul_f32 v58, s30, v58
v_mfma_f32_16x16x32_bf16 a[56:59], a[248:251], v[52:55], a[56:59]
s_waitcnt vmcnt(18)
v_exp_f32 v39, v39
v_mfma_f32_16x16x32_bf16 a[60:63], a[252:255], v[52:55], a[60:63]
s_barrier
v_cvt_pk_bf16_f32 v50, v36, v37
v_cvt_pk_bf16_f32 v51, v38, v39
v_mfma_f32_16x16x32_bf16 v[32:35], a[192:195], a[160:163], 0
v_exp_f32 v40, v40
v_mfma_f32_16x16x32_bf16 v[32:35], a[196:199], a[164:167], v[32:35]
v_mul_f32 v59, s30, v59
v_cvt_pk_bf16_f32 v229, v58, v59
v_mfma_f32_16x16x32_bf16 v[32:35], a[200:203], a[168:171], v[32:35]
v_exp_f32 v41, v41
v_mfma_f32_16x16x32_bf16 v[32:35], a[204:207], a[172:175], v[32:35]
v_lshlrev_b32 v56, 16, v230
v_and_b32 v57, s32, v230
v_mfma_f32_16x16x32_bf16 a[64:67], a[224:227], v[48:51], a[64:67]
v_exp_f32 v42, v42
v_mfma_f32_16x16x32_bf16 a[68:71], a[228:231], v[48:51], a[68:71]
v_mul_f32 v56, s30, v56
v_mul_f32 v57, s30, v57
v_mfma_f32_16x16x32_bf16 a[72:75], a[232:235], v[48:51], a[72:75]
v_exp_f32 v43, v43
v_mfma_f32_16x16x32_bf16 a[76:79], a[236:239], v[48:51], a[76:79]
v_cvt_pk_bf16_f32 v52, v40, v41
v_cvt_pk_bf16_f32 v53, v42, v43
v_mfma_f32_16x16x32_bf16 v[36:39], a[208:211], a[160:163], 0
v_exp_f32 v44, v44
v_mfma_f32_16x16x32_bf16 v[36:39], a[212:215], a[164:167], v[36:39]
v_cvt_pk_bf16_f32 v230, v56, v57
v_lshlrev_b32 v58, 16, v231
v_mfma_f32_16x16x32_bf16 v[36:39], a[216:219], a[168:171], v[36:39]
v_exp_f32 v45, v45
v_mfma_f32_16x16x32_bf16 v[36:39], a[220:223], a[172:175], v[36:39]
v_and_b32 v59, s32, v231
v_mul_f32 v58, s30, v58
v_mfma_f32_16x16x32_bf16 a[80:83], a[240:243], v[48:51], a[80:83]
v_exp_f32 v46, v46
v_mfma_f32_16x16x32_bf16 a[84:87], a[244:247], v[48:51], a[84:87]
v_mul_f32 v59, s30, v59
v_cvt_pk_bf16_f32 v231, v58, v59
v_mfma_f32_16x16x32_bf16 a[88:91], a[248:251], v[48:51], a[88:91]
v_exp_f32 v47, v47
v_mfma_f32_16x16x32_bf16 a[92:95], a[252:255], v[48:51], a[92:95]
v_cvt_pk_bf16_f32 v54, v44, v45
v_cvt_pk_bf16_f32 v55, v46, v47
v_mfma_f32_16x16x32_bf16 v[40:43], a[192:195], a[176:179], 0
s_add_u32 m0, s21, 8448
v_exp_f32 v32, v32
v_mfma_f32_16x16x32_bf16 v[40:43], a[196:199], a[180:183], v[40:43]
ds_read_b128 a[192:195], v1 offset:42240
ds_read_b128 a[196:199], v1 offset:42304
v_mfma_f32_16x16x32_bf16 v[40:43], a[200:203], a[184:187], v[40:43]
v_exp_f32 v33, v33
v_mfma_f32_16x16x32_bf16 v[40:43], a[204:207], a[188:191], v[40:43]
ds_read_b128 a[200:203], v1 offset:42368
ds_read_b128 a[204:207], v1 offset:42432
v_smfmac_f32_16x16x64_bf16 v[16:19], v[24:27], v[48:55], v28
buffer_load_dwordx4 v3, s[8:11], s26 offen offset:0 nt lds
v_mfma_f32_16x16x32_bf16 v[64:67], a[224:227], v[52:55], v[64:67]
v_exp_f32 v34, v34
v_mfma_f32_16x16x32_bf16 v[68:71], a[228:231], v[52:55], v[68:71]
v_mfma_f32_16x16x32_bf16 v[72:75], a[232:235], v[52:55], v[72:75]
v_exp_f32 v35, v35
v_mfma_f32_16x16x32_bf16 v[76:79], a[236:239], v[52:55], v[76:79]
v_cvt_pk_bf16_f32 v48, v32, v33
v_cvt_pk_bf16_f32 v49, v34, v35
v_mfma_f32_16x16x32_bf16 v[44:47], a[208:211], a[176:179], 0
v_exp_f32 v36, v36
v_mfma_f32_16x16x32_bf16 v[44:47], a[212:215], a[180:183], v[44:47]
ds_read_b128 a[208:211], v1 offset:43264
ds_read_b128 a[212:215], v1 offset:43328
v_mfma_f32_16x16x32_bf16 v[44:47], a[216:219], a[184:187], v[44:47]
v_exp_f32 v37, v37
v_mfma_f32_16x16x32_bf16 v[44:47], a[220:223], a[188:191], v[44:47]
ds_read_b128 a[216:219], v1 offset:43392
ds_read_b128 a[220:223], v1 offset:43456
v_mfma_f32_16x16x32_bf16 v[80:83], a[240:243], v[52:55], v[80:83]
v_exp_f32 v38, v38
v_mfma_f32_16x16x32_bf16 v[84:87], a[244:247], v[52:55], v[84:87]
buffer_load_dwordx4 v3, s[8:11], s26 offen offset:1024 nt lds
v_mfma_f32_16x16x32_bf16 v[88:91], a[248:251], v[52:55], v[88:91]
v_exp_f32 v39, v39
v_mfma_f32_16x16x32_bf16 v[92:95], a[252:255], v[52:55], v[92:95]
s_waitcnt lgkmcnt(4)
v_cvt_pk_bf16_f32 v50, v36, v37
v_cvt_pk_bf16_f32 v51, v38, v39
v_mfma_f32_16x16x32_bf16 v[32:35], a[192:195], a[96:99], 0
s_add_u32 s50, s39, 20480
v_exp_f32 v40, v40
v_mfma_f32_16x16x32_bf16 v[32:35], a[196:199], a[100:103], v[32:35]
v_cndmask_b32_dpp v60, v240, v244, vcc row_ror:8 row_mask:0xf bank_mask:0xf
v_cndmask_b32_dpp v61, v241, v245, vcc row_ror:8 row_mask:0xf bank_mask:0xf
v_mfma_f32_16x16x32_bf16 v[32:35], a[200:203], a[104:107], v[32:35]
v_exp_f32 v41, v41
v_mfma_f32_16x16x32_bf16 v[32:35], a[204:207], a[108:111], v[32:35]
v_cndmask_b32_dpp v62, v242, v246, vcc row_ror:8 row_mask:0xf bank_mask:0xf
v_cndmask_b32_dpp v63, v243, v247, vcc row_ror:8 row_mask:0xf bank_mask:0xf
v_mfma_f32_16x16x32_bf16 v[96:99], a[224:227], v[48:51], v[96:99]
v_exp_f32 v42, v42
v_mfma_f32_16x16x32_bf16 v[100:103], a[228:231], v[48:51], v[100:103]
v_mov_b32_dpp v240, v244 row_ror:8 row_mask:0xf bank_mask:0xc
v_mov_b32_dpp v241, v245 row_ror:8 row_mask:0xf bank_mask:0xc
v_mfma_f32_16x16x32_bf16 v[104:107], a[232:235], v[48:51], v[104:107]
v_exp_f32 v43, v43
v_mfma_f32_16x16x32_bf16 v[108:111], a[236:239], v[48:51], v[108:111]
s_waitcnt lgkmcnt(0)
v_cvt_pk_bf16_f32 v52, v40, v41
v_cvt_pk_bf16_f32 v53, v42, v43
v_mfma_f32_16x16x32_bf16 v[36:39], a[208:211], a[96:99], 0
v_exp_f32 v44, v44
v_mfma_f32_16x16x32_bf16 v[36:39], a[212:215], a[100:103], v[36:39]
v_mov_b32_dpp v242, v246 row_ror:8 row_mask:0xf bank_mask:0xc
v_mov_b32_dpp v243, v247 row_ror:8 row_mask:0xf bank_mask:0xc
v_mfma_f32_16x16x32_bf16 v[36:39], a[216:219], a[104:107], v[36:39]
buffer_store_dwordx4 v[240:243], v6, s[16:19], s50 offen offset:0 nt
v_exp_f32 v45, v45
v_mfma_f32_16x16x32_bf16 v[36:39], a[220:223], a[108:111], v[36:39]
v_mfma_f32_16x16x32_bf16 v[112:115], a[240:243], v[48:51], v[112:115]
v_exp_f32 v46, v46
v_mfma_f32_16x16x32_bf16 v[116:119], a[244:247], v[48:51], v[116:119]
v_mfma_f32_16x16x32_bf16 v[120:123], a[248:251], v[48:51], v[120:123]
buffer_store_dwordx4 v[60:63], v6, s[16:19], s50 offen offset:2048 nt
v_exp_f32 v47, v47
v_mfma_f32_16x16x32_bf16 v[124:127], a[252:255], v[48:51], v[124:127]
v_cvt_pk_bf16_f32 v54, v44, v45
v_cvt_pk_bf16_f32 v55, v46, v47
v_mfma_f32_16x16x32_bf16 v[40:43], a[192:195], a[112:115], 0
s_waitcnt vmcnt(20)
v_exp_f32 v32, v32
v_mfma_f32_16x16x32_bf16 v[40:43], a[196:199], a[116:119], v[40:43]
v_exp_f32 v33, v33
v_mfma_f32_16x16x32_bf16 v[40:43], a[200:203], a[120:123], v[40:43]
v_exp_f32 v34, v34
v_mfma_f32_16x16x32_bf16 v[40:43], a[204:207], a[124:127], v[40:43]
v_exp_f32 v35, v35
v_smfmac_f32_16x16x64_bf16 v[20:23], v[24:27], v[48:55], v28
v_exp_f32 v36, v36
v_mfma_f32_16x16x32_bf16 v[128:131], a[224:227], v[52:55], v[128:131]
ds_read_b64_tr_b16 a[224:225], v2 offset:42240
ds_read_b64_tr_b16 a[226:227], v2 offset:42496
v_mfma_f32_16x16x32_bf16 v[132:135], a[228:231], v[52:55], v[132:135]
v_cvt_pk_bf16_f32 v48, v32, v33
v_cvt_pk_bf16_f32 v49, v34, v35
v_mfma_f32_16x16x32_bf16 v[136:139], a[232:235], v[52:55], v[136:139]
ds_read_b64_tr_b16 a[228:229], v2 offset:42248
ds_read_b64_tr_b16 a[230:231], v2 offset:42504
v_mfma_f32_16x16x32_bf16 v[140:143], a[236:239], v[52:55], v[140:143]
v_exp_f32 v37, v37
v_mfma_f32_16x16x32_bf16 v[44:47], a[208:211], a[112:115], 0
ds_read_b64_tr_b16 a[232:233], v2 offset:42304
ds_read_b64_tr_b16 a[234:235], v2 offset:42560
v_mfma_f32_16x16x32_bf16 v[44:47], a[212:215], a[116:119], v[44:47]
v_exp_f32 v38, v38
v_mfma_f32_16x16x32_bf16 v[44:47], a[216:219], a[120:123], v[44:47]
ds_read_b64_tr_b16 a[236:237], v2 offset:42312
ds_read_b64_tr_b16 a[238:239], v2 offset:42568
v_mfma_f32_16x16x32_bf16 v[44:47], a[220:223], a[124:127], v[44:47]
v_exp_f32 v39, v39
v_mfma_f32_16x16x32_bf16 v[144:147], a[240:243], v[52:55], v[144:147]
ds_read_b64_tr_b16 a[240:241], v2 offset:42368
ds_read_b64_tr_b16 a[242:243], v2 offset:42624
v_mfma_f32_16x16x32_bf16 v[148:151], a[244:247], v[52:55], v[148:151]
v_mfma_f32_16x16x32_bf16 v[152:155], a[248:251], v[52:55], v[152:155]
ds_read_b64_tr_b16 a[244:245], v2 offset:42376
ds_read_b64_tr_b16 a[246:247], v2 offset:42632
v_mfma_f32_16x16x32_bf16 v[156:159], a[252:255], v[52:55], v[156:159]
v_cvt_pk_bf16_f32 v50, v36, v37
v_cvt_pk_bf16_f32 v51, v38, v39
v_mfma_f32_16x16x32_bf16 v[32:35], a[192:195], a[128:131], 0
v_exp_f32 v40, v40
v_mfma_f32_16x16x32_bf16 v[32:35], a[196:199], a[132:135], v[32:35]
ds_read_b64_tr_b16 a[248:249], v2 offset:42432
ds_read_b64_tr_b16 a[250:251], v2 offset:42688
v_mfma_f32_16x16x32_bf16 v[32:35], a[200:203], a[136:139], v[32:35]
v_exp_f32 v41, v41
v_mfma_f32_16x16x32_bf16 v[32:35], a[204:207], a[140:143], v[32:35]
s_waitcnt lgkmcnt(6)
ds_read_b64_tr_b16 a[252:253], v2 offset:42440
ds_read_b64_tr_b16 a[254:255], v2 offset:42696
v_mfma_f32_16x16x32_bf16 a[0:3], a[224:227], v[48:51], a[0:3]
v_exp_f32 v42, v42
v_mfma_f32_16x16x32_bf16 a[4:7], a[228:231], v[48:51], a[4:7]
ds_read_b128 v[232:235], v8 offset:0
ds_read_b128 v[236:239], v8 offset:64
v_mfma_f32_16x16x32_bf16 a[8:11], a[232:235], v[48:51], a[8:11]
v_exp_f32 v43, v43
v_mfma_f32_16x16x32_bf16 a[12:15], a[236:239], v[48:51], a[12:15]
v_cvt_pk_bf16_f32 v52, v40, v41
v_cvt_pk_bf16_f32 v53, v42, v43
v_mfma_f32_16x16x32_bf16 v[36:39], a[208:211], a[128:131], 0
v_exp_f32 v44, v44
v_mfma_f32_16x16x32_bf16 v[36:39], a[212:215], a[132:135], v[36:39]
v_mfma_f32_16x16x32_bf16 v[36:39], a[216:219], a[136:139], v[36:39]
v_exp_f32 v45, v45
v_mfma_f32_16x16x32_bf16 v[36:39], a[220:223], a[140:143], v[36:39]
s_waitcnt lgkmcnt(2)
v_mfma_f32_16x16x32_bf16 a[16:19], a[240:243], v[48:51], a[16:19]
v_exp_f32 v46, v46
v_mfma_f32_16x16x32_bf16 a[20:23], a[244:247], v[48:51], a[20:23]
s_waitcnt lgkmcnt(0)
v_mfma_f32_16x16x32_bf16 a[24:27], a[248:251], v[48:51], a[24:27]
v_exp_f32 v47, v47
v_mfma_f32_16x16x32_bf16 a[28:31], a[252:255], v[48:51], a[28:31]
v_cvt_pk_bf16_f32 v54, v44, v45
v_cvt_pk_bf16_f32 v55, v46, v47
v_mfma_f32_16x16x32_bf16 v[40:43], a[192:195], a[144:147], 0
s_add_u32 m0, s22, 8448
v_exp_f32 v32, v32
v_mfma_f32_16x16x32_bf16 v[40:43], a[196:199], a[148:151], v[40:43]
buffer_load_dwordx4 v4, s[12:15], s26 offen offset:0 nt lds
v_mfma_f32_16x16x32_bf16 v[40:43], a[200:203], a[152:155], v[40:43]
s_sub_u32 m0, m0, 1016
v_exp_f32 v33, v33
v_mfma_f32_16x16x32_bf16 v[40:43], a[204:207], a[156:159], v[40:43]
buffer_load_dwordx4 v4, s[12:15], s26 offen offset:2048 nt lds
v_smfmac_f32_16x16x64_bf16 v[12:15], v[24:27], v[48:55], v28
s_add_u32 s26, s26, 8192
v_lshlrev_b32 v56, 16, v232
v_and_b32 v57, s32, v232
v_mfma_f32_16x16x32_bf16 a[32:35], a[224:227], v[52:55], a[32:35]
v_exp_f32 v34, v34
v_mfma_f32_16x16x32_bf16 a[36:39], a[228:231], v[52:55], a[36:39]
v_mul_f32 v56, s30, v56
v_mul_f32 v57, s30, v57
v_mfma_f32_16x16x32_bf16 a[40:43], a[232:235], v[52:55], a[40:43]
v_exp_f32 v35, v35
v_mfma_f32_16x16x32_bf16 a[44:47], a[236:239], v[52:55], a[44:47]
v_cvt_pk_bf16_f32 v48, v32, v33
v_cvt_pk_bf16_f32 v49, v34, v35
v_mfma_f32_16x16x32_bf16 v[44:47], a[208:211], a[144:147], 0
v_exp_f32 v36, v36
v_mfma_f32_16x16x32_bf16 v[44:47], a[212:215], a[148:151], v[44:47]
v_cvt_pk_bf16_f32 v232, v56, v57
v_lshlrev_b32 v58, 16, v233
v_mfma_f32_16x16x32_bf16 v[44:47], a[216:219], a[152:155], v[44:47]
v_exp_f32 v37, v37
v_mfma_f32_16x16x32_bf16 v[44:47], a[220:223], a[156:159], v[44:47]
v_and_b32 v59, s32, v233
v_mul_f32 v58, s30, v58
v_mfma_f32_16x16x32_bf16 a[48:51], a[240:243], v[52:55], a[48:51]
v_exp_f32 v38, v38
v_mfma_f32_16x16x32_bf16 a[52:55], a[244:247], v[52:55], a[52:55]
v_mul_f32 v59, s30, v59
v_cvt_pk_bf16_f32 v233, v58, v59
v_mfma_f32_16x16x32_bf16 a[56:59], a[248:251], v[52:55], a[56:59]
v_exp_f32 v39, v39
v_mfma_f32_16x16x32_bf16 a[60:63], a[252:255], v[52:55], a[60:63]
v_cvt_pk_bf16_f32 v50, v36, v37
v_cvt_pk_bf16_f32 v51, v38, v39
v_mfma_f32_16x16x32_bf16 v[32:35], a[192:195], a[160:163], 0
s_add_u32 m0, s21, 16896
v_exp_f32 v40, v40
v_mfma_f32_16x16x32_bf16 v[32:35], a[196:199], a[164:167], v[32:35]
buffer_load_dwordx4 v3, s[8:11], s26 offen offset:0 nt lds
v_mfma_f32_16x16x32_bf16 v[32:35], a[200:203], a[168:171], v[32:35]
v_exp_f32 v41, v41
v_mfma_f32_16x16x32_bf16 v[32:35], a[204:207], a[172:175], v[32:35]
v_lshlrev_b32 v56, 16, v234
v_and_b32 v57, s32, v234
v_mfma_f32_16x16x32_bf16 a[64:67], a[224:227], v[48:51], a[64:67]
v_exp_f32 v42, v42
v_mfma_f32_16x16x32_bf16 a[68:71], a[228:231], v[48:51], a[68:71]
buffer_load_dwordx4 v3, s[8:11], s26 offen offset:1024 nt lds
v_mfma_f32_16x16x32_bf16 a[72:75], a[232:235], v[48:51], a[72:75]
v_exp_f32 v43, v43
v_mfma_f32_16x16x32_bf16 a[76:79], a[236:239], v[48:51], a[76:79]
v_cvt_pk_bf16_f32 v52, v40, v41
v_cvt_pk_bf16_f32 v53, v42, v43
v_mfma_f32_16x16x32_bf16 v[36:39], a[208:211], a[160:163], 0
v_exp_f32 v44, v44
v_mfma_f32_16x16x32_bf16 v[36:39], a[212:215], a[164:167], v[36:39]
v_mul_f32 v56, s30, v56
v_mul_f32 v57, s30, v57
v_mfma_f32_16x16x32_bf16 v[36:39], a[216:219], a[168:171], v[36:39]
v_exp_f32 v45, v45
v_mfma_f32_16x16x32_bf16 v[36:39], a[220:223], a[172:175], v[36:39]
v_cvt_pk_bf16_f32 v234, v56, v57
v_lshlrev_b32 v58, 16, v235
v_mfma_f32_16x16x32_bf16 a[80:83], a[240:243], v[48:51], a[80:83]
v_exp_f32 v46, v46
v_mfma_f32_16x16x32_bf16 a[84:87], a[244:247], v[48:51], a[84:87]
v_and_b32 v59, s32, v235
v_mul_f32 v58, s30, v58
v_mfma_f32_16x16x32_bf16 a[88:91], a[248:251], v[48:51], a[88:91]
v_exp_f32 v47, v47
v_mfma_f32_16x16x32_bf16 a[92:95], a[252:255], v[48:51], a[92:95]
v_cvt_pk_bf16_f32 v54, v44, v45
v_cvt_pk_bf16_f32 v55, v46, v47
v_mfma_f32_16x16x32_bf16 v[40:43], a[192:195], a[176:179], 0
v_exp_f32 v32, v32
v_mfma_f32_16x16x32_bf16 v[40:43], a[196:199], a[180:183], v[40:43]
ds_read_b128 a[192:195], v1 offset:50688
ds_read_b128 a[196:199], v1 offset:50752
v_mfma_f32_16x16x32_bf16 v[40:43], a[200:203], a[184:187], v[40:43]
v_exp_f32 v33, v33
v_mfma_f32_16x16x32_bf16 v[40:43], a[204:207], a[188:191], v[40:43]
ds_read_b128 a[200:203], v1 offset:50816
ds_read_b128 a[204:207], v1 offset:50880
v_smfmac_f32_16x16x64_bf16 v[16:19], v[24:27], v[48:55], v28
v_mul_f32 v59, s30, v59
v_cvt_pk_bf16_f32 v235, v58, v59
v_mfma_f32_16x16x32_bf16 v[64:67], a[224:227], v[52:55], v[64:67]
v_exp_f32 v34, v34
v_mfma_f32_16x16x32_bf16 v[68:71], a[228:231], v[52:55], v[68:71]
v_lshlrev_b32 v56, 16, v236
v_and_b32 v57, s32, v236
v_mfma_f32_16x16x32_bf16 v[72:75], a[232:235], v[52:55], v[72:75]
v_exp_f32 v35, v35
v_mfma_f32_16x16x32_bf16 v[76:79], a[236:239], v[52:55], v[76:79]
v_cvt_pk_bf16_f32 v48, v32, v33
v_cvt_pk_bf16_f32 v49, v34, v35
v_mfma_f32_16x16x32_bf16 v[44:47], a[208:211], a[176:179], 0
v_exp_f32 v36, v36
v_mfma_f32_16x16x32_bf16 v[44:47], a[212:215], a[180:183], v[44:47]
ds_read_b128 a[208:211], v1 offset:51712
ds_read_b128 a[212:215], v1 offset:51776
v_mfma_f32_16x16x32_bf16 v[44:47], a[216:219], a[184:187], v[44:47]
v_exp_f32 v37, v37
v_mfma_f32_16x16x32_bf16 v[44:47], a[220:223], a[188:191], v[44:47]
ds_read_b128 a[216:219], v1 offset:51840
ds_read_b128 a[220:223], v1 offset:51904
v_mfma_f32_16x16x32_bf16 v[80:83], a[240:243], v[52:55], v[80:83]
v_exp_f32 v38, v38
v_mfma_f32_16x16x32_bf16 v[84:87], a[244:247], v[52:55], v[84:87]
v_mul_f32 v56, s30, v56
v_mul_f32 v57, s30, v57
v_mfma_f32_16x16x32_bf16 v[88:91], a[248:251], v[52:55], v[88:91]
v_exp_f32 v39, v39
v_mfma_f32_16x16x32_bf16 v[92:95], a[252:255], v[52:55], v[92:95]
s_waitcnt lgkmcnt(4)
v_cvt_pk_bf16_f32 v50, v36, v37
v_cvt_pk_bf16_f32 v51, v38, v39
v_mfma_f32_16x16x32_bf16 v[32:35], a[192:195], a[96:99], 0
s_add_u32 m0, s22, 16896
v_exp_f32 v40, v40
v_mfma_f32_16x16x32_bf16 v[32:35], a[196:199], a[100:103], v[32:35]
buffer_load_dwordx4 v4, s[12:15], s26 offen offset:0 nt lds
v_mfma_f32_16x16x32_bf16 v[32:35], a[200:203], a[104:107], v[32:35]
s_sub_u32 m0, m0, 1016
v_exp_f32 v41, v41
v_mfma_f32_16x16x32_bf16 v[32:35], a[204:207], a[108:111], v[32:35]
buffer_load_dwordx4 v4, s[12:15], s26 offen offset:2048 nt lds
v_mfma_f32_16x16x32_bf16 v[96:99], a[224:227], v[48:51], v[96:99]
s_add_u32 s26, s26, 8192
v_exp_f32 v42, v42
v_mfma_f32_16x16x32_bf16 v[100:103], a[228:231], v[48:51], v[100:103]
v_cvt_pk_bf16_f32 v236, v56, v57
v_lshlrev_b32 v58, 16, v237
v_mfma_f32_16x16x32_bf16 v[104:107], a[232:235], v[48:51], v[104:107]
v_exp_f32 v43, v43
v_mfma_f32_16x16x32_bf16 v[108:111], a[236:239], v[48:51], v[108:111]
s_waitcnt lgkmcnt(0)
v_cvt_pk_bf16_f32 v52, v40, v41
v_cvt_pk_bf16_f32 v53, v42, v43
v_mfma_f32_16x16x32_bf16 v[36:39], a[208:211], a[96:99], 0
v_exp_f32 v44, v44
v_mfma_f32_16x16x32_bf16 v[36:39], a[212:215], a[100:103], v[36:39]
v_and_b32 v59, s32, v237
v_mul_f32 v58, s30, v58
v_mfma_f32_16x16x32_bf16 v[36:39], a[216:219], a[104:107], v[36:39]
v_exp_f32 v45, v45
v_mfma_f32_16x16x32_bf16 v[36:39], a[220:223], a[108:111], v[36:39]
v_mul_f32 v59, s30, v59
v_cvt_pk_bf16_f32 v237, v58, v59
v_mfma_f32_16x16x32_bf16 v[112:115], a[240:243], v[48:51], v[112:115]
v_exp_f32 v46, v46
v_mfma_f32_16x16x32_bf16 v[116:119], a[244:247], v[48:51], v[116:119]
v_lshlrev_b32 v56, 16, v238
v_and_b32 v57, s32, v238
v_mfma_f32_16x16x32_bf16 v[120:123], a[248:251], v[48:51], v[120:123]
v_exp_f32 v47, v47
v_mfma_f32_16x16x32_bf16 v[124:127], a[252:255], v[48:51], v[124:127]
v_cvt_pk_bf16_f32 v54, v44, v45
v_cvt_pk_bf16_f32 v55, v46, v47
v_mfma_f32_16x16x32_bf16 v[40:43], a[192:195], a[112:115], 0
s_add_u32 m0, s21, 25344
v_exp_f32 v32, v32
v_mfma_f32_16x16x32_bf16 v[40:43], a[196:199], a[116:119], v[40:43]
v_exp_f32 v33, v33
v_mfma_f32_16x16x32_bf16 v[40:43], a[200:203], a[120:123], v[40:43]
v_exp_f32 v34, v34
v_mfma_f32_16x16x32_bf16 v[40:43], a[204:207], a[124:127], v[40:43]
v_exp_f32 v35, v35
v_smfmac_f32_16x16x64_bf16 v[20:23], v[24:27], v[48:55], v28
v_exp_f32 v36, v36
v_mfma_f32_16x16x32_bf16 v[128:131], a[224:227], v[52:55], v[128:131]
ds_read_b64_tr_b16 a[224:225], v2 offset:50688
ds_read_b64_tr_b16 a[226:227], v2 offset:50944
v_mfma_f32_16x16x32_bf16 v[132:135], a[228:231], v[52:55], v[132:135]
v_cvt_pk_bf16_f32 v48, v32, v33
v_cvt_pk_bf16_f32 v49, v34, v35
v_mfma_f32_16x16x32_bf16 v[136:139], a[232:235], v[52:55], v[136:139]
ds_read_b64_tr_b16 a[228:229], v2 offset:50696
ds_read_b64_tr_b16 a[230:231], v2 offset:50952
v_mfma_f32_16x16x32_bf16 v[140:143], a[236:239], v[52:55], v[140:143]
v_exp_f32 v37, v37
v_mfma_f32_16x16x32_bf16 v[44:47], a[208:211], a[112:115], 0
ds_read_b64_tr_b16 a[232:233], v2 offset:50752
ds_read_b64_tr_b16 a[234:235], v2 offset:51008
v_mfma_f32_16x16x32_bf16 v[44:47], a[212:215], a[116:119], v[44:47]
v_exp_f32 v38, v38
v_mfma_f32_16x16x32_bf16 v[44:47], a[216:219], a[120:123], v[44:47]
ds_read_b64_tr_b16 a[236:237], v2 offset:50760
ds_read_b64_tr_b16 a[238:239], v2 offset:51016
v_mfma_f32_16x16x32_bf16 v[44:47], a[220:223], a[124:127], v[44:47]
v_exp_f32 v39, v39
v_mfma_f32_16x16x32_bf16 v[144:147], a[240:243], v[52:55], v[144:147]
ds_read_b64_tr_b16 a[240:241], v2 offset:50816
ds_read_b64_tr_b16 a[242:243], v2 offset:51072
v_mfma_f32_16x16x32_bf16 v[148:151], a[244:247], v[52:55], v[148:151]
buffer_load_dwordx4 v3, s[8:11], s26 offen offset:0 nt lds
v_mfma_f32_16x16x32_bf16 v[152:155], a[248:251], v[52:55], v[152:155]
ds_read_b64_tr_b16 a[244:245], v2 offset:50824
ds_read_b64_tr_b16 a[246:247], v2 offset:51080
v_mfma_f32_16x16x32_bf16 v[156:159], a[252:255], v[52:55], v[156:159]
v_cvt_pk_bf16_f32 v50, v36, v37
v_cvt_pk_bf16_f32 v51, v38, v39
v_mfma_f32_16x16x32_bf16 v[32:35], a[192:195], a[128:131], 0
s_waitcnt vmcnt(21)
v_exp_f32 v40, v40
v_mfma_f32_16x16x32_bf16 v[32:35], a[196:199], a[132:135], v[32:35]
s_add_u32 s50, s39, 20480
ds_read_b64_tr_b16 a[248:249], v2 offset:50880
ds_read_b64_tr_b16 a[250:251], v2 offset:51136
v_mfma_f32_16x16x32_bf16 v[32:35], a[200:203], a[136:139], v[32:35]
v_exp_f32 v41, v41
v_mfma_f32_16x16x32_bf16 v[32:35], a[204:207], a[140:143], v[32:35]
s_waitcnt lgkmcnt(6)
ds_read_b64_tr_b16 a[252:253], v2 offset:50888
ds_read_b64_tr_b16 a[254:255], v2 offset:51144
v_mfma_f32_16x16x32_bf16 a[0:3], a[224:227], v[48:51], a[0:3]
v_exp_f32 v42, v42
v_mfma_f32_16x16x32_bf16 a[4:7], a[228:231], v[48:51], a[4:7]
ds_read_b128 v[240:243], v8 offset:1024
ds_read_b128 v[244:247], v8 offset:1088
v_mfma_f32_16x16x32_bf16 a[8:11], a[232:235], v[48:51], a[8:11]
v_exp_f32 v43, v43
v_mfma_f32_16x16x32_bf16 a[12:15], a[236:239], v[48:51], a[12:15]
v_cvt_pk_bf16_f32 v52, v40, v41
v_cvt_pk_bf16_f32 v53, v42, v43
v_mfma_f32_16x16x32_bf16 v[36:39], a[208:211], a[128:131], 0
v_exp_f32 v44, v44
v_mfma_f32_16x16x32_bf16 v[36:39], a[212:215], a[132:135], v[36:39]
buffer_load_dwordx4 v3, s[8:11], s26 offen offset:1024 nt lds
v_mfma_f32_16x16x32_bf16 v[36:39], a[216:219], a[136:139], v[36:39]
v_exp_f32 v45, v45
v_mfma_f32_16x16x32_bf16 v[36:39], a[220:223], a[140:143], v[36:39]
s_waitcnt lgkmcnt(2)
v_cndmask_b32_dpp v60, v248, v252, vcc row_ror:8 row_mask:0xf bank_mask:0xf
v_cndmask_b32_dpp v61, v249, v253, vcc row_ror:8 row_mask:0xf bank_mask:0xf
v_mfma_f32_16x16x32_bf16 a[16:19], a[240:243], v[48:51], a[16:19]
v_exp_f32 v46, v46
v_mfma_f32_16x16x32_bf16 a[20:23], a[244:247], v[48:51], a[20:23]
s_waitcnt lgkmcnt(0)
v_cndmask_b32_dpp v62, v250, v254, vcc row_ror:8 row_mask:0xf bank_mask:0xf
v_cndmask_b32_dpp v63, v251, v255, vcc row_ror:8 row_mask:0xf bank_mask:0xf
v_mfma_f32_16x16x32_bf16 a[24:27], a[248:251], v[48:51], a[24:27]
v_exp_f32 v47, v47
v_mfma_f32_16x16x32_bf16 a[28:31], a[252:255], v[48:51], a[28:31]
v_cvt_pk_bf16_f32 v54, v44, v45
v_cvt_pk_bf16_f32 v55, v46, v47
v_mfma_f32_16x16x32_bf16 v[40:43], a[192:195], a[144:147], 0
v_exp_f32 v32, v32
v_mfma_f32_16x16x32_bf16 v[40:43], a[196:199], a[148:151], v[40:43]
v_mov_b32_dpp v248, v252 row_ror:8 row_mask:0xf bank_mask:0xc
v_mov_b32_dpp v249, v253 row_ror:8 row_mask:0xf bank_mask:0xc
v_mfma_f32_16x16x32_bf16 v[40:43], a[200:203], a[152:155], v[40:43]
v_exp_f32 v33, v33
v_mfma_f32_16x16x32_bf16 v[40:43], a[204:207], a[156:159], v[40:43]
v_mov_b32_dpp v250, v254 row_ror:8 row_mask:0xf bank_mask:0xc
v_mov_b32_dpp v251, v255 row_ror:8 row_mask:0xf bank_mask:0xc
v_smfmac_f32_16x16x64_bf16 v[12:15], v[24:27], v[48:55], v28
v_mul_f32 v56, s30, v56
v_mul_f32 v57, s30, v57
v_mfma_f32_16x16x32_bf16 a[32:35], a[224:227], v[52:55], a[32:35]
buffer_store_dwordx4 v[248:251], v6, s[16:19], s50 offen offset:128 nt
v_exp_f32 v34, v34
v_cvt_pk_bf16_f32 v238, v56, v57
v_mfma_f32_16x16x32_bf16 a[36:39], a[228:231], v[52:55], a[36:39]
v_lshlrev_b32 v58, 16, v239
v_and_b32 v59, s32, v239
v_mfma_f32_16x16x32_bf16 a[40:43], a[232:235], v[52:55], a[40:43]
v_exp_f32 v35, v35
v_mfma_f32_16x16x32_bf16 a[44:47], a[236:239], v[52:55], a[44:47]
v_cvt_pk_bf16_f32 v48, v32, v33
v_cvt_pk_bf16_f32 v49, v34, v35
v_mfma_f32_16x16x32_bf16 v[44:47], a[208:211], a[144:147], 0
buffer_store_dwordx4 v[60:63], v6, s[16:19], s50 offen offset:2176 nt
v_exp_f32 v36, v36
v_mul_f32 v58, s30, v58
v_mfma_f32_16x16x32_bf16 v[44:47], a[212:215], a[148:151], v[44:47]
v_mul_f32 v59, s30, v59
v_cvt_pk_bf16_f32 v239, v58, v59
v_mfma_f32_16x16x32_bf16 v[44:47], a[216:219], a[152:155], v[44:47]
v_exp_f32 v37, v37
v_mfma_f32_16x16x32_bf16 v[44:47], a[220:223], a[156:159], v[44:47]
v_mfma_f32_16x16x32_bf16 a[48:51], a[240:243], v[52:55], a[48:51]
v_exp_f32 v38, v38
v_mfma_f32_16x16x32_bf16 a[52:55], a[244:247], v[52:55], a[52:55]
v_mfma_f32_16x16x32_bf16 a[56:59], a[248:251], v[52:55], a[56:59]
s_waitcnt vmcnt(16)
v_exp_f32 v39, v39
v_mfma_f32_16x16x32_bf16 a[60:63], a[252:255], v[52:55], a[60:63]
s_barrier
v_cvt_pk_bf16_f32 v50, v36, v37
v_cvt_pk_bf16_f32 v51, v38, v39
v_mfma_f32_16x16x32_bf16 v[32:35], a[192:195], a[160:163], 0
v_exp_f32 v40, v40
v_mfma_f32_16x16x32_bf16 v[32:35], a[196:199], a[164:167], v[32:35]
v_mfma_f32_16x16x32_bf16 v[32:35], a[200:203], a[168:171], v[32:35]
v_exp_f32 v41, v41
v_mfma_f32_16x16x32_bf16 v[32:35], a[204:207], a[172:175], v[32:35]
v_mfma_f32_16x16x32_bf16 a[64:67], a[224:227], v[48:51], a[64:67]
v_exp_f32 v42, v42
v_mfma_f32_16x16x32_bf16 a[68:71], a[228:231], v[48:51], a[68:71]
v_mfma_f32_16x16x32_bf16 a[72:75], a[232:235], v[48:51], a[72:75]
v_exp_f32 v43, v43
v_mfma_f32_16x16x32_bf16 a[76:79], a[236:239], v[48:51], a[76:79]
v_cvt_pk_bf16_f32 v52, v40, v41
v_cvt_pk_bf16_f32 v53, v42, v43
v_mfma_f32_16x16x32_bf16 v[36:39], a[208:211], a[160:163], 0
v_exp_f32 v44, v44
v_mfma_f32_16x16x32_bf16 v[36:39], a[212:215], a[164:167], v[36:39]
v_mfma_f32_16x16x32_bf16 v[36:39], a[216:219], a[168:171], v[36:39]
v_exp_f32 v45, v45
v_mfma_f32_16x16x32_bf16 v[36:39], a[220:223], a[172:175], v[36:39]
v_mfma_f32_16x16x32_bf16 a[80:83], a[240:243], v[48:51], a[80:83]
v_exp_f32 v46, v46
v_mfma_f32_16x16x32_bf16 a[84:87], a[244:247], v[48:51], a[84:87]
v_mfma_f32_16x16x32_bf16 a[88:91], a[248:251], v[48:51], a[88:91]
v_exp_f32 v47, v47
v_mfma_f32_16x16x32_bf16 a[92:95], a[252:255], v[48:51], a[92:95]
v_cvt_pk_bf16_f32 v54, v44, v45
v_cvt_pk_bf16_f32 v55, v46, v47
v_mfma_f32_16x16x32_bf16 v[40:43], a[192:195], a[176:179], 0
s_add_u32 m0, s22, 25344
v_exp_f32 v32, v32
v_mfma_f32_16x16x32_bf16 v[40:43], a[196:199], a[180:183], v[40:43]
ds_read_b128 a[192:195], v1 offset:59136
ds_read_b128 a[196:199], v1 offset:59200
v_mfma_f32_16x16x32_bf16 v[40:43], a[200:203], a[184:187], v[40:43]
v_exp_f32 v33, v33
v_mfma_f32_16x16x32_bf16 v[40:43], a[204:207], a[188:191], v[40:43]
ds_read_b128 a[200:203], v1 offset:59264
ds_read_b128 a[204:207], v1 offset:59328
v_smfmac_f32_16x16x64_bf16 v[16:19], v[24:27], v[48:55], v28
buffer_load_dwordx4 v4, s[12:15], s26 offen offset:0 nt lds
v_mfma_f32_16x16x32_bf16 v[64:67], a[224:227], v[52:55], v[64:67]
s_sub_u32 m0, m0, 1016
v_exp_f32 v34, v34
v_mfma_f32_16x16x32_bf16 v[68:71], a[228:231], v[52:55], v[68:71]
buffer_load_dwordx4 v4, s[12:15], s26 offen offset:2048 nt lds
v_mfma_f32_16x16x32_bf16 v[72:75], a[232:235], v[52:55], v[72:75]
s_add_u32 s26, s26, 8192
v_exp_f32 v35, v35
v_mfma_f32_16x16x32_bf16 v[76:79], a[236:239], v[52:55], v[76:79]
v_cvt_pk_bf16_f32 v48, v32, v33
v_cvt_pk_bf16_f32 v49, v34, v35
v_mfma_f32_16x16x32_bf16 v[44:47], a[208:211], a[176:179], 0
v_exp_f32 v36, v36
v_mfma_f32_16x16x32_bf16 v[44:47], a[212:215], a[180:183], v[44:47]
ds_read_b128 a[208:211], v1 offset:60160
ds_read_b128 a[212:215], v1 offset:60224
v_mfma_f32_16x16x32_bf16 v[44:47], a[216:219], a[184:187], v[44:47]
v_exp_f32 v37, v37
v_mfma_f32_16x16x32_bf16 v[44:47], a[220:223], a[188:191], v[44:47]
ds_read_b128 a[216:219], v1 offset:60288
ds_read_b128 a[220:223], v1 offset:60352
v_mfma_f32_16x16x32_bf16 v[80:83], a[240:243], v[52:55], v[80:83]
v_exp_f32 v38, v38
v_mfma_f32_16x16x32_bf16 v[84:87], a[244:247], v[52:55], v[84:87]
v_mfma_f32_16x16x32_bf16 v[88:91], a[248:251], v[52:55], v[88:91]
v_exp_f32 v39, v39
v_mfma_f32_16x16x32_bf16 v[92:95], a[252:255], v[52:55], v[92:95]
s_waitcnt lgkmcnt(4)
v_cvt_pk_bf16_f32 v50, v36, v37
v_cvt_pk_bf16_f32 v51, v38, v39
v_mfma_f32_16x16x32_bf16 v[32:35], a[192:195], a[96:99], 0
s_mov_b32 s18, 100663296
v_exp_f32 v40, v40
v_mfma_f32_16x16x32_bf16 v[32:35], a[196:199], a[100:103], v[32:35]
s_mov_b32 s39, s24
v_mfma_f32_16x16x32_bf16 v[32:35], a[200:203], a[104:107], v[32:35]
s_add_u32 s23, s23, 1
v_exp_f32 v41, v41
v_mfma_f32_16x16x32_bf16 v[32:35], a[204:207], a[108:111], v[32:35]
s_mov_b32 s24, s25
v_mfma_f32_16x16x32_bf16 v[96:99], a[224:227], v[48:51], v[96:99]
s_add_u32 s25, s25, 25165824
v_exp_f32 v42, v42
v_mfma_f32_16x16x32_bf16 v[100:103], a[228:231], v[48:51], v[100:103]
s_add_u32 s27, s27, 16777216
v_mfma_f32_16x16x32_bf16 v[104:107], a[232:235], v[48:51], v[104:107]
s_cmp_lt_u32 s23, 3
s_cselect_b32 s6, s6, 0
v_exp_f32 v43, v43
v_mfma_f32_16x16x32_bf16 v[108:111], a[236:239], v[48:51], v[108:111]
s_waitcnt lgkmcnt(0)
v_cvt_pk_bf16_f32 v52, v40, v41
v_cvt_pk_bf16_f32 v53, v42, v43
v_mfma_f32_16x16x32_bf16 v[36:39], a[208:211], a[96:99], 0
s_add_u32 s28, s25, 0
v_exp_f32 v44, v44
v_mfma_f32_16x16x32_bf16 v[36:39], a[212:215], a[100:103], v[36:39]
s_add_u32 m0, s51, 0
v_mfma_f32_16x16x32_bf16 v[36:39], a[216:219], a[104:107], v[36:39]
v_exp_f32 v45, v45
v_mfma_f32_16x16x32_bf16 v[36:39], a[220:223], a[108:111], v[36:39]
buffer_load_dwordx4 v5, s[4:7], s28 offen offset:0 nt lds
v_mfma_f32_16x16x32_bf16 v[112:115], a[240:243], v[48:51], v[112:115]
v_exp_f32 v46, v46
v_accvgpr_write_b32 a104, v168
v_accvgpr_write_b32 a105, v169
v_mfma_f32_16x16x32_bf16 v[116:119], a[244:247], v[48:51], v[116:119]
v_accvgpr_write_b32 a96, v160
v_accvgpr_write_b32 a97, v161
v_accvgpr_write_b32 a98, v162
v_accvgpr_write_b32 a106, v170
v_mfma_f32_16x16x32_bf16 v[120:123], a[248:251], v[48:51], v[120:123]
v_exp_f32 v47, v47
v_accvgpr_write_b32 a99, v163
v_accvgpr_write_b32 a107, v171
v_mfma_f32_16x16x32_bf16 v[124:127], a[252:255], v[48:51], v[124:127]
v_cvt_pk_bf16_f32 v54, v44, v45
v_cvt_pk_bf16_f32 v55, v46, v47
v_accvgpr_write_b32 a100, v164
v_accvgpr_write_b32 a108, v172
v_mfma_f32_16x16x32_bf16 v[40:43], a[192:195], a[112:115], 0
v_exp_f32 v32, v32
v_accvgpr_write_b32 a101, v165
v_accvgpr_write_b32 a109, v173
v_mfma_f32_16x16x32_bf16 v[40:43], a[196:199], a[116:119], v[40:43]
v_exp_f32 v33, v33
v_accvgpr_write_b32 a102, v166
v_mfma_f32_16x16x32_bf16 v[40:43], a[200:203], a[120:123], v[40:43]
v_exp_f32 v34, v34
v_accvgpr_write_b32 a103, v167
v_mfma_f32_16x16x32_bf16 v[40:43], a[204:207], a[124:127], v[40:43]
v_exp_f32 v35, v35
v_accvgpr_write_b32 a110, v174
v_smfmac_f32_16x16x64_bf16 v[20:23], v[24:27], v[48:55], v28
v_exp_f32 v36, v36
v_accvgpr_write_b32 a111, v175
v_mfma_f32_16x16x32_bf16 v[128:131], a[224:227], v[52:55], v[128:131]
ds_read_b64_tr_b16 a[224:225], v2 offset:59136
ds_read_b64_tr_b16 a[226:227], v2 offset:59392
v_mfma_f32_16x16x32_bf16 v[132:135], a[228:231], v[52:55], v[132:135]
v_cvt_pk_bf16_f32 v48, v32, v33
v_cvt_pk_bf16_f32 v49, v34, v35
v_mfma_f32_16x16x32_bf16 v[136:139], a[232:235], v[52:55], v[136:139]
ds_read_b64_tr_b16 a[228:229], v2 offset:59144
ds_read_b64_tr_b16 a[230:231], v2 offset:59400
v_mfma_f32_16x16x32_bf16 v[140:143], a[236:239], v[52:55], v[140:143]
v_exp_f32 v37, v37
v_mfma_f32_16x16x32_bf16 v[44:47], a[208:211], a[112:115], 0
ds_read_b64_tr_b16 a[232:233], v2 offset:59200
ds_read_b64_tr_b16 a[234:235], v2 offset:59456
v_mfma_f32_16x16x32_bf16 v[44:47], a[212:215], a[116:119], v[44:47]
v_exp_f32 v38, v38
v_mfma_f32_16x16x32_bf16 v[44:47], a[216:219], a[120:123], v[44:47]
ds_read_b64_tr_b16 a[236:237], v2 offset:59208
ds_read_b64_tr_b16 a[238:239], v2 offset:59464
v_mfma_f32_16x16x32_bf16 v[44:47], a[220:223], a[124:127], v[44:47]
v_exp_f32 v39, v39
v_accvgpr_write_b32 a112, v176
v_accvgpr_write_b32 a120, v184
v_mfma_f32_16x16x32_bf16 v[144:147], a[240:243], v[52:55], v[144:147]
ds_read_b64_tr_b16 a[240:241], v2 offset:59264
ds_read_b64_tr_b16 a[242:243], v2 offset:59520
v_accvgpr_write_b32 a113, v177
v_accvgpr_write_b32 a121, v185
v_mfma_f32_16x16x32_bf16 v[148:151], a[244:247], v[52:55], v[148:151]
buffer_load_dwordx4 v5, s[4:7], s28 offen offset:2048 nt lds
v_accvgpr_write_b32 a122, v186
v_mfma_f32_16x16x32_bf16 v[152:155], a[248:251], v[52:55], v[152:155]
ds_read_b64_tr_b16 a[244:245], v2 offset:59272
ds_read_b64_tr_b16 a[246:247], v2 offset:59528
v_accvgpr_write_b32 a114, v178
v_accvgpr_write_b32 a123, v187
v_mfma_f32_16x16x32_bf16 v[156:159], a[252:255], v[52:55], v[156:159]
v_cvt_pk_bf16_f32 v50, v36, v37
v_cvt_pk_bf16_f32 v51, v38, v39
v_accvgpr_write_b32 a115, v179
v_accvgpr_write_b32 a124, v188
v_mfma_f32_16x16x32_bf16 v[32:35], a[192:195], a[128:131], 0
s_add_u32 m0, s21, 33792
v_exp_f32 v40, v40
v_accvgpr_write_b32 a116, v180
v_accvgpr_write_b32 a125, v189
v_mfma_f32_16x16x32_bf16 v[32:35], a[196:199], a[132:135], v[32:35]
ds_read_b64_tr_b16 a[248:249], v2 offset:59328
ds_read_b64_tr_b16 a[250:251], v2 offset:59584
v_accvgpr_write_b32 a117, v181
v_accvgpr_write_b32 a126, v190
v_mfma_f32_16x16x32_bf16 v[32:35], a[200:203], a[136:139], v[32:35]
v_exp_f32 v41, v41
v_accvgpr_write_b32 a118, v182
v_mfma_f32_16x16x32_bf16 v[32:35], a[204:207], a[140:143], v[32:35]
s_waitcnt lgkmcnt(6)
ds_read_b64_tr_b16 a[252:253], v2 offset:59336
ds_read_b64_tr_b16 a[254:255], v2 offset:59592
v_accvgpr_write_b32 a119, v183
v_accvgpr_write_b32 a127, v191
v_mfma_f32_16x16x32_bf16 a[0:3], a[224:227], v[48:51], a[0:3]
v_exp_f32 v42, v42
v_mfma_f32_16x16x32_bf16 a[4:7], a[228:231], v[48:51], a[4:7]
buffer_load_dwordx4 v3, s[8:11], s26 offen offset:0 nt lds
v_mfma_f32_16x16x32_bf16 a[8:11], a[232:235], v[48:51], a[8:11]
v_exp_f32 v43, v43
v_mfma_f32_16x16x32_bf16 a[12:15], a[236:239], v[48:51], a[12:15]
v_cvt_pk_bf16_f32 v52, v40, v41
v_cvt_pk_bf16_f32 v53, v42, v43
v_mfma_f32_16x16x32_bf16 v[36:39], a[208:211], a[128:131], 0
v_exp_f32 v44, v44
v_mfma_f32_16x16x32_bf16 v[36:39], a[212:215], a[132:135], v[36:39]
buffer_load_dwordx4 v3, s[8:11], s26 offen offset:1024 nt lds
v_mfma_f32_16x16x32_bf16 v[36:39], a[216:219], a[136:139], v[36:39]
v_exp_f32 v45, v45
v_mfma_f32_16x16x32_bf16 v[36:39], a[220:223], a[140:143], v[36:39]
s_waitcnt lgkmcnt(0)
v_accvgpr_write_b32 a128, v192
v_accvgpr_write_b32 a129, v193
v_accvgpr_write_b32 a136, v200
v_mfma_f32_16x16x32_bf16 a[16:19], a[240:243], v[48:51], a[16:19]
v_exp_f32 v46, v46
v_accvgpr_write_b32 a137, v201
v_accvgpr_write_b32 a138, v202
v_mfma_f32_16x16x32_bf16 a[20:23], a[244:247], v[48:51], a[20:23]
v_accvgpr_write_b32 a130, v194
v_accvgpr_write_b32 a131, v195
v_accvgpr_write_b32 a132, v196
v_accvgpr_write_b32 a139, v203
v_mfma_f32_16x16x32_bf16 a[24:27], a[248:251], v[48:51], a[24:27]
v_exp_f32 v47, v47
v_accvgpr_write_b32 a133, v197
v_accvgpr_write_b32 a140, v204
v_mfma_f32_16x16x32_bf16 a[28:31], a[252:255], v[48:51], a[28:31]
v_cvt_pk_bf16_f32 v54, v44, v45
v_cvt_pk_bf16_f32 v55, v46, v47
v_accvgpr_write_b32 a134, v198
v_mfma_f32_16x16x32_bf16 v[40:43], a[192:195], a[144:147], 0
s_waitcnt vmcnt(20)
v_exp_f32 v32, v32
v_accvgpr_write_b32 a135, v199
v_mfma_f32_16x16x32_bf16 v[40:43], a[196:199], a[148:151], v[40:43]
ds_read_b128 v[248:251], v8 offset:4096
ds_read_b128 v[252:255], v8 offset:4160
v_accvgpr_write_b32 a141, v205
v_mfma_f32_16x16x32_bf16 v[40:43], a[200:203], a[152:155], v[40:43]
v_exp_f32 v33, v33
v_mfma_f32_16x16x32_bf16 v[40:43], a[204:207], a[156:159], v[40:43]
v_accvgpr_write_b32 a142, v206
v_accvgpr_write_b32 a143, v207
v_smfmac_f32_16x16x64_bf16 v[12:15], v[24:27], v[48:55], v28
v_mfma_f32_16x16x32_bf16 a[32:35], a[224:227], v[52:55], a[32:35]
v_exp_f32 v34, v34
v_mfma_f32_16x16x32_bf16 a[36:39], a[228:231], v[52:55], a[36:39]
v_mfma_f32_16x16x32_bf16 a[40:43], a[232:235], v[52:55], a[40:43]
v_exp_f32 v35, v35
v_mfma_f32_16x16x32_bf16 a[44:47], a[236:239], v[52:55], a[44:47]
v_cvt_pk_bf16_f32 v48, v32, v33
v_cvt_pk_bf16_f32 v49, v34, v35
v_mfma_f32_16x16x32_bf16 v[44:47], a[208:211], a[144:147], 0
s_waitcnt lgkmcnt(0)
v_exp_f32 v36, v36
v_add_f32 v11, v12, v13
v_mov_b64 v[12:13], 0
v_rcp_f32 v10, v11
v_subrev_u32 v9, s33, v11
v_accvgpr_read_b32 v56, a0
v_accvgpr_read_b32 v57, a1
v_accvgpr_read_b32 v58, a2
v_accvgpr_read_b32 v59, a3
v_accvgpr_read_b32 v60, a4
v_accvgpr_read_b32 v61, a5
v_accvgpr_read_b32 v62, a6
v_accvgpr_read_b32 v63, a7
v_pk_mul_f32 v[56:57], v[56:57], v[10:11] op_sel_hi:[1,0]
v_pk_mul_f32 v[58:59], v[58:59], v[10:11] op_sel_hi:[1,0]
v_pk_mul_f32 v[60:61], v[60:61], v[10:11] op_sel_hi:[1,0]
v_pk_mul_f32 v[62:63], v[62:63], v[10:11] op_sel_hi:[1,0]
v_cvt_pk_bf16_f32 v160, v56, v57
v_cvt_pk_bf16_f32 v161, v58, v59
v_cvt_pk_bf16_f32 v162, v60, v61
v_cvt_pk_bf16_f32 v163, v62, v63
v_accvgpr_read_b32 v56, a8
v_accvgpr_read_b32 v57, a9
v_accvgpr_read_b32 v58, a10
v_accvgpr_read_b32 v59, a11
v_accvgpr_read_b32 v60, a12
v_accvgpr_read_b32 v61, a13
v_accvgpr_read_b32 v62, a14
v_accvgpr_read_b32 v63, a15
v_pk_mul_f32 v[56:57], v[56:57], v[10:11] op_sel_hi:[1,0]
v_pk_mul_f32 v[58:59], v[58:59], v[10:11] op_sel_hi:[1,0]
v_pk_mul_f32 v[60:61], v[60:61], v[10:11] op_sel_hi:[1,0]
v_pk_mul_f32 v[62:63], v[62:63], v[10:11] op_sel_hi:[1,0]
v_cvt_pk_bf16_f32 v164, v56, v57
v_cvt_pk_bf16_f32 v165, v58, v59
v_cvt_pk_bf16_f32 v166, v60, v61
v_cvt_pk_bf16_f32 v167, v62, v63
v_accvgpr_read_b32 v56, a16
v_accvgpr_read_b32 v57, a17
v_accvgpr_read_b32 v58, a18
v_accvgpr_read_b32 v59, a19
v_accvgpr_read_b32 v60, a20
v_accvgpr_read_b32 v61, a21
v_accvgpr_read_b32 v62, a22
v_accvgpr_read_b32 v63, a23
v_pk_mul_f32 v[56:57], v[56:57], v[10:11] op_sel_hi:[1,0]
v_pk_mul_f32 v[58:59], v[58:59], v[10:11] op_sel_hi:[1,0]
v_pk_mul_f32 v[60:61], v[60:61], v[10:11] op_sel_hi:[1,0]
v_pk_mul_f32 v[62:63], v[62:63], v[10:11] op_sel_hi:[1,0]
v_cvt_pk_bf16_f32 v168, v56, v57
v_cvt_pk_bf16_f32 v169, v58, v59
v_cvt_pk_bf16_f32 v170, v60, v61
v_cvt_pk_bf16_f32 v171, v62, v63
v_accvgpr_read_b32 v56, a24
v_accvgpr_read_b32 v57, a25
v_accvgpr_read_b32 v58, a26
v_accvgpr_read_b32 v59, a27
v_accvgpr_read_b32 v60, a28
v_accvgpr_read_b32 v61, a29
v_accvgpr_read_b32 v62, a30
v_accvgpr_read_b32 v63, a31
v_pk_mul_f32 v[56:57], v[56:57], v[10:11] op_sel_hi:[1,0]
v_pk_mul_f32 v[58:59], v[58:59], v[10:11] op_sel_hi:[1,0]
v_pk_mul_f32 v[60:61], v[60:61], v[10:11] op_sel_hi:[1,0]
v_pk_mul_f32 v[62:63], v[62:63], v[10:11] op_sel_hi:[1,0]
v_cvt_pk_bf16_f32 v172, v56, v57
v_cvt_pk_bf16_f32 v173, v58, v59
v_cvt_pk_bf16_f32 v174, v60, v61
v_cvt_pk_bf16_f32 v175, v62, v63
v_mfma_f32_16x16x32_bf16 v[44:47], a[212:215], a[148:151], v[44:47]
v_mfma_f32_16x16x32_bf16 v[44:47], a[216:219], a[152:155], v[44:47]
v_exp_f32 v37, v37
v_mfma_f32_16x16x32_bf16 v[44:47], a[220:223], a[156:159], v[44:47]
v_accvgpr_write_b32 a144, v208
v_accvgpr_write_b32 a145, v209
v_accvgpr_write_b32 a152, v216
v_mfma_f32_16x16x32_bf16 a[48:51], a[240:243], v[52:55], a[48:51]
v_exp_f32 v38, v38
v_accvgpr_write_b32 a153, v217
v_accvgpr_write_b32 a154, v218
v_mfma_f32_16x16x32_bf16 a[52:55], a[244:247], v[52:55], a[52:55]
v_accvgpr_write_b32 a146, v210
v_accvgpr_write_b32 a147, v211
v_accvgpr_write_b32 a148, v212
v_accvgpr_write_b32 a155, v219
v_mfma_f32_16x16x32_bf16 a[56:59], a[248:251], v[52:55], a[56:59]
v_exp_f32 v39, v39
v_accvgpr_write_b32 a149, v213
v_accvgpr_write_b32 a156, v220
v_mfma_f32_16x16x32_bf16 a[60:63], a[252:255], v[52:55], a[60:63]
v_cvt_pk_bf16_f32 v50, v36, v37
v_cvt_pk_bf16_f32 v51, v38, v39
v_accvgpr_write_b32 a150, v214
v_accvgpr_write_b32 a157, v221
v_mfma_f32_16x16x32_bf16 v[32:35], a[192:195], a[160:163], 0
s_add_u32 m0, s22, 33792
v_exp_f32 v40, v40
v_accvgpr_write_b32 a151, v215
v_mfma_f32_16x16x32_bf16 v[32:35], a[196:199], a[164:167], v[32:35]
buffer_load_dwordx4 v4, s[12:15], s26 offen offset:0 nt lds
v_mfma_f32_16x16x32_bf16 v[32:35], a[200:203], a[168:171], v[32:35]
s_sub_u32 m0, m0, 1016
v_exp_f32 v41, v41
v_accvgpr_write_b32 a158, v222
v_mfma_f32_16x16x32_bf16 v[32:35], a[204:207], a[172:175], v[32:35]
buffer_load_dwordx4 v4, s[12:15], s26 offen offset:2048 nt lds
v_accvgpr_write_b32 a159, v223
v_mfma_f32_16x16x32_bf16 a[64:67], a[224:227], v[48:51], a[64:67]
s_add_u32 s26, s26, 8192
v_exp_f32 v42, v42
v_mfma_f32_16x16x32_bf16 a[68:71], a[228:231], v[48:51], a[68:71]
s_add_u32 m0, s21, 42240
v_mfma_f32_16x16x32_bf16 a[72:75], a[232:235], v[48:51], a[72:75]
v_exp_f32 v43, v43
v_mfma_f32_16x16x32_bf16 a[76:79], a[236:239], v[48:51], a[76:79]
v_cvt_pk_bf16_f32 v52, v40, v41
v_cvt_pk_bf16_f32 v53, v42, v43
v_mfma_f32_16x16x32_bf16 v[36:39], a[208:211], a[160:163], 0
v_exp_f32 v44, v44
v_add_f32 v11, v14, v15
v_mov_b64 v[14:15], 0
v_rcp_f32 v10, v11
v_subrev_u32 v11, s33, v11
v_max_u32 v9, v9, v11
v_accvgpr_read_b32 v56, a32
v_accvgpr_read_b32 v57, a33
v_accvgpr_read_b32 v58, a34
v_accvgpr_read_b32 v59, a35
v_accvgpr_read_b32 v60, a36
v_accvgpr_read_b32 v61, a37
v_accvgpr_read_b32 v62, a38
v_accvgpr_read_b32 v63, a39
v_pk_mul_f32 v[56:57], v[56:57], v[10:11] op_sel_hi:[1,0]
v_pk_mul_f32 v[58:59], v[58:59], v[10:11] op_sel_hi:[1,0]
v_pk_mul_f32 v[60:61], v[60:61], v[10:11] op_sel_hi:[1,0]
v_pk_mul_f32 v[62:63], v[62:63], v[10:11] op_sel_hi:[1,0]
v_cvt_pk_bf16_f32 v176, v56, v57
v_cvt_pk_bf16_f32 v177, v58, v59
v_cvt_pk_bf16_f32 v178, v60, v61
v_cvt_pk_bf16_f32 v179, v62, v63
v_accvgpr_read_b32 v56, a40
v_accvgpr_read_b32 v57, a41
v_accvgpr_read_b32 v58, a42
v_accvgpr_read_b32 v59, a43
v_accvgpr_read_b32 v60, a44
v_accvgpr_read_b32 v61, a45
v_accvgpr_read_b32 v62, a46
v_accvgpr_read_b32 v63, a47
v_pk_mul_f32 v[56:57], v[56:57], v[10:11] op_sel_hi:[1,0]
v_pk_mul_f32 v[58:59], v[58:59], v[10:11] op_sel_hi:[1,0]
v_pk_mul_f32 v[60:61], v[60:61], v[10:11] op_sel_hi:[1,0]
v_pk_mul_f32 v[62:63], v[62:63], v[10:11] op_sel_hi:[1,0]
v_cvt_pk_bf16_f32 v180, v56, v57
v_cvt_pk_bf16_f32 v181, v58, v59
v_cvt_pk_bf16_f32 v182, v60, v61
v_cvt_pk_bf16_f32 v183, v62, v63
v_accvgpr_read_b32 v56, a48
v_accvgpr_read_b32 v57, a49
v_accvgpr_read_b32 v58, a50
v_accvgpr_read_b32 v59, a51
v_accvgpr_read_b32 v60, a52
v_accvgpr_read_b32 v61, a53
v_accvgpr_read_b32 v62, a54
v_accvgpr_read_b32 v63, a55
v_pk_mul_f32 v[56:57], v[56:57], v[10:11] op_sel_hi:[1,0]
v_pk_mul_f32 v[58:59], v[58:59], v[10:11] op_sel_hi:[1,0]
v_pk_mul_f32 v[60:61], v[60:61], v[10:11] op_sel_hi:[1,0]
v_pk_mul_f32 v[62:63], v[62:63], v[10:11] op_sel_hi:[1,0]
v_cvt_pk_bf16_f32 v184, v56, v57
v_cvt_pk_bf16_f32 v185, v58, v59
v_cvt_pk_bf16_f32 v186, v60, v61
v_cvt_pk_bf16_f32 v187, v62, v63
v_accvgpr_read_b32 v56, a56
v_accvgpr_read_b32 v57, a57
v_accvgpr_read_b32 v58, a58
v_accvgpr_read_b32 v59, a59
v_accvgpr_read_b32 v60, a60
v_accvgpr_read_b32 v61, a61
v_accvgpr_read_b32 v62, a62
v_accvgpr_read_b32 v63, a63
v_pk_mul_f32 v[56:57], v[56:57], v[10:11] op_sel_hi:[1,0]
v_pk_mul_f32 v[58:59], v[58:59], v[10:11] op_sel_hi:[1,0]
v_pk_mul_f32 v[60:61], v[60:61], v[10:11] op_sel_hi:[1,0]
v_pk_mul_f32 v[62:63], v[62:63], v[10:11] op_sel_hi:[1,0]
v_cvt_pk_bf16_f32 v188, v56, v57
v_cvt_pk_bf16_f32 v189, v58, v59
v_cvt_pk_bf16_f32 v190, v60, v61
v_cvt_pk_bf16_f32 v191, v62, v63
v_mfma_f32_16x16x32_bf16 v[36:39], a[212:215], a[164:167], v[36:39]
buffer_load_dwordx4 v3, s[8:11], s26 offen offset:0 nt lds
v_mfma_f32_16x16x32_bf16 v[36:39], a[216:219], a[168:171], v[36:39]
v_exp_f32 v45, v45
v_mfma_f32_16x16x32_bf16 v[36:39], a[220:223], a[172:175], v[36:39]
v_accvgpr_write_b32 a160, v224
v_accvgpr_write_b32 a161, v225
v_accvgpr_write_b32 a162, v226
v_accvgpr_write_b32 a168, v232
v_mfma_f32_16x16x32_bf16 a[80:83], a[240:243], v[48:51], a[80:83]
v_exp_f32 v46, v46
v_accvgpr_write_b32 a163, v227
v_accvgpr_write_b32 a169, v233
v_mfma_f32_16x16x32_bf16 a[84:87], a[244:247], v[48:51], a[84:87]
buffer_load_dwordx4 v3, s[8:11], s26 offen offset:1024 nt lds
v_accvgpr_write_b32 a170, v234
v_mfma_f32_16x16x32_bf16 a[88:91], a[248:251], v[48:51], a[88:91]
v_exp_f32 v47, v47
v_accvgpr_write_b32 a164, v228
v_accvgpr_write_b32 a171, v235
v_mfma_f32_16x16x32_bf16 a[92:95], a[252:255], v[48:51], a[92:95]
v_cvt_pk_bf16_f32 v54, v44, v45
v_cvt_pk_bf16_f32 v55, v46, v47
v_accvgpr_write_b32 a165, v229
v_accvgpr_write_b32 a172, v236
v_mfma_f32_16x16x32_bf16 v[40:43], a[192:195], a[176:179], 0
s_add_u32 m0, s51, 896
v_exp_f32 v32, v32
v_accvgpr_write_b32 a166, v230
v_mfma_f32_16x16x32_bf16 v[40:43], a[196:199], a[180:183], v[40:43]
ds_read_b128 a[192:195], v1 offset:0
ds_read_b128 a[196:199], v1 offset:64
v_accvgpr_write_b32 a167, v231
v_mfma_f32_16x16x32_bf16 v[40:43], a[200:203], a[184:187], v[40:43]
v_exp_f32 v33, v33
v_accvgpr_write_b32 a173, v237
v_mfma_f32_16x16x32_bf16 v[40:43], a[204:207], a[188:191], v[40:43]
ds_read_b128 a[200:203], v1 offset:128
ds_read_b128 a[204:207], v1 offset:192
v_accvgpr_write_b32 a174, v238
v_smfmac_f32_16x16x64_bf16 v[16:19], v[24:27], v[48:55], v28
buffer_load_dwordx4 v5, s[4:7], s28 offen offset:128 nt lds
v_mfma_f32_16x16x32_bf16 v[64:67], a[224:227], v[52:55], v[64:67]
v_exp_f32 v34, v34
v_mfma_f32_16x16x32_bf16 v[68:71], a[228:231], v[52:55], v[68:71]
v_accvgpr_write_b32 a175, v239
v_mfma_f32_16x16x32_bf16 v[72:75], a[232:235], v[52:55], v[72:75]
v_exp_f32 v35, v35
v_mfma_f32_16x16x32_bf16 v[76:79], a[236:239], v[52:55], v[76:79]
v_cvt_pk_bf16_f32 v48, v32, v33
v_cvt_pk_bf16_f32 v49, v34, v35
v_mfma_f32_16x16x32_bf16 v[44:47], a[208:211], a[176:179], 0
v_exp_f32 v36, v36
v_add_f32 v11, v16, v17
v_mov_b64 v[16:17], 0
v_rcp_f32 v10, v11
v_subrev_u32 v11, s33, v11
v_max_u32 v9, v9, v11
v_accvgpr_read_b32 v56, a64
v_accvgpr_read_b32 v57, a65
v_accvgpr_read_b32 v58, a66
v_accvgpr_read_b32 v59, a67
v_accvgpr_read_b32 v60, a68
v_accvgpr_read_b32 v61, a69
v_accvgpr_read_b32 v62, a70
v_accvgpr_read_b32 v63, a71
v_pk_mul_f32 v[56:57], v[56:57], v[10:11] op_sel_hi:[1,0]
v_pk_mul_f32 v[58:59], v[58:59], v[10:11] op_sel_hi:[1,0]
v_pk_mul_f32 v[60:61], v[60:61], v[10:11] op_sel_hi:[1,0]
v_pk_mul_f32 v[62:63], v[62:63], v[10:11] op_sel_hi:[1,0]
v_cvt_pk_bf16_f32 v192, v56, v57
v_cvt_pk_bf16_f32 v193, v58, v59
v_cvt_pk_bf16_f32 v194, v60, v61
v_cvt_pk_bf16_f32 v195, v62, v63
v_accvgpr_read_b32 v56, a72
v_accvgpr_read_b32 v57, a73
v_accvgpr_read_b32 v58, a74
v_accvgpr_read_b32 v59, a75
v_accvgpr_read_b32 v60, a76
v_accvgpr_read_b32 v61, a77
v_accvgpr_read_b32 v62, a78
v_accvgpr_read_b32 v63, a79
v_pk_mul_f32 v[56:57], v[56:57], v[10:11] op_sel_hi:[1,0]
v_pk_mul_f32 v[58:59], v[58:59], v[10:11] op_sel_hi:[1,0]
v_pk_mul_f32 v[60:61], v[60:61], v[10:11] op_sel_hi:[1,0]
v_pk_mul_f32 v[62:63], v[62:63], v[10:11] op_sel_hi:[1,0]
v_cvt_pk_bf16_f32 v196, v56, v57
v_cvt_pk_bf16_f32 v197, v58, v59
v_cvt_pk_bf16_f32 v198, v60, v61
v_cvt_pk_bf16_f32 v199, v62, v63
v_accvgpr_read_b32 v56, a80
v_accvgpr_read_b32 v57, a81
v_accvgpr_read_b32 v58, a82
v_accvgpr_read_b32 v59, a83
v_accvgpr_read_b32 v60, a84
v_accvgpr_read_b32 v61, a85
v_accvgpr_read_b32 v62, a86
v_accvgpr_read_b32 v63, a87
v_pk_mul_f32 v[56:57], v[56:57], v[10:11] op_sel_hi:[1,0]
v_pk_mul_f32 v[58:59], v[58:59], v[10:11] op_sel_hi:[1,0]
v_pk_mul_f32 v[60:61], v[60:61], v[10:11] op_sel_hi:[1,0]
v_pk_mul_f32 v[62:63], v[62:63], v[10:11] op_sel_hi:[1,0]
v_cvt_pk_bf16_f32 v200, v56, v57
v_cvt_pk_bf16_f32 v201, v58, v59
v_cvt_pk_bf16_f32 v202, v60, v61
v_cvt_pk_bf16_f32 v203, v62, v63
v_accvgpr_read_b32 v56, a88
v_accvgpr_read_b32 v57, a89
v_accvgpr_read_b32 v58, a90
v_accvgpr_read_b32 v59, a91
v_accvgpr_read_b32 v60, a92
v_accvgpr_read_b32 v61, a93
v_accvgpr_read_b32 v62, a94
v_accvgpr_read_b32 v63, a95
v_pk_mul_f32 v[56:57], v[56:57], v[10:11] op_sel_hi:[1,0]
v_pk_mul_f32 v[58:59], v[58:59], v[10:11] op_sel_hi:[1,0]
v_pk_mul_f32 v[60:61], v[60:61], v[10:11] op_sel_hi:[1,0]
v_pk_mul_f32 v[62:63], v[62:63], v[10:11] op_sel_hi:[1,0]
v_cvt_pk_bf16_f32 v204, v56, v57
v_cvt_pk_bf16_f32 v205, v58, v59
v_cvt_pk_bf16_f32 v206, v60, v61
v_cvt_pk_bf16_f32 v207, v62, v63
v_mfma_f32_16x16x32_bf16 v[44:47], a[212:215], a[180:183], v[44:47]
ds_read_b128 a[208:211], v1 offset:1024
ds_read_b128 a[212:215], v1 offset:1088
v_mfma_f32_16x16x32_bf16 v[44:47], a[216:219], a[184:187], v[44:47]
v_exp_f32 v37, v37
v_mfma_f32_16x16x32_bf16 v[44:47], a[220:223], a[188:191], v[44:47]
ds_read_b128 a[216:219], v1 offset:1152
ds_read_b128 a[220:223], v1 offset:1216
v_mfma_f32_16x16x32_bf16 v[80:83], a[240:243], v[52:55], v[80:83]
v_exp_f32 v38, v38
v_mfma_f32_16x16x32_bf16 v[84:87], a[244:247], v[52:55], v[84:87]
buffer_load_dwordx4 v5, s[4:7], s28 offen offset:2176 nt lds
v_mfma_f32_16x16x32_bf16 v[88:91], a[248:251], v[52:55], v[88:91]
v_exp_f32 v39, v39
v_mfma_f32_16x16x32_bf16 v[92:95], a[252:255], v[52:55], v[92:95]
s_waitcnt lgkmcnt(4)
v_cvt_pk_bf16_f32 v50, v36, v37
v_cvt_pk_bf16_f32 v51, v38, v39
v_lshlrev_b32 v56, 16, v240
v_and_b32 v57, s32, v240
v_lshlrev_b32 v58, 16, v241
v_and_b32 v59, s32, v241
v_lshlrev_b32 v60, 16, v242
v_and_b32 v61, s32, v242
v_lshlrev_b32 v62, 16, v243
v_and_b32 v63, s32, v243
v_pk_mul_f32 v[56:57], v[56:57], s[30:31]
v_pk_mul_f32 v[58:59], v[58:59], s[30:31]
v_pk_mul_f32 v[60:61], v[60:61], s[30:31]
v_pk_mul_f32 v[62:63], v[62:63], s[30:31]
v_cvt_pk_bf16_f32 v240, v56, v57
v_cvt_pk_bf16_f32 v241, v58, v59
v_cvt_pk_bf16_f32 v242, v60, v61
v_cvt_pk_bf16_f32 v243, v62, v63
v_lshlrev_b32 v56, 16, v244
v_and_b32 v57, s32, v244
v_lshlrev_b32 v58, 16, v245
v_and_b32 v59, s32, v245
v_lshlrev_b32 v60, 16, v246
v_and_b32 v61, s32, v246
v_lshlrev_b32 v62, 16, v247
v_and_b32 v63, s32, v247
v_pk_mul_f32 v[56:57], v[56:57], s[30:31]
v_pk_mul_f32 v[58:59], v[58:59], s[30:31]
v_pk_mul_f32 v[60:61], v[60:61], s[30:31]
v_pk_mul_f32 v[62:63], v[62:63], s[30:31]
v_cvt_pk_bf16_f32 v244, v56, v57
v_cvt_pk_bf16_f32 v245, v58, v59
v_cvt_pk_bf16_f32 v246, v60, v61
v_cvt_pk_bf16_f32 v247, v62, v63
v_accvgpr_write_b32 a176, v240
v_accvgpr_write_b32 a177, v241
v_accvgpr_write_b32 a178, v242
v_accvgpr_write_b32 a179, v243
v_accvgpr_write_b32 a180, v244
v_accvgpr_write_b32 a181, v245
v_accvgpr_write_b32 a182, v246
v_accvgpr_write_b32 a183, v247
v_lshlrev_b32 v56, 16, v248
v_and_b32 v57, s32, v248
v_lshlrev_b32 v58, 16, v249
v_and_b32 v59, s32, v249
v_lshlrev_b32 v60, 16, v250
v_and_b32 v61, s32, v250
v_lshlrev_b32 v62, 16, v251
v_and_b32 v63, s32, v251
v_pk_mul_f32 v[56:57], v[56:57], s[30:31]
v_pk_mul_f32 v[58:59], v[58:59], s[30:31]
v_pk_mul_f32 v[60:61], v[60:61], s[30:31]
v_pk_mul_f32 v[62:63], v[62:63], s[30:31]
v_cvt_pk_bf16_f32 v248, v56, v57
v_cvt_pk_bf16_f32 v249, v58, v59
v_cvt_pk_bf16_f32 v250, v60, v61
v_cvt_pk_bf16_f32 v251, v62, v63
v_lshlrev_b32 v56, 16, v252
v_and_b32 v57, s32, v252
v_lshlrev_b32 v58, 16, v253
v_and_b32 v59, s32, v253
v_lshlrev_b32 v60, 16, v254
v_and_b32 v61, s32, v254
v_lshlrev_b32 v62, 16, v255
v_and_b32 v63, s32, v255
v_pk_mul_f32 v[56:57], v[56:57], s[30:31]
v_pk_mul_f32 v[58:59], v[58:59], s[30:31]
v_pk_mul_f32 v[60:61], v[60:61], s[30:31]
v_pk_mul_f32 v[62:63], v[62:63], s[30:31]
v_cvt_pk_bf16_f32 v252, v56, v57
v_cvt_pk_bf16_f32 v253, v58, v59
v_cvt_pk_bf16_f32 v254, v60, v61
v_cvt_pk_bf16_f32 v255, v62, v63
v_accvgpr_write_b32 a184, v248
v_accvgpr_write_b32 a185, v249
v_accvgpr_write_b32 a186, v250
v_accvgpr_write_b32 a187, v251
v_accvgpr_write_b32 a188, v252
v_accvgpr_write_b32 a189, v253
v_accvgpr_write_b32 a190, v254
v_accvgpr_write_b32 a191, v255
v_mfma_f32_16x16x32_bf16 v[32:35], a[192:195], a[96:99], 0
s_add_u32 m0, s22, 42240
v_exp_f32 v40, v40
v_mfma_f32_16x16x32_bf16 v[32:35], a[196:199], a[100:103], v[32:35]
buffer_load_dwordx4 v4, s[12:15], s26 offen offset:0 nt lds
v_mfma_f32_16x16x32_bf16 v[32:35], a[200:203], a[104:107], v[32:35]
s_sub_u32 m0, m0, 1016
v_exp_f32 v41, v41
v_mfma_f32_16x16x32_bf16 v[32:35], a[204:207], a[108:111], v[32:35]
buffer_load_dwordx4 v4, s[12:15], s26 offen offset:2048 nt lds
v_mfma_f32_16x16x32_bf16 v[96:99], a[224:227], v[48:51], v[96:99]
s_add_u32 s26, s26, 8192
v_exp_f32 v42, v42
v_mfma_f32_16x16x32_bf16 v[100:103], a[228:231], v[48:51], v[100:103]
s_add_u32 m0, s21, 50688
v_mfma_f32_16x16x32_bf16 v[104:107], a[232:235], v[48:51], v[104:107]
v_exp_f32 v43, v43
v_mfma_f32_16x16x32_bf16 v[108:111], a[236:239], v[48:51], v[108:111]
s_waitcnt lgkmcnt(0)
v_cvt_pk_bf16_f32 v52, v40, v41
v_cvt_pk_bf16_f32 v53, v42, v43
v_mfma_f32_16x16x32_bf16 v[36:39], a[208:211], a[96:99], 0
v_exp_f32 v44, v44
v_add_f32 v11, v18, v19
v_mov_b64 v[18:19], 0
v_rcp_f32 v10, v11
v_subrev_u32 v11, s33, v11
v_max_u32 v9, v9, v11
v_pk_mul_f32 v[64:65], v[64:65], v[10:11] op_sel_hi:[1,0]
v_pk_mul_f32 v[66:67], v[66:67], v[10:11] op_sel_hi:[1,0]
v_pk_mul_f32 v[68:69], v[68:69], v[10:11] op_sel_hi:[1,0]
v_pk_mul_f32 v[70:71], v[70:71], v[10:11] op_sel_hi:[1,0]
v_cvt_pk_bf16_f32 v208, v64, v65
v_cvt_pk_bf16_f32 v209, v66, v67
v_cvt_pk_bf16_f32 v210, v68, v69
v_cvt_pk_bf16_f32 v211, v70, v71
v_pk_mul_f32 v[72:73], v[72:73], v[10:11] op_sel_hi:[1,0]
v_pk_mul_f32 v[74:75], v[74:75], v[10:11] op_sel_hi:[1,0]
v_pk_mul_f32 v[76:77], v[76:77], v[10:11] op_sel_hi:[1,0]
v_pk_mul_f32 v[78:79], v[78:79], v[10:11] op_sel_hi:[1,0]
v_cvt_pk_bf16_f32 v212, v72, v73
v_cvt_pk_bf16_f32 v213, v74, v75
v_cvt_pk_bf16_f32 v214, v76, v77
v_cvt_pk_bf16_f32 v215, v78, v79
v_pk_mul_f32 v[80:81], v[80:81], v[10:11] op_sel_hi:[1,0]
v_pk_mul_f32 v[82:83], v[82:83], v[10:11] op_sel_hi:[1,0]
v_pk_mul_f32 v[84:85], v[84:85], v[10:11] op_sel_hi:[1,0]
v_pk_mul_f32 v[86:87], v[86:87], v[10:11] op_sel_hi:[1,0]
v_cvt_pk_bf16_f32 v216, v80, v81
v_cvt_pk_bf16_f32 v217, v82, v83
v_cvt_pk_bf16_f32 v218, v84, v85
v_cvt_pk_bf16_f32 v219, v86, v87
v_pk_mul_f32 v[88:89], v[88:89], v[10:11] op_sel_hi:[1,0]
v_pk_mul_f32 v[90:91], v[90:91], v[10:11] op_sel_hi:[1,0]
v_pk_mul_f32 v[92:93], v[92:93], v[10:11] op_sel_hi:[1,0]
v_pk_mul_f32 v[94:95], v[94:95], v[10:11] op_sel_hi:[1,0]
v_cvt_pk_bf16_f32 v220, v88, v89
v_cvt_pk_bf16_f32 v221, v90, v91
v_cvt_pk_bf16_f32 v222, v92, v93
v_cvt_pk_bf16_f32 v223, v94, v95
v_mfma_f32_16x16x32_bf16 v[36:39], a[212:215], a[100:103], v[36:39]
buffer_load_dwordx4 v3, s[8:11], s26 offen offset:0 nt lds
v_mfma_f32_16x16x32_bf16 v[36:39], a[216:219], a[104:107], v[36:39]
v_exp_f32 v45, v45
v_mfma_f32_16x16x32_bf16 v[36:39], a[220:223], a[108:111], v[36:39]
v_mfma_f32_16x16x32_bf16 v[112:115], a[240:243], v[48:51], v[112:115]
v_exp_f32 v46, v46
v_mfma_f32_16x16x32_bf16 v[116:119], a[244:247], v[48:51], v[116:119]
buffer_load_dwordx4 v3, s[8:11], s26 offen offset:1024 nt lds
v_mfma_f32_16x16x32_bf16 v[120:123], a[248:251], v[48:51], v[120:123]
v_exp_f32 v47, v47
v_mfma_f32_16x16x32_bf16 v[124:127], a[252:255], v[48:51], v[124:127]
v_cvt_pk_bf16_f32 v54, v44, v45
v_cvt_pk_bf16_f32 v55, v46, v47
v_mfma_f32_16x16x32_bf16 v[40:43], a[192:195], a[112:115], 0
s_add_u32 m0, s22, 50688
v_exp_f32 v32, v32
v_mfma_f32_16x16x32_bf16 v[40:43], a[196:199], a[116:119], v[40:43]
v_exp_f32 v33, v33
v_mfma_f32_16x16x32_bf16 v[40:43], a[200:203], a[120:123], v[40:43]
v_exp_f32 v34, v34
v_mfma_f32_16x16x32_bf16 v[40:43], a[204:207], a[124:127], v[40:43]
v_exp_f32 v35, v35
v_smfmac_f32_16x16x64_bf16 v[20:23], v[24:27], v[48:55], v28
v_exp_f32 v36, v36
v_mfma_f32_16x16x32_bf16 v[128:131], a[224:227], v[52:55], v[128:131]
ds_read_b64_tr_b16 a[224:225], v2 offset:0
ds_read_b64_tr_b16 a[226:227], v2 offset:256
v_mfma_f32_16x16x32_bf16 v[132:135], a[228:231], v[52:55], v[132:135]
v_cvt_pk_bf16_f32 v48, v32, v33
v_cvt_pk_bf16_f32 v49, v34, v35
v_mfma_f32_16x16x32_bf16 v[136:139], a[232:235], v[52:55], v[136:139]
ds_read_b64_tr_b16 a[228:229], v2 offset:8
ds_read_b64_tr_b16 a[230:231], v2 offset:264
v_mfma_f32_16x16x32_bf16 v[140:143], a[236:239], v[52:55], v[140:143]
v_exp_f32 v37, v37
v_mfma_f32_16x16x32_bf16 v[44:47], a[208:211], a[112:115], 0
v_add_f32 v11, v20, v21
v_mov_b64 v[20:21], 0
v_rcp_f32 v10, v11
v_subrev_u32 v11, s33, v11
v_max_u32 v9, v9, v11
v_pk_mul_f32 v[96:97], v[96:97], v[10:11] op_sel_hi:[1,0]
v_pk_mul_f32 v[98:99], v[98:99], v[10:11] op_sel_hi:[1,0]
v_pk_mul_f32 v[100:101], v[100:101], v[10:11] op_sel_hi:[1,0]
v_pk_mul_f32 v[102:103], v[102:103], v[10:11] op_sel_hi:[1,0]
v_cvt_pk_bf16_f32 v224, v96, v97
v_cvt_pk_bf16_f32 v225, v98, v99
v_cvt_pk_bf16_f32 v226, v100, v101
v_cvt_pk_bf16_f32 v227, v102, v103
v_pk_mul_f32 v[104:105], v[104:105], v[10:11] op_sel_hi:[1,0]
v_pk_mul_f32 v[106:107], v[106:107], v[10:11] op_sel_hi:[1,0]
v_pk_mul_f32 v[108:109], v[108:109], v[10:11] op_sel_hi:[1,0]
v_pk_mul_f32 v[110:111], v[110:111], v[10:11] op_sel_hi:[1,0]
v_cvt_pk_bf16_f32 v228, v104, v105
v_cvt_pk_bf16_f32 v229, v106, v107
v_cvt_pk_bf16_f32 v230, v108, v109
v_cvt_pk_bf16_f32 v231, v110, v111
v_pk_mul_f32 v[112:113], v[112:113], v[10:11] op_sel_hi:[1,0]
v_pk_mul_f32 v[114:115], v[114:115], v[10:11] op_sel_hi:[1,0]
v_pk_mul_f32 v[116:117], v[116:117], v[10:11] op_sel_hi:[1,0]
v_pk_mul_f32 v[118:119], v[118:119], v[10:11] op_sel_hi:[1,0]
v_cvt_pk_bf16_f32 v232, v112, v113
v_cvt_pk_bf16_f32 v233, v114, v115
v_cvt_pk_bf16_f32 v234, v116, v117
v_cvt_pk_bf16_f32 v235, v118, v119
v_pk_mul_f32 v[120:121], v[120:121], v[10:11] op_sel_hi:[1,0]
v_pk_mul_f32 v[122:123], v[122:123], v[10:11] op_sel_hi:[1,0]
v_pk_mul_f32 v[124:125], v[124:125], v[10:11] op_sel_hi:[1,0]
v_pk_mul_f32 v[126:127], v[126:127], v[10:11] op_sel_hi:[1,0]
v_cvt_pk_bf16_f32 v236, v120, v121
v_cvt_pk_bf16_f32 v237, v122, v123
v_cvt_pk_bf16_f32 v238, v124, v125
v_cvt_pk_bf16_f32 v239, v126, v127
v_mfma_f32_16x16x32_bf16 v[44:47], a[212:215], a[116:119], v[44:47]
v_exp_f32 v38, v38
v_mfma_f32_16x16x32_bf16 v[44:47], a[216:219], a[120:123], v[44:47]
ds_read_b64_tr_b16 a[232:233], v2 offset:64
ds_read_b64_tr_b16 a[234:235], v2 offset:320
v_mfma_f32_16x16x32_bf16 v[44:47], a[220:223], a[124:127], v[44:47]
v_exp_f32 v39, v39
v_mfma_f32_16x16x32_bf16 v[144:147], a[240:243], v[52:55], v[144:147]
ds_read_b64_tr_b16 a[236:237], v2 offset:72
ds_read_b64_tr_b16 a[238:239], v2 offset:328
v_mfma_f32_16x16x32_bf16 v[148:151], a[244:247], v[52:55], v[148:151]
buffer_load_dwordx4 v4, s[12:15], s26 offen offset:0 nt lds
v_mfma_f32_16x16x32_bf16 v[152:155], a[248:251], v[52:55], v[152:155]
s_sub_u32 m0, m0, 1016
ds_read_b64_tr_b16 a[240:241], v2 offset:128
ds_read_b64_tr_b16 a[242:243], v2 offset:384
v_mfma_f32_16x16x32_bf16 v[156:159], a[252:255], v[52:55], v[156:159]
ds_read_b64_tr_b16 a[252:253], v2 offset:200
v_cvt_pk_bf16_f32 v50, v36, v37
v_cvt_pk_bf16_f32 v51, v38, v39
v_mfma_f32_16x16x32_bf16 v[32:35], a[192:195], a[128:131], 0
ds_read_b64_tr_b16 a[254:255], v2 offset:456
v_exp_f32 v40, v40
v_mfma_f32_16x16x32_bf16 v[32:35], a[196:199], a[132:135], v[32:35]
ds_read_b64_tr_b16 a[244:245], v2 offset:136
ds_read_b64_tr_b16 a[246:247], v2 offset:392
v_mfma_f32_16x16x32_bf16 v[32:35], a[200:203], a[136:139], v[32:35]
v_exp_f32 v41, v41
v_mfma_f32_16x16x32_bf16 v[32:35], a[204:207], a[140:143], v[32:35]
s_waitcnt lgkmcnt(6)
ds_read_b64_tr_b16 a[248:249], v2 offset:192
ds_read_b64_tr_b16 a[250:251], v2 offset:448
v_mfma_f32_16x16x32_bf16 a[0:3], a[224:227], v[48:51], 0
v_exp_f32 v42, v42
v_mfma_f32_16x16x32_bf16 a[4:7], a[228:231], v[48:51], 0
buffer_load_dwordx4 v4, s[12:15], s26 offen offset:2048 nt lds
v_mfma_f32_16x16x32_bf16 a[8:11], a[232:235], v[48:51], 0
s_add_u32 s26, s26, 8192
v_exp_f32 v43, v43
v_mfma_f32_16x16x32_bf16 a[12:15], a[236:239], v[48:51], 0
v_cvt_pk_bf16_f32 v52, v40, v41
v_cvt_pk_bf16_f32 v53, v42, v43
v_mfma_f32_16x16x32_bf16 v[36:39], a[208:211], a[128:131], 0
v_exp_f32 v44, v44
v_add_f32 v11, v22, v23
v_mov_b64 v[22:23], 0
v_rcp_f32 v10, v11
v_subrev_u32 v11, s33, v11
v_max_u32 v9, v9, v11
v_cmp_lt_u32 s[54:55], s56, v9
v_pk_mul_f32 v[128:129], v[128:129], v[10:11] op_sel_hi:[1,0]
v_pk_mul_f32 v[130:131], v[130:131], v[10:11] op_sel_hi:[1,0]
v_pk_mul_f32 v[132:133], v[132:133], v[10:11] op_sel_hi:[1,0]
v_pk_mul_f32 v[134:135], v[134:135], v[10:11] op_sel_hi:[1,0]
v_cvt_pk_bf16_f32 v240, v128, v129
v_cvt_pk_bf16_f32 v241, v130, v131
v_cvt_pk_bf16_f32 v242, v132, v133
v_cvt_pk_bf16_f32 v243, v134, v135
v_mfma_f32_16x16x32_bf16 v[36:39], a[212:215], a[132:135], v[36:39]
v_mul_f32 v136, v10, v136
v_mul_f32 v137, v10, v137
v_mfma_f32_16x16x32_bf16 v[36:39], a[216:219], a[136:139], v[36:39]
s_waitcnt lgkmcnt(0)
v_exp_f32 v45, v45
v_mfma_f32_16x16x32_bf16 v[36:39], a[220:223], a[140:143], v[36:39]
s_cmp_lg_u64 s[54:55], 0
s_cselect_b32 s37, s38, 0
v_cvt_pk_bf16_f32 v244, v136, v137
v_mfma_f32_16x16x32_bf16 a[16:19], a[240:243], v[48:51], 0
s_or_b32 s29, s29, s37
v_exp_f32 v46, v46
v_mfma_f32_16x16x32_bf16 a[20:23], a[244:247], v[48:51], 0
s_lshl_b32 s38, s38, 1
v_mul_f32 v138, v10, v138
v_mul_f32 v139, v10, v139
v_mfma_f32_16x16x32_bf16 a[24:27], a[248:251], v[48:51], 0
v_exp_f32 v47, v47
v_mfma_f32_16x16x32_bf16 a[28:31], a[252:255], v[48:51], 0
v_cvt_pk_bf16_f32 v54, v44, v45
v_cvt_pk_bf16_f32 v55, v46, v47
v_mfma_f32_16x16x32_bf16 v[40:43], a[192:195], a[144:147], 0
s_add_u32 s50, s39, 0
v_exp_f32 v32, v32
v_cndmask_b32_dpp v60, v160, v164, vcc row_ror:8 row_mask:0xf bank_mask:0xf
v_mfma_f32_16x16x32_bf16 v[40:43], a[196:199], a[148:151], v[40:43]
v_cvt_pk_bf16_f32 v245, v138, v139
v_mul_f32 v140, v10, v140
v_cndmask_b32_dpp v61, v161, v165, vcc row_ror:8 row_mask:0xf bank_mask:0xf
v_mfma_f32_16x16x32_bf16 v[40:43], a[200:203], a[152:155], v[40:43]
v_exp_f32 v33, v33
v_cndmask_b32_dpp v62, v162, v166, vcc row_ror:8 row_mask:0xf bank_mask:0xf
v_mfma_f32_16x16x32_bf16 v[40:43], a[204:207], a[156:159], v[40:43]
v_mul_f32 v141, v10, v141
v_cvt_pk_bf16_f32 v246, v140, v141
v_cndmask_b32_dpp v63, v163, v167, vcc row_ror:8 row_mask:0xf bank_mask:0xf
v_smfmac_f32_16x16x64_bf16 v[12:15], v[24:27], v[48:55], v28
v_mul_f32 v142, v10, v142
v_mul_f32 v143, v10, v143
v_mov_b32_dpp v160, v164 row_ror:8 row_mask:0xf bank_mask:0xc
v_mfma_f32_16x16x32_bf16 a[32:35], a[224:227], v[52:55], 0
v_exp_f32 v34, v34
v_mov_b32_dpp v161, v165 row_ror:8 row_mask:0xf bank_mask:0xc
v_mfma_f32_16x16x32_bf16 a[36:39], a[228:231], v[52:55], 0
v_cvt_pk_bf16_f32 v247, v142, v143
v_mul_f32 v144, v10, v144
v_mfma_f32_16x16x32_bf16 a[40:43], a[232:235], v[52:55], 0
v_exp_f32 v35, v35
v_mfma_f32_16x16x32_bf16 a[44:47], a[236:239], v[52:55], 0
v_cvt_pk_bf16_f32 v48, v32, v33
v_cvt_pk_bf16_f32 v49, v34, v35
v_mfma_f32_16x16x32_bf16 v[44:47], a[208:211], a[144:147], 0
v_exp_f32 v36, v36
v_mfma_f32_16x16x32_bf16 v[44:47], a[212:215], a[148:151], v[44:47]
v_mul_f32 v145, v10, v145
v_cvt_pk_bf16_f32 v248, v144, v145
v_mfma_f32_16x16x32_bf16 v[44:47], a[216:219], a[152:155], v[44:47]
v_exp_f32 v37, v37
v_mfma_f32_16x16x32_bf16 v[44:47], a[220:223], a[156:159], v[44:47]
v_mul_f32 v146, v10, v146
v_mul_f32 v147, v10, v147
v_mfma_f32_16x16x32_bf16 a[48:51], a[240:243], v[52:55], 0
v_exp_f32 v38, v38
v_mfma_f32_16x16x32_bf16 a[52:55], a[244:247], v[52:55], 0
v_cvt_pk_bf16_f32 v249, v146, v147
v_mul_f32 v148, v10, v148
v_mfma_f32_16x16x32_bf16 a[56:59], a[248:251], v[52:55], 0
s_waitcnt vmcnt(22)
v_exp_f32 v39, v39
v_mfma_f32_16x16x32_bf16 a[60:63], a[252:255], v[52:55], 0
s_barrier
v_cvt_pk_bf16_f32 v50, v36, v37
v_cvt_pk_bf16_f32 v51, v38, v39
v_mfma_f32_16x16x32_bf16 v[32:35], a[192:195], a[160:163], 0
s_add_u32 m0, s21, 59136
v_exp_f32 v40, v40
v_mfma_f32_16x16x32_bf16 v[32:35], a[196:199], a[164:167], v[32:35]
buffer_load_dwordx4 v3, s[8:11], s26 offen offset:0 nt lds
v_mfma_f32_16x16x32_bf16 v[32:35], a[200:203], a[168:171], v[32:35]
v_exp_f32 v41, v41
v_mfma_f32_16x16x32_bf16 v[32:35], a[204:207], a[172:175], v[32:35]
v_mul_f32 v149, v10, v149
v_cvt_pk_bf16_f32 v250, v148, v149
v_mfma_f32_16x16x32_bf16 a[64:67], a[224:227], v[48:51], 0
v_exp_f32 v42, v42
v_mfma_f32_16x16x32_bf16 a[68:71], a[228:231], v[48:51], 0
buffer_load_dwordx4 v3, s[8:11], s26 offen offset:1024 nt lds
v_mfma_f32_16x16x32_bf16 a[72:75], a[232:235], v[48:51], 0
v_exp_f32 v43, v43
v_mfma_f32_16x16x32_bf16 a[76:79], a[236:239], v[48:51], 0
v_cvt_pk_bf16_f32 v52, v40, v41
v_cvt_pk_bf16_f32 v53, v42, v43
v_mfma_f32_16x16x32_bf16 v[36:39], a[208:211], a[160:163], 0
v_exp_f32 v44, v44
v_mfma_f32_16x16x32_bf16 v[36:39], a[212:215], a[164:167], v[36:39]
v_mul_f32 v150, v10, v150
v_mul_f32 v151, v10, v151
v_mfma_f32_16x16x32_bf16 v[36:39], a[216:219], a[168:171], v[36:39]
v_exp_f32 v45, v45
v_mfma_f32_16x16x32_bf16 v[36:39], a[220:223], a[172:175], v[36:39]
v_cvt_pk_bf16_f32 v251, v150, v151
v_mul_f32 v152, v10, v152
v_mfma_f32_16x16x32_bf16 a[80:83], a[240:243], v[48:51], 0
v_exp_f32 v46, v46
v_mfma_f32_16x16x32_bf16 a[84:87], a[244:247], v[48:51], 0
v_mul_f32 v153, v10, v153
v_cvt_pk_bf16_f32 v252, v152, v153
v_mfma_f32_16x16x32_bf16 a[88:91], a[248:251], v[48:51], 0
v_exp_f32 v47, v47
v_mfma_f32_16x16x32_bf16 a[92:95], a[252:255], v[48:51], 0
v_cvt_pk_bf16_f32 v54, v44, v45
v_cvt_pk_bf16_f32 v55, v46, v47
v_mfma_f32_16x16x32_bf16 v[40:43], a[192:195], a[176:179], 0
s_add_u32 m0, s22, 59136
v_exp_f32 v32, v32
v_mfma_f32_16x16x32_bf16 v[40:43], a[196:199], a[180:183], v[40:43]
ds_read_b128 a[192:195], v1 offset:8448
ds_read_b128 a[196:199], v1 offset:8512
v_mfma_f32_16x16x32_bf16 v[40:43], a[200:203], a[184:187], v[40:43]
v_exp_f32 v33, v33
v_mfma_f32_16x16x32_bf16 v[40:43], a[204:207], a[188:191], v[40:43]
ds_read_b128 a[200:203], v1 offset:8576
ds_read_b128 a[204:207], v1 offset:8640
v_smfmac_f32_16x16x64_bf16 v[16:19], v[24:27], v[48:55], v28
buffer_load_dwordx4 v4, s[12:15], s26 offen offset:0 nt lds
v_mfma_f32_16x16x32_bf16 v[64:67], a[224:227], v[52:55], 0
s_sub_u32 m0, m0, 1016
v_exp_f32 v34, v34
v_mfma_f32_16x16x32_bf16 v[68:71], a[228:231], v[52:55], 0
buffer_load_dwordx4 v4, s[12:15], s26 offen offset:2048 nt lds
v_mfma_f32_16x16x32_bf16 v[72:75], a[232:235], v[52:55], 0
s_add_u32 s26, s26, 8192
v_exp_f32 v35, v35
v_mfma_f32_16x16x32_bf16 v[76:79], a[236:239], v[52:55], 0
v_cvt_pk_bf16_f32 v48, v32, v33
v_cvt_pk_bf16_f32 v49, v34, v35
v_mfma_f32_16x16x32_bf16 v[44:47], a[208:211], a[176:179], 0
v_exp_f32 v36, v36
v_mfma_f32_16x16x32_bf16 v[44:47], a[212:215], a[180:183], v[44:47]
ds_read_b128 a[208:211], v1 offset:9472
ds_read_b128 a[212:215], v1 offset:9536
v_mfma_f32_16x16x32_bf16 v[44:47], a[216:219], a[184:187], v[44:47]
v_exp_f32 v37, v37
v_mfma_f32_16x16x32_bf16 v[44:47], a[220:223], a[188:191], v[44:47]
ds_read_b128 a[216:219], v1 offset:9600
ds_read_b128 a[220:223], v1 offset:9664
v_mfma_f32_16x16x32_bf16 v[80:83], a[240:243], v[52:55], 0
v_exp_f32 v38, v38
v_mfma_f32_16x16x32_bf16 v[84:87], a[244:247], v[52:55], 0
v_mul_f32 v154, v10, v154
v_mul_f32 v155, v10, v155
v_mfma_f32_16x16x32_bf16 v[88:91], a[248:251], v[52:55], 0
v_exp_f32 v39, v39
v_mfma_f32_16x16x32_bf16 v[92:95], a[252:255], v[52:55], 0
s_waitcnt lgkmcnt(4)
v_cvt_pk_bf16_f32 v50, v36, v37
v_cvt_pk_bf16_f32 v51, v38, v39
v_mfma_f32_16x16x32_bf16 v[32:35], a[192:195], a[96:99], 0
s_add_u32 s28, s25, 4096
v_exp_f32 v40, v40
v_mfma_f32_16x16x32_bf16 v[32:35], a[196:199], a[100:103], v[32:35]
s_add_u32 m0, s51, 4096
v_cvt_pk_bf16_f32 v253, v154, v155
v_mul_f32 v156, v10, v156
v_mfma_f32_16x16x32_bf16 v[32:35], a[200:203], a[104:107], v[32:35]
v_exp_f32 v41, v41
v_mfma_f32_16x16x32_bf16 v[32:35], a[204:207], a[108:111], v[32:35]
buffer_load_dwordx4 v5, s[4:7], s28 offen offset:0 nt lds
v_mfma_f32_16x16x32_bf16 v[96:99], a[224:227], v[48:51], 0
v_exp_f32 v42, v42
v_mfma_f32_16x16x32_bf16 v[100:103], a[228:231], v[48:51], 0
v_mul_f32 v157, v10, v157
v_cvt_pk_bf16_f32 v254, v156, v157
v_mfma_f32_16x16x32_bf16 v[104:107], a[232:235], v[48:51], 0
v_exp_f32 v43, v43
v_mfma_f32_16x16x32_bf16 v[108:111], a[236:239], v[48:51], 0
s_waitcnt lgkmcnt(0)
v_cvt_pk_bf16_f32 v52, v40, v41
v_cvt_pk_bf16_f32 v53, v42, v43
v_mfma_f32_16x16x32_bf16 v[36:39], a[208:211], a[96:99], 0
v_exp_f32 v44, v44
v_mfma_f32_16x16x32_bf16 v[36:39], a[212:215], a[100:103], v[36:39]
buffer_load_dwordx4 v5, s[4:7], s28 offen offset:2048 nt lds
v_mfma_f32_16x16x32_bf16 v[36:39], a[216:219], a[104:107], v[36:39]
v_exp_f32 v45, v45
v_mfma_f32_16x16x32_bf16 v[36:39], a[220:223], a[108:111], v[36:39]
v_mul_f32 v158, v10, v158
v_mul_f32 v159, v10, v159
v_mfma_f32_16x16x32_bf16 v[112:115], a[240:243], v[48:51], 0
v_exp_f32 v46, v46
v_mfma_f32_16x16x32_bf16 v[116:119], a[244:247], v[48:51], 0
v_cvt_pk_bf16_f32 v255, v158, v159
v_mov_b32_dpp v162, v166 row_ror:8 row_mask:0xf bank_mask:0xc
v_mfma_f32_16x16x32_bf16 v[120:123], a[248:251], v[48:51], 0
v_exp_f32 v47, v47
v_mfma_f32_16x16x32_bf16 v[124:127], a[252:255], v[48:51], 0
v_cvt_pk_bf16_f32 v54, v44, v45
v_cvt_pk_bf16_f32 v55, v46, v47
v_mfma_f32_16x16x32_bf16 v[40:43], a[192:195], a[112:115], 0
v_exp_f32 v32, v32
v_mfma_f32_16x16x32_bf16 v[40:43], a[196:199], a[116:119], v[40:43]
v_exp_f32 v33, v33
v_mfma_f32_16x16x32_bf16 v[40:43], a[200:203], a[120:123], v[40:43]
v_exp_f32 v34, v34
v_mfma_f32_16x16x32_bf16 v[40:43], a[204:207], a[124:127], v[40:43]
v_exp_f32 v35, v35
v_smfmac_f32_16x16x64_bf16 v[20:23], v[24:27], v[48:55], v28
v_exp_f32 v36, v36
v_mfma_f32_16x16x32_bf16 v[128:131], a[224:227], v[52:55], 0
ds_read_b64_tr_b16 a[224:225], v2 offset:8448
ds_read_b64_tr_b16 a[226:227], v2 offset:8704
v_mfma_f32_16x16x32_bf16 v[132:135], a[228:231], v[52:55], 0
v_cvt_pk_bf16_f32 v48, v32, v33
v_cvt_pk_bf16_f32 v49, v34, v35
v_mfma_f32_16x16x32_bf16 v[136:139], a[232:235], v[52:55], 0
ds_read_b64_tr_b16 a[228:229], v2 offset:8456
ds_read_b64_tr_b16 a[230:231], v2 offset:8712
v_mfma_f32_16x16x32_bf16 v[140:143], a[236:239], v[52:55], 0
v_exp_f32 v37, v37
v_mfma_f32_16x16x32_bf16 v[44:47], a[208:211], a[112:115], 0
ds_read_b64_tr_b16 a[232:233], v2 offset:8512
ds_read_b64_tr_b16 a[234:235], v2 offset:8768
v_mfma_f32_16x16x32_bf16 v[44:47], a[212:215], a[116:119], v[44:47]
v_exp_f32 v38, v38
v_mfma_f32_16x16x32_bf16 v[44:47], a[216:219], a[120:123], v[44:47]
ds_read_b64_tr_b16 a[236:237], v2 offset:8520
ds_read_b64_tr_b16 a[238:239], v2 offset:8776
v_mfma_f32_16x16x32_bf16 v[44:47], a[220:223], a[124:127], v[44:47]
v_exp_f32 v39, v39
v_mfma_f32_16x16x32_bf16 v[144:147], a[240:243], v[52:55], 0
ds_read_b64_tr_b16 a[240:241], v2 offset:8576
ds_read_b64_tr_b16 a[242:243], v2 offset:8832
v_mfma_f32_16x16x32_bf16 v[148:151], a[244:247], v[52:55], 0
v_mov_b32_dpp v163, v167 row_ror:8 row_mask:0xf bank_mask:0xc
v_mfma_f32_16x16x32_bf16 v[152:155], a[248:251], v[52:55], 0
ds_read_b64_tr_b16 a[244:245], v2 offset:8584
ds_read_b64_tr_b16 a[246:247], v2 offset:8840
v_mfma_f32_16x16x32_bf16 v[156:159], a[252:255], v[52:55], 0
buffer_store_dwordx4 v[160:163], v6, s[16:19], s50 offen offset:0 nt
v_cvt_pk_bf16_f32 v50, v36, v37
v_cvt_pk_bf16_f32 v51, v38, v39
v_mfma_f32_16x16x32_bf16 v[32:35], a[192:195], a[128:131], 0
v_exp_f32 v40, v40
v_mfma_f32_16x16x32_bf16 v[32:35], a[196:199], a[132:135], v[32:35]
ds_read_b64_tr_b16 a[248:249], v2 offset:8640
ds_read_b64_tr_b16 a[250:251], v2 offset:8896
v_mfma_f32_16x16x32_bf16 v[32:35], a[200:203], a[136:139], v[32:35]
v_exp_f32 v41, v41
v_mfma_f32_16x16x32_bf16 v[32:35], a[204:207], a[140:143], v[32:35]
s_waitcnt lgkmcnt(6)
ds_read_b64_tr_b16 a[252:253], v2 offset:8648
ds_read_b64_tr_b16 a[254:255], v2 offset:8904
v_mfma_f32_16x16x32_bf16 a[0:3], a[224:227], v[48:51], a[0:3]
buffer_store_dwordx4 v[60:63], v6, s[16:19], s50 offen offset:2048 nt
v_exp_f32 v42, v42
v_mfma_f32_16x16x32_bf16 a[4:7], a[228:231], v[48:51], a[4:7]
v_mfma_f32_16x16x32_bf16 a[8:11], a[232:235], v[48:51], a[8:11]
v_exp_f32 v43, v43
v_mfma_f32_16x16x32_bf16 a[12:15], a[236:239], v[48:51], a[12:15]
v_cvt_pk_bf16_f32 v52, v40, v41
v_cvt_pk_bf16_f32 v53, v42, v43
v_mfma_f32_16x16x32_bf16 v[36:39], a[208:211], a[128:131], 0
v_exp_f32 v44, v44
v_mfma_f32_16x16x32_bf16 v[36:39], a[212:215], a[132:135], v[36:39]
v_mfma_f32_16x16x32_bf16 v[36:39], a[216:219], a[136:139], v[36:39]
v_exp_f32 v45, v45
v_mfma_f32_16x16x32_bf16 v[36:39], a[220:223], a[140:143], v[36:39]
s_waitcnt lgkmcnt(0)
v_mfma_f32_16x16x32_bf16 a[16:19], a[240:243], v[48:51], a[16:19]
v_exp_f32 v46, v46
v_mfma_f32_16x16x32_bf16 a[20:23], a[244:247], v[48:51], a[20:23]
v_mfma_f32_16x16x32_bf16 a[24:27], a[248:251], v[48:51], a[24:27]
v_exp_f32 v47, v47
v_mfma_f32_16x16x32_bf16 a[28:31], a[252:255], v[48:51], a[28:31]
v_cvt_pk_bf16_f32 v54, v44, v45
v_cvt_pk_bf16_f32 v55, v46, v47
v_mfma_f32_16x16x32_bf16 v[40:43], a[192:195], a[144:147], 0
s_add_u32 m0, s21, 0
v_exp_f32 v32, v32
v_mfma_f32_16x16x32_bf16 v[40:43], a[196:199], a[148:151], v[40:43]
buffer_load_dwordx4 v3, s[8:11], s26 offen offset:0 nt lds
v_mfma_f32_16x16x32_bf16 v[40:43], a[200:203], a[152:155], v[40:43]
v_exp_f32 v33, v33
v_mfma_f32_16x16x32_bf16 v[40:43], a[204:207], a[156:159], v[40:43]
v_smfmac_f32_16x16x64_bf16 v[12:15], v[24:27], v[48:55], v28
v_mfma_f32_16x16x32_bf16 a[32:35], a[224:227], v[52:55], a[32:35]
v_exp_f32 v34, v34
v_mfma_f32_16x16x32_bf16 a[36:39], a[228:231], v[52:55], a[36:39]
buffer_load_dwordx4 v3, s[8:11], s26 offen offset:1024 nt lds
v_mfma_f32_16x16x32_bf16 a[40:43], a[232:235], v[52:55], a[40:43]
v_exp_f32 v35, v35
v_mfma_f32_16x16x32_bf16 a[44:47], a[236:239], v[52:55], a[44:47]
v_cvt_pk_bf16_f32 v48, v32, v33
v_cvt_pk_bf16_f32 v49, v34, v35
v_mfma_f32_16x16x32_bf16 v[44:47], a[208:211], a[144:147], 0
v_exp_f32 v36, v36
v_mfma_f32_16x16x32_bf16 v[44:47], a[212:215], a[148:151], v[44:47]
v_mfma_f32_16x16x32_bf16 v[44:47], a[216:219], a[152:155], v[44:47]
v_exp_f32 v37, v37
v_mfma_f32_16x16x32_bf16 v[44:47], a[220:223], a[156:159], v[44:47]
v_mfma_f32_16x16x32_bf16 a[48:51], a[240:243], v[52:55], a[48:51]
v_exp_f32 v38, v38
v_mfma_f32_16x16x32_bf16 a[52:55], a[244:247], v[52:55], a[52:55]
v_mfma_f32_16x16x32_bf16 a[56:59], a[248:251], v[52:55], a[56:59]
v_exp_f32 v39, v39
v_mfma_f32_16x16x32_bf16 a[60:63], a[252:255], v[52:55], a[60:63]
v_cvt_pk_bf16_f32 v50, v36, v37
v_cvt_pk_bf16_f32 v51, v38, v39
v_mfma_f32_16x16x32_bf16 v[32:35], a[192:195], a[160:163], 0
s_add_u32 s50, s39, 0
v_exp_f32 v40, v40
v_mfma_f32_16x16x32_bf16 v[32:35], a[196:199], a[164:167], v[32:35]
v_cndmask_b32_dpp v60, v168, v172, vcc row_ror:8 row_mask:0xf bank_mask:0xf
v_cndmask_b32_dpp v61, v169, v173, vcc row_ror:8 row_mask:0xf bank_mask:0xf
v_mfma_f32_16x16x32_bf16 v[32:35], a[200:203], a[168:171], v[32:35]
v_exp_f32 v41, v41
v_mfma_f32_16x16x32_bf16 v[32:35], a[204:207], a[172:175], v[32:35]
v_cndmask_b32_dpp v62, v170, v174, vcc row_ror:8 row_mask:0xf bank_mask:0xf
v_cndmask_b32_dpp v63, v171, v175, vcc row_ror:8 row_mask:0xf bank_mask:0xf
v_mfma_f32_16x16x32_bf16 a[64:67], a[224:227], v[48:51], a[64:67]
v_exp_f32 v42, v42
v_mfma_f32_16x16x32_bf16 a[68:71], a[228:231], v[48:51], a[68:71]
v_mov_b32_dpp v168, v172 row_ror:8 row_mask:0xf bank_mask:0xc
v_mov_b32_dpp v169, v173 row_ror:8 row_mask:0xf bank_mask:0xc
v_mfma_f32_16x16x32_bf16 a[72:75], a[232:235], v[48:51], a[72:75]
v_exp_f32 v43, v43
v_mfma_f32_16x16x32_bf16 a[76:79], a[236:239], v[48:51], a[76:79]
v_cvt_pk_bf16_f32 v52, v40, v41
v_cvt_pk_bf16_f32 v53, v42, v43
v_mfma_f32_16x16x32_bf16 v[36:39], a[208:211], a[160:163], 0
v_exp_f32 v44, v44
v_mfma_f32_16x16x32_bf16 v[36:39], a[212:215], a[164:167], v[36:39]
v_mov_b32_dpp v170, v174 row_ror:8 row_mask:0xf bank_mask:0xc
v_mov_b32_dpp v171, v175 row_ror:8 row_mask:0xf bank_mask:0xc
v_mfma_f32_16x16x32_bf16 v[36:39], a[216:219], a[168:171], v[36:39]
buffer_store_dwordx4 v[168:171], v6, s[16:19], s50 offen offset:128 nt
v_exp_f32 v45, v45
v_mfma_f32_16x16x32_bf16 v[36:39], a[220:223], a[172:175], v[36:39]
v_mfma_f32_16x16x32_bf16 a[80:83], a[240:243], v[48:51], a[80:83]
v_exp_f32 v46, v46
v_mfma_f32_16x16x32_bf16 a[84:87], a[244:247], v[48:51], a[84:87]
v_mfma_f32_16x16x32_bf16 a[88:91], a[248:251], v[48:51], a[88:91]
buffer_store_dwordx4 v[60:63], v6, s[16:19], s50 offen offset:2176 nt
v_exp_f32 v47, v47
v_mfma_f32_16x16x32_bf16 a[92:95], a[252:255], v[48:51], a[92:95]
v_cvt_pk_bf16_f32 v54, v44, v45
v_cvt_pk_bf16_f32 v55, v46, v47
v_mfma_f32_16x16x32_bf16 v[40:43], a[192:195], a[176:179], 0
v_exp_f32 v32, v32
v_mfma_f32_16x16x32_bf16 v[40:43], a[196:199], a[180:183], v[40:43]
ds_read_b128 a[192:195], v1 offset:16896
ds_read_b128 a[196:199], v1 offset:16960
v_mfma_f32_16x16x32_bf16 v[40:43], a[200:203], a[184:187], v[40:43]
v_exp_f32 v33, v33
v_mfma_f32_16x16x32_bf16 v[40:43], a[204:207], a[188:191], v[40:43]
ds_read_b128 a[200:203], v1 offset:17024
ds_read_b128 a[204:207], v1 offset:17088
v_smfmac_f32_16x16x64_bf16 v[16:19], v[24:27], v[48:55], v28
v_mfma_f32_16x16x32_bf16 v[64:67], a[224:227], v[52:55], v[64:67]
v_exp_f32 v34, v34
v_mfma_f32_16x16x32_bf16 v[68:71], a[228:231], v[52:55], v[68:71]
v_mfma_f32_16x16x32_bf16 v[72:75], a[232:235], v[52:55], v[72:75]
v_exp_f32 v35, v35
v_mfma_f32_16x16x32_bf16 v[76:79], a[236:239], v[52:55], v[76:79]
v_cvt_pk_bf16_f32 v48, v32, v33
v_cvt_pk_bf16_f32 v49, v34, v35
v_mfma_f32_16x16x32_bf16 v[44:47], a[208:211], a[176:179], 0
v_exp_f32 v36, v36
v_mfma_f32_16x16x32_bf16 v[44:47], a[212:215], a[180:183], v[44:47]
ds_read_b128 a[208:211], v1 offset:17920
ds_read_b128 a[212:215], v1 offset:17984
v_mfma_f32_16x16x32_bf16 v[44:47], a[216:219], a[184:187], v[44:47]
v_exp_f32 v37, v37
v_mfma_f32_16x16x32_bf16 v[44:47], a[220:223], a[188:191], v[44:47]
ds_read_b128 a[216:219], v1 offset:18048
ds_read_b128 a[220:223], v1 offset:18112
v_mfma_f32_16x16x32_bf16 v[80:83], a[240:243], v[52:55], v[80:83]
v_exp_f32 v38, v38
v_mfma_f32_16x16x32_bf16 v[84:87], a[244:247], v[52:55], v[84:87]
v_mfma_f32_16x16x32_bf16 v[88:91], a[248:251], v[52:55], v[88:91]
v_exp_f32 v39, v39
v_mfma_f32_16x16x32_bf16 v[92:95], a[252:255], v[52:55], v[92:95]
s_waitcnt lgkmcnt(4)
v_cvt_pk_bf16_f32 v50, v36, v37
v_cvt_pk_bf16_f32 v51, v38, v39
v_mfma_f32_16x16x32_bf16 v[32:35], a[192:195], a[96:99], 0
s_add_u32 m0, s22, 0
v_exp_f32 v40, v40
v_mfma_f32_16x16x32_bf16 v[32:35], a[196:199], a[100:103], v[32:35]
buffer_load_dwordx4 v4, s[12:15], s26 offen offset:0 nt lds
v_mfma_f32_16x16x32_bf16 v[32:35], a[200:203], a[104:107], v[32:35]
s_sub_u32 m0, m0, 1016
v_exp_f32 v41, v41
v_mfma_f32_16x16x32_bf16 v[32:35], a[204:207], a[108:111], v[32:35]
buffer_load_dwordx4 v4, s[12:15], s26 offen offset:2048 nt lds
v_mfma_f32_16x16x32_bf16 v[96:99], a[224:227], v[48:51], v[96:99]
s_add_u32 s26, s26, 8192
v_exp_f32 v42, v42
v_mfma_f32_16x16x32_bf16 v[100:103], a[228:231], v[48:51], v[100:103]
v_mfma_f32_16x16x32_bf16 v[104:107], a[232:235], v[48:51], v[104:107]
v_exp_f32 v43, v43
v_mfma_f32_16x16x32_bf16 v[108:111], a[236:239], v[48:51], v[108:111]
s_waitcnt lgkmcnt(0)
v_cvt_pk_bf16_f32 v52, v40, v41
v_cvt_pk_bf16_f32 v53, v42, v43
v_mfma_f32_16x16x32_bf16 v[36:39], a[208:211], a[96:99], 0
v_exp_f32 v44, v44
v_mfma_f32_16x16x32_bf16 v[36:39], a[212:215], a[100:103], v[36:39]
v_mfma_f32_16x16x32_bf16 v[36:39], a[216:219], a[104:107], v[36:39]
v_exp_f32 v45, v45
v_mfma_f32_16x16x32_bf16 v[36:39], a[220:223], a[108:111], v[36:39]
v_mfma_f32_16x16x32_bf16 v[112:115], a[240:243], v[48:51], v[112:115]
v_exp_f32 v46, v46
v_mfma_f32_16x16x32_bf16 v[116:119], a[244:247], v[48:51], v[116:119]
v_mfma_f32_16x16x32_bf16 v[120:123], a[248:251], v[48:51], v[120:123]
v_exp_f32 v47, v47
v_mfma_f32_16x16x32_bf16 v[124:127], a[252:255], v[48:51], v[124:127]
v_cvt_pk_bf16_f32 v54, v44, v45
v_cvt_pk_bf16_f32 v55, v46, v47
v_mfma_f32_16x16x32_bf16 v[40:43], a[192:195], a[112:115], 0
v_exp_f32 v32, v32
v_mfma_f32_16x16x32_bf16 v[40:43], a[196:199], a[116:119], v[40:43]
v_exp_f32 v33, v33
v_mfma_f32_16x16x32_bf16 v[40:43], a[200:203], a[120:123], v[40:43]
v_exp_f32 v34, v34
v_mfma_f32_16x16x32_bf16 v[40:43], a[204:207], a[124:127], v[40:43]
v_exp_f32 v35, v35
v_smfmac_f32_16x16x64_bf16 v[20:23], v[24:27], v[48:55], v28
v_exp_f32 v36, v36
v_mfma_f32_16x16x32_bf16 v[128:131], a[224:227], v[52:55], v[128:131]
ds_read_b64_tr_b16 a[224:225], v2 offset:16896
ds_read_b64_tr_b16 a[226:227], v2 offset:17152
v_mfma_f32_16x16x32_bf16 v[132:135], a[228:231], v[52:55], v[132:135]
v_cvt_pk_bf16_f32 v48, v32, v33
v_cvt_pk_bf16_f32 v49, v34, v35
v_mfma_f32_16x16x32_bf16 v[136:139], a[232:235], v[52:55], v[136:139]
ds_read_b64_tr_b16 a[228:229], v2 offset:16904
ds_read_b64_tr_b16 a[230:231], v2 offset:17160
v_mfma_f32_16x16x32_bf16 v[140:143], a[236:239], v[52:55], v[140:143]
v_exp_f32 v37, v37
v_mfma_f32_16x16x32_bf16 v[44:47], a[208:211], a[112:115], 0
ds_read_b64_tr_b16 a[232:233], v2 offset:16960
ds_read_b64_tr_b16 a[234:235], v2 offset:17216
v_mfma_f32_16x16x32_bf16 v[44:47], a[212:215], a[116:119], v[44:47]
v_exp_f32 v38, v38
v_mfma_f32_16x16x32_bf16 v[44:47], a[216:219], a[120:123], v[44:47]
ds_read_b64_tr_b16 a[236:237], v2 offset:16968
ds_read_b64_tr_b16 a[238:239], v2 offset:17224
v_mfma_f32_16x16x32_bf16 v[44:47], a[220:223], a[124:127], v[44:47]
v_exp_f32 v39, v39
v_mfma_f32_16x16x32_bf16 v[144:147], a[240:243], v[52:55], v[144:147]
ds_read_b64_tr_b16 a[240:241], v2 offset:17024
ds_read_b64_tr_b16 a[242:243], v2 offset:17280
v_mfma_f32_16x16x32_bf16 v[148:151], a[244:247], v[52:55], v[148:151]
v_mfma_f32_16x16x32_bf16 v[152:155], a[248:251], v[52:55], v[152:155]
ds_read_b64_tr_b16 a[244:245], v2 offset:17032
ds_read_b64_tr_b16 a[246:247], v2 offset:17288
ds_read_b64_tr_b16 a[248:249], v2 offset:17088
v_mfma_f32_16x16x32_bf16 v[156:159], a[252:255], v[52:55], v[156:159]
ds_read_b64_tr_b16 a[250:251], v2 offset:17344
ds_read_b64_tr_b16 a[252:253], v2 offset:17096
ds_read_b64_tr_b16 a[254:255], v2 offset:17352
v_cvt_pk_bf16_f32 v50, v36, v37
v_cvt_pk_bf16_f32 v51, v38, v39
s_branch Litem
Llast:
s_waitcnt lgkmcnt(0)
v_mfma_f32_16x16x32_bf16 v[32:35], a[192:195], a[128:131], 0
v_exp_f32 v40, v40
v_mfma_f32_16x16x32_bf16 v[32:35], a[196:199], a[132:135], v[32:35]
v_mfma_f32_16x16x32_bf16 v[32:35], a[200:203], a[136:139], v[32:35]
s_add_u32 s50, s39, 20480
v_exp_f32 v41, v41
v_mfma_f32_16x16x32_bf16 v[32:35], a[204:207], a[140:143], v[32:35]
v_cndmask_b32_dpp v60, v240, v244, vcc row_ror:8 row_mask:0xf bank_mask:0xf
v_cndmask_b32_dpp v61, v241, v245, vcc row_ror:8 row_mask:0xf bank_mask:0xf
v_mfma_f32_16x16x32_bf16 a[0:3], a[224:227], v[48:51], a[0:3]
v_exp_f32 v42, v42
v_mfma_f32_16x16x32_bf16 a[4:7], a[228:231], v[48:51], a[4:7]
v_cndmask_b32_dpp v62, v242, v246, vcc row_ror:8 row_mask:0xf bank_mask:0xf
v_cndmask_b32_dpp v63, v243, v247, vcc row_ror:8 row_mask:0xf bank_mask:0xf
v_mfma_f32_16x16x32_bf16 a[8:11], a[232:235], v[48:51], a[8:11]
v_exp_f32 v43, v43
v_mfma_f32_16x16x32_bf16 a[12:15], a[236:239], v[48:51], a[12:15]
v_cvt_pk_bf16_f32 v52, v40, v41
v_cvt_pk_bf16_f32 v53, v42, v43
v_mfma_f32_16x16x32_bf16 v[36:39], a[208:211], a[128:131], 0
v_exp_f32 v44, v44
v_mfma_f32_16x16x32_bf16 v[36:39], a[212:215], a[132:135], v[36:39]
v_mov_b32_dpp v240, v244 row_ror:8 row_mask:0xf bank_mask:0xc
v_mov_b32_dpp v241, v245 row_ror:8 row_mask:0xf bank_mask:0xc
v_mfma_f32_16x16x32_bf16 v[36:39], a[216:219], a[136:139], v[36:39]
v_exp_f32 v45, v45
v_mfma_f32_16x16x32_bf16 v[36:39], a[220:223], a[140:143], v[36:39]
v_mov_b32_dpp v242, v246 row_ror:8 row_mask:0xf bank_mask:0xc
v_mov_b32_dpp v243, v247 row_ror:8 row_mask:0xf bank_mask:0xc
v_mfma_f32_16x16x32_bf16 a[16:19], a[240:243], v[48:51], a[16:19]
buffer_store_dwordx4 v[240:243], v6, s[16:19], s50 offen offset:0 sc1
v_exp_f32 v46, v46
v_mfma_f32_16x16x32_bf16 a[20:23], a[244:247], v[48:51], a[20:23]
v_mfma_f32_16x16x32_bf16 a[24:27], a[248:251], v[48:51], a[24:27]
v_exp_f32 v47, v47
v_mfma_f32_16x16x32_bf16 a[28:31], a[252:255], v[48:51], a[28:31]
v_cvt_pk_bf16_f32 v54, v44, v45
v_cvt_pk_bf16_f32 v55, v46, v47
s_waitcnt vmcnt(17)
s_barrier
v_mfma_f32_16x16x32_bf16 v[40:43], a[192:195], a[144:147], 0
buffer_store_dwordx4 v[60:63], v6, s[16:19], s50 offen offset:2048 sc1
v_exp_f32 v32, v32
v_mfma_f32_16x16x32_bf16 v[40:43], a[196:199], a[148:151], v[40:43]
ds_read_b128 a[192:195], v1 offset:42240
ds_read_b128 a[196:199], v1 offset:42304
v_mfma_f32_16x16x32_bf16 v[40:43], a[200:203], a[152:155], v[40:43]
s_add_u32 s50, s39, 20480
v_exp_f32 v33, v33
v_mfma_f32_16x16x32_bf16 v[40:43], a[204:207], a[156:159], v[40:43]
ds_read_b128 a[200:203], v1 offset:42368
ds_read_b128 a[204:207], v1 offset:42432
v_smfmac_f32_16x16x64_bf16 v[12:15], v[24:27], v[48:55], v28
v_cndmask_b32_dpp v60, v248, v252, vcc row_ror:8 row_mask:0xf bank_mask:0xf
v_cndmask_b32_dpp v61, v249, v253, vcc row_ror:8 row_mask:0xf bank_mask:0xf
v_mfma_f32_16x16x32_bf16 a[32:35], a[224:227], v[52:55], a[32:35]
v_exp_f32 v34, v34
v_mfma_f32_16x16x32_bf16 a[36:39], a[228:231], v[52:55], a[36:39]
v_cndmask_b32_dpp v62, v250, v254, vcc row_ror:8 row_mask:0xf bank_mask:0xf
v_cndmask_b32_dpp v63, v251, v255, vcc row_ror:8 row_mask:0xf bank_mask:0xf
v_mfma_f32_16x16x32_bf16 a[40:43], a[232:235], v[52:55], a[40:43]
v_exp_f32 v35, v35
v_mfma_f32_16x16x32_bf16 a[44:47], a[236:239], v[52:55], a[44:47]
v_cvt_pk_bf16_f32 v48, v32, v33
v_cvt_pk_bf16_f32 v49, v34, v35
v_mfma_f32_16x16x32_bf16 v[44:47], a[208:211], a[144:147], 0
v_exp_f32 v36, v36
v_mfma_f32_16x16x32_bf16 v[44:47], a[212:215], a[148:151], v[44:47]
ds_read_b128 a[208:211], v1 offset:43264
ds_read_b128 a[212:215], v1 offset:43328
v_mfma_f32_16x16x32_bf16 v[44:47], a[216:219], a[152:155], v[44:47]
v_exp_f32 v37, v37
v_mfma_f32_16x16x32_bf16 v[44:47], a[220:223], a[156:159], v[44:47]
ds_read_b128 a[216:219], v1 offset:43392
ds_read_b128 a[220:223], v1 offset:43456
v_mfma_f32_16x16x32_bf16 a[48:51], a[240:243], v[52:55], a[48:51]
v_exp_f32 v38, v38
v_mfma_f32_16x16x32_bf16 a[52:55], a[244:247], v[52:55], a[52:55]
v_mov_b32_dpp v248, v252 row_ror:8 row_mask:0xf bank_mask:0xc
v_mov_b32_dpp v249, v253 row_ror:8 row_mask:0xf bank_mask:0xc
v_mfma_f32_16x16x32_bf16 a[56:59], a[248:251], v[52:55], a[56:59]
v_exp_f32 v39, v39
v_mfma_f32_16x16x32_bf16 a[60:63], a[252:255], v[52:55], a[60:63]
s_waitcnt lgkmcnt(4)
v_cvt_pk_bf16_f32 v50, v36, v37
v_cvt_pk_bf16_f32 v51, v38, v39
v_mfma_f32_16x16x32_bf16 v[32:35], a[192:195], a[96:99], 0
v_exp_f32 v40, v40
v_mfma_f32_16x16x32_bf16 v[32:35], a[196:199], a[100:103], v[32:35]
v_mov_b32_dpp v250, v254 row_ror:8 row_mask:0xf bank_mask:0xc
v_mov_b32_dpp v251, v255 row_ror:8 row_mask:0xf bank_mask:0xc
v_mfma_f32_16x16x32_bf16 v[32:35], a[200:203], a[104:107], v[32:35]
buffer_store_dwordx4 v[248:251], v6, s[16:19], s50 offen offset:128 sc1
v_exp_f32 v41, v41
v_mfma_f32_16x16x32_bf16 v[32:35], a[204:207], a[108:111], v[32:35]
v_mfma_f32_16x16x32_bf16 a[64:67], a[224:227], v[48:51], a[64:67]
v_exp_f32 v42, v42
v_mfma_f32_16x16x32_bf16 a[68:71], a[228:231], v[48:51], a[68:71]
v_mfma_f32_16x16x32_bf16 a[72:75], a[232:235], v[48:51], a[72:75]
buffer_store_dwordx4 v[60:63], v6, s[16:19], s50 offen offset:2176 sc1
v_exp_f32 v43, v43
v_mfma_f32_16x16x32_bf16 a[76:79], a[236:239], v[48:51], a[76:79]
s_waitcnt lgkmcnt(0)
v_cvt_pk_bf16_f32 v52, v40, v41
v_cvt_pk_bf16_f32 v53, v42, v43
v_mfma_f32_16x16x32_bf16 v[36:39], a[208:211], a[96:99], 0
v_exp_f32 v44, v44
v_mfma_f32_16x16x32_bf16 v[36:39], a[212:215], a[100:103], v[36:39]
v_mfma_f32_16x16x32_bf16 v[36:39], a[216:219], a[104:107], v[36:39]
v_exp_f32 v45, v45
v_mfma_f32_16x16x32_bf16 v[36:39], a[220:223], a[108:111], v[36:39]
v_mfma_f32_16x16x32_bf16 a[80:83], a[240:243], v[48:51], a[80:83]
v_exp_f32 v46, v46
v_mfma_f32_16x16x32_bf16 a[84:87], a[244:247], v[48:51], a[84:87]
v_mfma_f32_16x16x32_bf16 a[88:91], a[248:251], v[48:51], a[88:91]
v_exp_f32 v47, v47
v_mfma_f32_16x16x32_bf16 a[92:95], a[252:255], v[48:51], a[92:95]
v_cvt_pk_bf16_f32 v54, v44, v45
v_cvt_pk_bf16_f32 v55, v46, v47
v_mfma_f32_16x16x32_bf16 v[40:43], a[192:195], a[112:115], 0
v_exp_f32 v32, v32
v_mfma_f32_16x16x32_bf16 v[40:43], a[196:199], a[116:119], v[40:43]
v_exp_f32 v33, v33
v_mfma_f32_16x16x32_bf16 v[40:43], a[200:203], a[120:123], v[40:43]
v_exp_f32 v34, v34
v_mfma_f32_16x16x32_bf16 v[40:43], a[204:207], a[124:127], v[40:43]
v_exp_f32 v35, v35
v_smfmac_f32_16x16x64_bf16 v[16:19], v[24:27], v[48:55], v28
v_exp_f32 v36, v36
v_mfma_f32_16x16x32_bf16 v[64:67], a[224:227], v[52:55], v[64:67]
ds_read_b64_tr_b16 a[224:225], v2 offset:42240
ds_read_b64_tr_b16 a[226:227], v2 offset:42496
v_mfma_f32_16x16x32_bf16 v[68:71], a[228:231], v[52:55], v[68:71]
v_cvt_pk_bf16_f32 v48, v32, v33
v_cvt_pk_bf16_f32 v49, v34, v35
v_mfma_f32_16x16x32_bf16 v[72:75], a[232:235], v[52:55], v[72:75]
ds_read_b64_tr_b16 a[228:229], v2 offset:42248
ds_read_b64_tr_b16 a[230:231], v2 offset:42504
v_mfma_f32_16x16x32_bf16 v[76:79], a[236:239], v[52:55], v[76:79]
v_exp_f32 v37, v37
v_mfma_f32_16x16x32_bf16 v[44:47], a[208:211], a[112:115], 0
ds_read_b64_tr_b16 a[232:233], v2 offset:42304
ds_read_b64_tr_b16 a[234:235], v2 offset:42560
v_mfma_f32_16x16x32_bf16 v[44:47], a[212:215], a[116:119], v[44:47]
v_exp_f32 v38, v38
v_mfma_f32_16x16x32_bf16 v[44:47], a[216:219], a[120:123], v[44:47]
ds_read_b64_tr_b16 a[236:237], v2 offset:42312
ds_read_b64_tr_b16 a[238:239], v2 offset:42568
v_mfma_f32_16x16x32_bf16 v[44:47], a[220:223], a[124:127], v[44:47]
v_exp_f32 v39, v39
v_mfma_f32_16x16x32_bf16 v[80:83], a[240:243], v[52:55], v[80:83]
ds_read_b64_tr_b16 a[240:241], v2 offset:42368
ds_read_b64_tr_b16 a[242:243], v2 offset:42624
v_mfma_f32_16x16x32_bf16 v[84:87], a[244:247], v[52:55], v[84:87]
v_mfma_f32_16x16x32_bf16 v[88:91], a[248:251], v[52:55], v[88:91]
ds_read_b64_tr_b16 a[244:245], v2 offset:42376
ds_read_b64_tr_b16 a[246:247], v2 offset:42632
v_mfma_f32_16x16x32_bf16 v[92:95], a[252:255], v[52:55], v[92:95]
v_cvt_pk_bf16_f32 v50, v36, v37
v_cvt_pk_bf16_f32 v51, v38, v39
v_mfma_f32_16x16x32_bf16 v[32:35], a[192:195], a[128:131], 0
v_exp_f32 v40, v40
v_mfma_f32_16x16x32_bf16 v[32:35], a[196:199], a[132:135], v[32:35]
ds_read_b64_tr_b16 a[248:249], v2 offset:42432
ds_read_b64_tr_b16 a[250:251], v2 offset:42688
v_mfma_f32_16x16x32_bf16 v[32:35], a[200:203], a[136:139], v[32:35]
v_exp_f32 v41, v41
v_mfma_f32_16x16x32_bf16 v[32:35], a[204:207], a[140:143], v[32:35]
s_waitcnt lgkmcnt(6)
ds_read_b64_tr_b16 a[252:253], v2 offset:42440
ds_read_b64_tr_b16 a[254:255], v2 offset:42696
v_mfma_f32_16x16x32_bf16 a[0:3], a[224:227], v[48:51], a[0:3]
v_exp_f32 v42, v42
v_mfma_f32_16x16x32_bf16 a[4:7], a[228:231], v[48:51], a[4:7]
v_mfma_f32_16x16x32_bf16 a[8:11], a[232:235], v[48:51], a[8:11]
v_exp_f32 v43, v43
v_mfma_f32_16x16x32_bf16 a[12:15], a[236:239], v[48:51], a[12:15]
v_cvt_pk_bf16_f32 v52, v40, v41
v_cvt_pk_bf16_f32 v53, v42, v43
v_mfma_f32_16x16x32_bf16 v[36:39], a[208:211], a[128:131], 0
v_exp_f32 v44, v44
v_mfma_f32_16x16x32_bf16 v[36:39], a[212:215], a[132:135], v[36:39]
v_mfma_f32_16x16x32_bf16 v[36:39], a[216:219], a[136:139], v[36:39]
v_exp_f32 v45, v45
v_mfma_f32_16x16x32_bf16 v[36:39], a[220:223], a[140:143], v[36:39]
s_waitcnt lgkmcnt(0)
v_mfma_f32_16x16x32_bf16 a[16:19], a[240:243], v[48:51], a[16:19]
v_exp_f32 v46, v46
v_mfma_f32_16x16x32_bf16 a[20:23], a[244:247], v[48:51], a[20:23]
v_mfma_f32_16x16x32_bf16 a[24:27], a[248:251], v[48:51], a[24:27]
v_exp_f32 v47, v47
v_mfma_f32_16x16x32_bf16 a[28:31], a[252:255], v[48:51], a[28:31]
v_cvt_pk_bf16_f32 v54, v44, v45
v_cvt_pk_bf16_f32 v55, v46, v47
v_mfma_f32_16x16x32_bf16 v[40:43], a[192:195], a[144:147], 0
v_exp_f32 v32, v32
v_mfma_f32_16x16x32_bf16 v[40:43], a[196:199], a[148:151], v[40:43]
ds_read_b128 a[192:195], v1 offset:50688
ds_read_b128 a[196:199], v1 offset:50752
v_mfma_f32_16x16x32_bf16 v[40:43], a[200:203], a[152:155], v[40:43]
v_exp_f32 v33, v33
v_mfma_f32_16x16x32_bf16 v[40:43], a[204:207], a[156:159], v[40:43]
ds_read_b128 a[200:203], v1 offset:50816
ds_read_b128 a[204:207], v1 offset:50880
v_smfmac_f32_16x16x64_bf16 v[12:15], v[24:27], v[48:55], v28
v_mfma_f32_16x16x32_bf16 a[32:35], a[224:227], v[52:55], a[32:35]
v_exp_f32 v34, v34
v_mfma_f32_16x16x32_bf16 a[36:39], a[228:231], v[52:55], a[36:39]
v_mfma_f32_16x16x32_bf16 a[40:43], a[232:235], v[52:55], a[40:43]
v_exp_f32 v35, v35
v_mfma_f32_16x16x32_bf16 a[44:47], a[236:239], v[52:55], a[44:47]
v_cvt_pk_bf16_f32 v48, v32, v33
v_cvt_pk_bf16_f32 v49, v34, v35
v_mfma_f32_16x16x32_bf16 v[44:47], a[208:211], a[144:147], 0
v_exp_f32 v36, v36
v_mfma_f32_16x16x32_bf16 v[44:47], a[212:215], a[148:151], v[44:47]
ds_read_b128 a[208:211], v1 offset:51712
ds_read_b128 a[212:215], v1 offset:51776
v_mfma_f32_16x16x32_bf16 v[44:47], a[216:219], a[152:155], v[44:47]
v_exp_f32 v37, v37
v_mfma_f32_16x16x32_bf16 v[44:47], a[220:223], a[156:159], v[44:47]
ds_read_b128 a[216:219], v1 offset:51840
ds_read_b128 a[220:223], v1 offset:51904
v_mfma_f32_16x16x32_bf16 a[48:51], a[240:243], v[52:55], a[48:51]
v_exp_f32 v38, v38
v_mfma_f32_16x16x32_bf16 a[52:55], a[244:247], v[52:55], a[52:55]
v_mfma_f32_16x16x32_bf16 a[56:59], a[248:251], v[52:55], a[56:59]
v_exp_f32 v39, v39
v_mfma_f32_16x16x32_bf16 a[60:63], a[252:255], v[52:55], a[60:63]
s_waitcnt lgkmcnt(4)
v_cvt_pk_bf16_f32 v50, v36, v37
v_cvt_pk_bf16_f32 v51, v38, v39
v_mfma_f32_16x16x32_bf16 v[32:35], a[192:195], a[96:99], 0
v_exp_f32 v40, v40
v_mfma_f32_16x16x32_bf16 v[32:35], a[196:199], a[100:103], v[32:35]
v_mfma_f32_16x16x32_bf16 v[32:35], a[200:203], a[104:107], v[32:35]
v_exp_f32 v41, v41
v_mfma_f32_16x16x32_bf16 v[32:35], a[204:207], a[108:111], v[32:35]
v_mfma_f32_16x16x32_bf16 a[64:67], a[224:227], v[48:51], a[64:67]
v_exp_f32 v42, v42
v_mfma_f32_16x16x32_bf16 a[68:71], a[228:231], v[48:51], a[68:71]
v_mfma_f32_16x16x32_bf16 a[72:75], a[232:235], v[48:51], a[72:75]
v_exp_f32 v43, v43
v_mfma_f32_16x16x32_bf16 a[76:79], a[236:239], v[48:51], a[76:79]
s_waitcnt lgkmcnt(0)
v_cvt_pk_bf16_f32 v52, v40, v41
v_cvt_pk_bf16_f32 v53, v42, v43
v_mfma_f32_16x16x32_bf16 v[36:39], a[208:211], a[96:99], 0
v_exp_f32 v44, v44
v_mfma_f32_16x16x32_bf16 v[36:39], a[212:215], a[100:103], v[36:39]
v_mfma_f32_16x16x32_bf16 v[36:39], a[216:219], a[104:107], v[36:39]
v_exp_f32 v45, v45
v_mfma_f32_16x16x32_bf16 v[36:39], a[220:223], a[108:111], v[36:39]
v_mfma_f32_16x16x32_bf16 a[80:83], a[240:243], v[48:51], a[80:83]
v_exp_f32 v46, v46
v_mfma_f32_16x16x32_bf16 a[84:87], a[244:247], v[48:51], a[84:87]
v_mfma_f32_16x16x32_bf16 a[88:91], a[248:251], v[48:51], a[88:91]
v_exp_f32 v47, v47
v_mfma_f32_16x16x32_bf16 a[92:95], a[252:255], v[48:51], a[92:95]
v_cvt_pk_bf16_f32 v54, v44, v45
v_cvt_pk_bf16_f32 v55, v46, v47
v_mfma_f32_16x16x32_bf16 v[40:43], a[192:195], a[112:115], 0
v_exp_f32 v32, v32
v_mfma_f32_16x16x32_bf16 v[40:43], a[196:199], a[116:119], v[40:43]
v_exp_f32 v33, v33
v_mfma_f32_16x16x32_bf16 v[40:43], a[200:203], a[120:123], v[40:43]
v_exp_f32 v34, v34
v_mfma_f32_16x16x32_bf16 v[40:43], a[204:207], a[124:127], v[40:43]
v_exp_f32 v35, v35
v_smfmac_f32_16x16x64_bf16 v[16:19], v[24:27], v[48:55], v28
v_exp_f32 v36, v36
v_mfma_f32_16x16x32_bf16 v[64:67], a[224:227], v[52:55], v[64:67]
ds_read_b64_tr_b16 a[224:225], v2 offset:50688
ds_read_b64_tr_b16 a[226:227], v2 offset:50944
v_mfma_f32_16x16x32_bf16 v[68:71], a[228:231], v[52:55], v[68:71]
v_cvt_pk_bf16_f32 v48, v32, v33
v_cvt_pk_bf16_f32 v49, v34, v35
v_mfma_f32_16x16x32_bf16 v[72:75], a[232:235], v[52:55], v[72:75]
ds_read_b64_tr_b16 a[228:229], v2 offset:50696
ds_read_b64_tr_b16 a[230:231], v2 offset:50952
v_mfma_f32_16x16x32_bf16 v[76:79], a[236:239], v[52:55], v[76:79]
v_exp_f32 v37, v37
v_mfma_f32_16x16x32_bf16 v[44:47], a[208:211], a[112:115], 0
ds_read_b64_tr_b16 a[232:233], v2 offset:50752
ds_read_b64_tr_b16 a[234:235], v2 offset:51008
v_mfma_f32_16x16x32_bf16 v[44:47], a[212:215], a[116:119], v[44:47]
v_exp_f32 v38, v38
v_mfma_f32_16x16x32_bf16 v[44:47], a[216:219], a[120:123], v[44:47]
ds_read_b64_tr_b16 a[236:237], v2 offset:50760
ds_read_b64_tr_b16 a[238:239], v2 offset:51016
v_mfma_f32_16x16x32_bf16 v[44:47], a[220:223], a[124:127], v[44:47]
v_exp_f32 v39, v39
v_mfma_f32_16x16x32_bf16 v[80:83], a[240:243], v[52:55], v[80:83]
ds_read_b64_tr_b16 a[240:241], v2 offset:50816
ds_read_b64_tr_b16 a[242:243], v2 offset:51072
v_mfma_f32_16x16x32_bf16 v[84:87], a[244:247], v[52:55], v[84:87]
v_mfma_f32_16x16x32_bf16 v[88:91], a[248:251], v[52:55], v[88:91]
ds_read_b64_tr_b16 a[244:245], v2 offset:50824
ds_read_b64_tr_b16 a[246:247], v2 offset:51080
v_mfma_f32_16x16x32_bf16 v[92:95], a[252:255], v[52:55], v[92:95]
v_cvt_pk_bf16_f32 v50, v36, v37
v_cvt_pk_bf16_f32 v51, v38, v39
v_mfma_f32_16x16x32_bf16 v[32:35], a[192:195], a[128:131], 0
v_exp_f32 v40, v40
v_mfma_f32_16x16x32_bf16 v[32:35], a[196:199], a[132:135], v[32:35]
ds_read_b64_tr_b16 a[248:249], v2 offset:50880
ds_read_b64_tr_b16 a[250:251], v2 offset:51136
v_mfma_f32_16x16x32_bf16 v[32:35], a[200:203], a[136:139], v[32:35]
v_exp_f32 v41, v41
v_mfma_f32_16x16x32_bf16 v[32:35], a[204:207], a[140:143], v[32:35]
s_waitcnt lgkmcnt(6)
ds_read_b64_tr_b16 a[252:253], v2 offset:50888
ds_read_b64_tr_b16 a[254:255], v2 offset:51144
v_mfma_f32_16x16x32_bf16 a[0:3], a[224:227], v[48:51], a[0:3]
v_exp_f32 v42, v42
v_mfma_f32_16x16x32_bf16 a[4:7], a[228:231], v[48:51], a[4:7]
v_mfma_f32_16x16x32_bf16 a[8:11], a[232:235], v[48:51], a[8:11]
v_exp_f32 v43, v43
v_mfma_f32_16x16x32_bf16 a[12:15], a[236:239], v[48:51], a[12:15]
v_cvt_pk_bf16_f32 v52, v40, v41
v_cvt_pk_bf16_f32 v53, v42, v43
v_mfma_f32_16x16x32_bf16 v[36:39], a[208:211], a[128:131], 0
v_exp_f32 v44, v44
v_mfma_f32_16x16x32_bf16 v[36:39], a[212:215], a[132:135], v[36:39]
v_mfma_f32_16x16x32_bf16 v[36:39], a[216:219], a[136:139], v[36:39]
v_exp_f32 v45, v45
v_mfma_f32_16x16x32_bf16 v[36:39], a[220:223], a[140:143], v[36:39]
s_waitcnt lgkmcnt(0)
v_mfma_f32_16x16x32_bf16 a[16:19], a[240:243], v[48:51], a[16:19]
v_exp_f32 v46, v46
v_mfma_f32_16x16x32_bf16 a[20:23], a[244:247], v[48:51], a[20:23]
v_mfma_f32_16x16x32_bf16 a[24:27], a[248:251], v[48:51], a[24:27]
v_exp_f32 v47, v47
v_mfma_f32_16x16x32_bf16 a[28:31], a[252:255], v[48:51], a[28:31]
v_cvt_pk_bf16_f32 v54, v44, v45
v_cvt_pk_bf16_f32 v55, v46, v47
s_waitcnt vmcnt(10)
s_barrier
v_mfma_f32_16x16x32_bf16 v[40:43], a[192:195], a[144:147], 0
v_exp_f32 v32, v32
v_mfma_f32_16x16x32_bf16 v[40:43], a[196:199], a[148:151], v[40:43]
ds_read_b128 a[192:195], v1 offset:59136
ds_read_b128 a[196:199], v1 offset:59200
v_mfma_f32_16x16x32_bf16 v[40:43], a[200:203], a[152:155], v[40:43]
v_exp_f32 v33, v33
v_mfma_f32_16x16x32_bf16 v[40:43], a[204:207], a[156:159], v[40:43]
ds_read_b128 a[200:203], v1 offset:59264
ds_read_b128 a[204:207], v1 offset:59328
v_smfmac_f32_16x16x64_bf16 v[12:15], v[24:27], v[48:55], v28
v_mfma_f32_16x16x32_bf16 a[32:35], a[224:227], v[52:55], a[32:35]
v_exp_f32 v34, v34
v_mfma_f32_16x16x32_bf16 a[36:39], a[228:231], v[52:55], a[36:39]
v_mfma_f32_16x16x32_bf16 a[40:43], a[232:235], v[52:55], a[40:43]
v_exp_f32 v35, v35
v_mfma_f32_16x16x32_bf16 a[44:47], a[236:239], v[52:55], a[44:47]
v_cvt_pk_bf16_f32 v48, v32, v33
v_cvt_pk_bf16_f32 v49, v34, v35
v_mfma_f32_16x16x32_bf16 v[44:47], a[208:211], a[144:147], 0
v_exp_f32 v36, v36
v_mfma_f32_16x16x32_bf16 v[44:47], a[212:215], a[148:151], v[44:47]
ds_read_b128 a[208:211], v1 offset:60160
ds_read_b128 a[212:215], v1 offset:60224
v_mfma_f32_16x16x32_bf16 v[44:47], a[216:219], a[152:155], v[44:47]
v_exp_f32 v37, v37
v_mfma_f32_16x16x32_bf16 v[44:47], a[220:223], a[156:159], v[44:47]
ds_read_b128 a[216:219], v1 offset:60288
ds_read_b128 a[220:223], v1 offset:60352
v_mfma_f32_16x16x32_bf16 a[48:51], a[240:243], v[52:55], a[48:51]
v_exp_f32 v38, v38
v_mfma_f32_16x16x32_bf16 a[52:55], a[244:247], v[52:55], a[52:55]
v_mfma_f32_16x16x32_bf16 a[56:59], a[248:251], v[52:55], a[56:59]
v_exp_f32 v39, v39
v_mfma_f32_16x16x32_bf16 a[60:63], a[252:255], v[52:55], a[60:63]
s_waitcnt lgkmcnt(4)
v_cvt_pk_bf16_f32 v50, v36, v37
v_cvt_pk_bf16_f32 v51, v38, v39
v_mfma_f32_16x16x32_bf16 v[32:35], a[192:195], a[96:99], 0
v_exp_f32 v40, v40
v_mfma_f32_16x16x32_bf16 v[32:35], a[196:199], a[100:103], v[32:35]
v_mfma_f32_16x16x32_bf16 v[32:35], a[200:203], a[104:107], v[32:35]
v_exp_f32 v41, v41
v_mfma_f32_16x16x32_bf16 v[32:35], a[204:207], a[108:111], v[32:35]
v_mfma_f32_16x16x32_bf16 a[64:67], a[224:227], v[48:51], a[64:67]
v_exp_f32 v42, v42
v_mfma_f32_16x16x32_bf16 a[68:71], a[228:231], v[48:51], a[68:71]
v_mfma_f32_16x16x32_bf16 a[72:75], a[232:235], v[48:51], a[72:75]
v_exp_f32 v43, v43
v_mfma_f32_16x16x32_bf16 a[76:79], a[236:239], v[48:51], a[76:79]
s_waitcnt lgkmcnt(0)
v_cvt_pk_bf16_f32 v52, v40, v41
v_cvt_pk_bf16_f32 v53, v42, v43
v_mfma_f32_16x16x32_bf16 v[36:39], a[208:211], a[96:99], 0
v_exp_f32 v44, v44
v_mfma_f32_16x16x32_bf16 v[36:39], a[212:215], a[100:103], v[36:39]
v_mfma_f32_16x16x32_bf16 v[36:39], a[216:219], a[104:107], v[36:39]
v_exp_f32 v45, v45
v_mfma_f32_16x16x32_bf16 v[36:39], a[220:223], a[108:111], v[36:39]
v_mfma_f32_16x16x32_bf16 a[80:83], a[240:243], v[48:51], a[80:83]
v_exp_f32 v46, v46
v_mfma_f32_16x16x32_bf16 a[84:87], a[244:247], v[48:51], a[84:87]
v_mfma_f32_16x16x32_bf16 a[88:91], a[248:251], v[48:51], a[88:91]
v_exp_f32 v47, v47
v_mfma_f32_16x16x32_bf16 a[92:95], a[252:255], v[48:51], a[92:95]
v_cvt_pk_bf16_f32 v54, v44, v45
v_cvt_pk_bf16_f32 v55, v46, v47
v_mfma_f32_16x16x32_bf16 v[40:43], a[192:195], a[112:115], 0
v_exp_f32 v32, v32
v_mfma_f32_16x16x32_bf16 v[40:43], a[196:199], a[116:119], v[40:43]
v_exp_f32 v33, v33
v_mfma_f32_16x16x32_bf16 v[40:43], a[200:203], a[120:123], v[40:43]
v_exp_f32 v34, v34
v_mfma_f32_16x16x32_bf16 v[40:43], a[204:207], a[124:127], v[40:43]
v_exp_f32 v35, v35
v_smfmac_f32_16x16x64_bf16 v[16:19], v[24:27], v[48:55], v28
v_exp_f32 v36, v36
v_mfma_f32_16x16x32_bf16 v[64:67], a[224:227], v[52:55], v[64:67]
ds_read_b64_tr_b16 a[224:225], v2 offset:59136
ds_read_b64_tr_b16 a[226:227], v2 offset:59392
v_mfma_f32_16x16x32_bf16 v[68:71], a[228:231], v[52:55], v[68:71]
v_cvt_pk_bf16_f32 v48, v32, v33
v_cvt_pk_bf16_f32 v49, v34, v35
v_mfma_f32_16x16x32_bf16 v[72:75], a[232:235], v[52:55], v[72:75]
ds_read_b64_tr_b16 a[228:229], v2 offset:59144
ds_read_b64_tr_b16 a[230:231], v2 offset:59400
v_mfma_f32_16x16x32_bf16 v[76:79], a[236:239], v[52:55], v[76:79]
v_exp_f32 v37, v37
v_mfma_f32_16x16x32_bf16 v[44:47], a[208:211], a[112:115], 0
ds_read_b64_tr_b16 a[232:233], v2 offset:59200
ds_read_b64_tr_b16 a[234:235], v2 offset:59456
v_mfma_f32_16x16x32_bf16 v[44:47], a[212:215], a[116:119], v[44:47]
v_exp_f32 v38, v38
v_mfma_f32_16x16x32_bf16 v[44:47], a[216:219], a[120:123], v[44:47]
ds_read_b64_tr_b16 a[236:237], v2 offset:59208
ds_read_b64_tr_b16 a[238:239], v2 offset:59464
v_mfma_f32_16x16x32_bf16 v[44:47], a[220:223], a[124:127], v[44:47]
v_exp_f32 v39, v39
v_mfma_f32_16x16x32_bf16 v[80:83], a[240:243], v[52:55], v[80:83]
ds_read_b64_tr_b16 a[240:241], v2 offset:59264
ds_read_b64_tr_b16 a[242:243], v2 offset:59520
v_mfma_f32_16x16x32_bf16 v[84:87], a[244:247], v[52:55], v[84:87]
v_mfma_f32_16x16x32_bf16 v[88:91], a[248:251], v[52:55], v[88:91]
ds_read_b64_tr_b16 a[244:245], v2 offset:59272
ds_read_b64_tr_b16 a[246:247], v2 offset:59528
v_mfma_f32_16x16x32_bf16 v[92:95], a[252:255], v[52:55], v[92:95]
v_cvt_pk_bf16_f32 v50, v36, v37
v_cvt_pk_bf16_f32 v51, v38, v39
v_mfma_f32_16x16x32_bf16 v[32:35], a[192:195], a[128:131], 0
v_exp_f32 v40, v40
v_mfma_f32_16x16x32_bf16 v[32:35], a[196:199], a[132:135], v[32:35]
ds_read_b64_tr_b16 a[248:249], v2 offset:59328
ds_read_b64_tr_b16 a[250:251], v2 offset:59584
v_mfma_f32_16x16x32_bf16 v[32:35], a[200:203], a[136:139], v[32:35]
v_exp_f32 v41, v41
v_mfma_f32_16x16x32_bf16 v[32:35], a[204:207], a[140:143], v[32:35]
s_waitcnt lgkmcnt(6)
ds_read_b64_tr_b16 a[252:253], v2 offset:59336
ds_read_b64_tr_b16 a[254:255], v2 offset:59592
v_mfma_f32_16x16x32_bf16 a[0:3], a[224:227], v[48:51], a[0:3]
v_exp_f32 v42, v42
v_mfma_f32_16x16x32_bf16 a[4:7], a[228:231], v[48:51], a[4:7]
v_mfma_f32_16x16x32_bf16 a[8:11], a[232:235], v[48:51], a[8:11]
v_exp_f32 v43, v43
v_mfma_f32_16x16x32_bf16 a[12:15], a[236:239], v[48:51], a[12:15]
v_cvt_pk_bf16_f32 v52, v40, v41
v_cvt_pk_bf16_f32 v53, v42, v43
v_mfma_f32_16x16x32_bf16 v[36:39], a[208:211], a[128:131], 0
v_exp_f32 v44, v44
v_mfma_f32_16x16x32_bf16 v[36:39], a[212:215], a[132:135], v[36:39]
v_mfma_f32_16x16x32_bf16 v[36:39], a[216:219], a[136:139], v[36:39]
v_exp_f32 v45, v45
v_mfma_f32_16x16x32_bf16 v[36:39], a[220:223], a[140:143], v[36:39]
s_waitcnt lgkmcnt(0)
v_mfma_f32_16x16x32_bf16 a[16:19], a[240:243], v[48:51], a[16:19]
v_exp_f32 v46, v46
v_mfma_f32_16x16x32_bf16 a[20:23], a[244:247], v[48:51], a[20:23]
v_mfma_f32_16x16x32_bf16 a[24:27], a[248:251], v[48:51], a[24:27]
v_exp_f32 v47, v47
v_mfma_f32_16x16x32_bf16 a[28:31], a[252:255], v[48:51], a[28:31]
v_cvt_pk_bf16_f32 v54, v44, v45
v_cvt_pk_bf16_f32 v55, v46, v47
v_mfma_f32_16x16x32_bf16 v[40:43], a[192:195], a[144:147], 0
v_exp_f32 v32, v32
v_mfma_f32_16x16x32_bf16 v[40:43], a[196:199], a[148:151], v[40:43]
ds_read_b128 a[192:195], v1 offset:33792
ds_read_b128 a[196:199], v1 offset:33856
v_mfma_f32_16x16x32_bf16 v[40:43], a[200:203], a[152:155], v[40:43]
v_exp_f32 v33, v33
v_mfma_f32_16x16x32_bf16 v[40:43], a[204:207], a[156:159], v[40:43]
ds_read_b128 a[200:203], v1 offset:33920
ds_read_b128 a[204:207], v1 offset:33984
v_smfmac_f32_16x16x64_bf16 v[12:15], v[24:27], v[48:55], v28
v_mfma_f32_16x16x32_bf16 a[32:35], a[224:227], v[52:55], a[32:35]
v_exp_f32 v34, v34
v_mfma_f32_16x16x32_bf16 a[36:39], a[228:231], v[52:55], a[36:39]
v_mfma_f32_16x16x32_bf16 a[40:43], a[232:235], v[52:55], a[40:43]
v_exp_f32 v35, v35
v_mfma_f32_16x16x32_bf16 a[44:47], a[236:239], v[52:55], a[44:47]
v_cvt_pk_bf16_f32 v48, v32, v33
v_cvt_pk_bf16_f32 v49, v34, v35
v_mfma_f32_16x16x32_bf16 v[44:47], a[208:211], a[144:147], 0
v_exp_f32 v36, v36
v_add_f32 v11, v12, v13
v_mov_b64 v[12:13], 0
v_rcp_f32 v10, v11
v_subrev_u32 v9, s33, v11
v_accvgpr_read_b32 v56, a0
v_accvgpr_read_b32 v57, a1
v_accvgpr_read_b32 v58, a2
v_accvgpr_read_b32 v59, a3
v_accvgpr_read_b32 v60, a4
v_accvgpr_read_b32 v61, a5
v_accvgpr_read_b32 v62, a6
v_accvgpr_read_b32 v63, a7
v_pk_mul_f32 v[56:57], v[56:57], v[10:11] op_sel_hi:[1,0]
v_pk_mul_f32 v[58:59], v[58:59], v[10:11] op_sel_hi:[1,0]
v_pk_mul_f32 v[60:61], v[60:61], v[10:11] op_sel_hi:[1,0]
v_pk_mul_f32 v[62:63], v[62:63], v[10:11] op_sel_hi:[1,0]
v_cvt_pk_bf16_f32 v160, v56, v57
v_cvt_pk_bf16_f32 v161, v58, v59
v_cvt_pk_bf16_f32 v162, v60, v61
v_cvt_pk_bf16_f32 v163, v62, v63
v_accvgpr_read_b32 v56, a8
v_accvgpr_read_b32 v57, a9
v_accvgpr_read_b32 v58, a10
v_accvgpr_read_b32 v59, a11
v_accvgpr_read_b32 v60, a12
v_accvgpr_read_b32 v61, a13
v_accvgpr_read_b32 v62, a14
v_accvgpr_read_b32 v63, a15
v_pk_mul_f32 v[56:57], v[56:57], v[10:11] op_sel_hi:[1,0]
v_pk_mul_f32 v[58:59], v[58:59], v[10:11] op_sel_hi:[1,0]
v_pk_mul_f32 v[60:61], v[60:61], v[10:11] op_sel_hi:[1,0]
v_pk_mul_f32 v[62:63], v[62:63], v[10:11] op_sel_hi:[1,0]
v_cvt_pk_bf16_f32 v56, v56, v57
v_cvt_pk_bf16_f32 v57, v58, v59
v_cvt_pk_bf16_f32 v58, v60, v61
v_cvt_pk_bf16_f32 v59, v62, v63
v_cndmask_b32_dpp v164, v160, v56, vcc row_ror:8 row_mask:0xf bank_mask:0xf
v_cndmask_b32_dpp v165, v161, v57, vcc row_ror:8 row_mask:0xf bank_mask:0xf
v_cndmask_b32_dpp v166, v162, v58, vcc row_ror:8 row_mask:0xf bank_mask:0xf
v_cndmask_b32_dpp v167, v163, v59, vcc row_ror:8 row_mask:0xf bank_mask:0xf
v_mov_b32_dpp v160, v56 row_ror:8 row_mask:0xf bank_mask:0xc
v_mov_b32_dpp v161, v57 row_ror:8 row_mask:0xf bank_mask:0xc
v_mov_b32_dpp v162, v58 row_ror:8 row_mask:0xf bank_mask:0xc
v_mov_b32_dpp v163, v59 row_ror:8 row_mask:0xf bank_mask:0xc
v_accvgpr_read_b32 v56, a16
v_accvgpr_read_b32 v57, a17
v_accvgpr_read_b32 v58, a18
v_accvgpr_read_b32 v59, a19
v_accvgpr_read_b32 v60, a20
v_accvgpr_read_b32 v61, a21
v_accvgpr_read_b32 v62, a22
v_accvgpr_read_b32 v63, a23
v_pk_mul_f32 v[56:57], v[56:57], v[10:11] op_sel_hi:[1,0]
v_pk_mul_f32 v[58:59], v[58:59], v[10:11] op_sel_hi:[1,0]
v_pk_mul_f32 v[60:61], v[60:61], v[10:11] op_sel_hi:[1,0]
v_pk_mul_f32 v[62:63], v[62:63], v[10:11] op_sel_hi:[1,0]
v_cvt_pk_bf16_f32 v168, v56, v57
v_cvt_pk_bf16_f32 v169, v58, v59
v_cvt_pk_bf16_f32 v170, v60, v61
v_cvt_pk_bf16_f32 v171, v62, v63
v_accvgpr_read_b32 v56, a24
v_accvgpr_read_b32 v57, a25
v_accvgpr_read_b32 v58, a26
v_accvgpr_read_b32 v59, a27
v_accvgpr_read_b32 v60, a28
v_accvgpr_read_b32 v61, a29
v_accvgpr_read_b32 v62, a30
v_accvgpr_read_b32 v63, a31
v_pk_mul_f32 v[56:57], v[56:57], v[10:11] op_sel_hi:[1,0]
v_pk_mul_f32 v[58:59], v[58:59], v[10:11] op_sel_hi:[1,0]
v_pk_mul_f32 v[60:61], v[60:61], v[10:11] op_sel_hi:[1,0]
v_pk_mul_f32 v[62:63], v[62:63], v[10:11] op_sel_hi:[1,0]
v_cvt_pk_bf16_f32 v56, v56, v57
v_cvt_pk_bf16_f32 v57, v58, v59
v_cvt_pk_bf16_f32 v58, v60, v61
v_cvt_pk_bf16_f32 v59, v62, v63
v_cndmask_b32_dpp v172, v168, v56, vcc row_ror:8 row_mask:0xf bank_mask:0xf
v_cndmask_b32_dpp v173, v169, v57, vcc row_ror:8 row_mask:0xf bank_mask:0xf
v_cndmask_b32_dpp v174, v170, v58, vcc row_ror:8 row_mask:0xf bank_mask:0xf
v_cndmask_b32_dpp v175, v171, v59, vcc row_ror:8 row_mask:0xf bank_mask:0xf
v_mov_b32_dpp v168, v56 row_ror:8 row_mask:0xf bank_mask:0xc
v_mov_b32_dpp v169, v57 row_ror:8 row_mask:0xf bank_mask:0xc
v_mov_b32_dpp v170, v58 row_ror:8 row_mask:0xf bank_mask:0xc
v_mov_b32_dpp v171, v59 row_ror:8 row_mask:0xf bank_mask:0xc
v_mfma_f32_16x16x32_bf16 v[44:47], a[212:215], a[148:151], v[44:47]
s_add_u32 s50, s24, 0
ds_read_b128 a[208:211], v1 offset:34816
ds_read_b128 a[212:215], v1 offset:34880
v_mfma_f32_16x16x32_bf16 v[44:47], a[216:219], a[152:155], v[44:47]
buffer_store_dwordx4 v[160:163], v6, s[16:19], s50 offen offset:0 sc1
v_exp_f32 v37, v37
v_mfma_f32_16x16x32_bf16 v[44:47], a[220:223], a[156:159], v[44:47]
ds_read_b128 a[216:219], v1 offset:34944
ds_read_b128 a[220:223], v1 offset:35008
v_mfma_f32_16x16x32_bf16 a[48:51], a[240:243], v[52:55], a[48:51]
v_exp_f32 v38, v38
v_mfma_f32_16x16x32_bf16 a[52:55], a[244:247], v[52:55], a[52:55]
v_mfma_f32_16x16x32_bf16 a[56:59], a[248:251], v[52:55], a[56:59]
buffer_store_dwordx4 v[164:167], v6, s[16:19], s50 offen offset:2048 sc1
v_exp_f32 v39, v39
v_mfma_f32_16x16x32_bf16 a[60:63], a[252:255], v[52:55], a[60:63]
s_waitcnt lgkmcnt(4)
v_cvt_pk_bf16_f32 v50, v36, v37
v_cvt_pk_bf16_f32 v51, v38, v39
v_mfma_f32_16x16x32_bf16 v[32:35], a[192:195], a[160:163], 0
v_exp_f32 v40, v40
v_mfma_f32_16x16x32_bf16 v[32:35], a[196:199], a[164:167], v[32:35]
v_mfma_f32_16x16x32_bf16 v[32:35], a[200:203], a[168:171], v[32:35]
v_exp_f32 v41, v41
v_mfma_f32_16x16x32_bf16 v[32:35], a[204:207], a[172:175], v[32:35]
v_mfma_f32_16x16x32_bf16 a[64:67], a[224:227], v[48:51], a[64:67]
v_exp_f32 v42, v42
v_mfma_f32_16x16x32_bf16 a[68:71], a[228:231], v[48:51], a[68:71]
v_mfma_f32_16x16x32_bf16 a[72:75], a[232:235], v[48:51], a[72:75]
buffer_store_dwordx4 v[168:171], v6, s[16:19], s50 offen offset:128 sc1
v_exp_f32 v43, v43
v_mfma_f32_16x16x32_bf16 a[76:79], a[236:239], v[48:51], a[76:79]
s_waitcnt lgkmcnt(0)
v_cvt_pk_bf16_f32 v52, v40, v41
v_cvt_pk_bf16_f32 v53, v42, v43
v_mfma_f32_16x16x32_bf16 v[36:39], a[208:211], a[160:163], 0
v_exp_f32 v44, v44
v_add_f32 v11, v14, v15
v_mov_b64 v[14:15], 0
v_rcp_f32 v10, v11
v_subrev_u32 v11, s33, v11
v_max_u32 v9, v9, v11
v_accvgpr_read_b32 v56, a32
v_accvgpr_read_b32 v57, a33
v_accvgpr_read_b32 v58, a34
v_accvgpr_read_b32 v59, a35
v_accvgpr_read_b32 v60, a36
v_accvgpr_read_b32 v61, a37
v_accvgpr_read_b32 v62, a38
v_accvgpr_read_b32 v63, a39
v_pk_mul_f32 v[56:57], v[56:57], v[10:11] op_sel_hi:[1,0]
v_pk_mul_f32 v[58:59], v[58:59], v[10:11] op_sel_hi:[1,0]
v_pk_mul_f32 v[60:61], v[60:61], v[10:11] op_sel_hi:[1,0]
v_pk_mul_f32 v[62:63], v[62:63], v[10:11] op_sel_hi:[1,0]
v_cvt_pk_bf16_f32 v176, v56, v57
v_cvt_pk_bf16_f32 v177, v58, v59
v_cvt_pk_bf16_f32 v178, v60, v61
v_cvt_pk_bf16_f32 v179, v62, v63
v_accvgpr_read_b32 v56, a40
v_accvgpr_read_b32 v57, a41
v_accvgpr_read_b32 v58, a42
v_accvgpr_read_b32 v59, a43
v_accvgpr_read_b32 v60, a44
v_accvgpr_read_b32 v61, a45
v_accvgpr_read_b32 v62, a46
v_accvgpr_read_b32 v63, a47
v_pk_mul_f32 v[56:57], v[56:57], v[10:11] op_sel_hi:[1,0]
v_pk_mul_f32 v[58:59], v[58:59], v[10:11] op_sel_hi:[1,0]
v_pk_mul_f32 v[60:61], v[60:61], v[10:11] op_sel_hi:[1,0]
v_pk_mul_f32 v[62:63], v[62:63], v[10:11] op_sel_hi:[1,0]
v_cvt_pk_bf16_f32 v56, v56, v57
v_cvt_pk_bf16_f32 v57, v58, v59
v_cvt_pk_bf16_f32 v58, v60, v61
v_cvt_pk_bf16_f32 v59, v62, v63
v_cndmask_b32_dpp v180, v176, v56, vcc row_ror:8 row_mask:0xf bank_mask:0xf
v_cndmask_b32_dpp v181, v177, v57, vcc row_ror:8 row_mask:0xf bank_mask:0xf
v_cndmask_b32_dpp v182, v178, v58, vcc row_ror:8 row_mask:0xf bank_mask:0xf
v_cndmask_b32_dpp v183, v179, v59, vcc row_ror:8 row_mask:0xf bank_mask:0xf
v_mov_b32_dpp v176, v56 row_ror:8 row_mask:0xf bank_mask:0xc
v_mov_b32_dpp v177, v57 row_ror:8 row_mask:0xf bank_mask:0xc
v_mov_b32_dpp v178, v58 row_ror:8 row_mask:0xf bank_mask:0xc
v_mov_b32_dpp v179, v59 row_ror:8 row_mask:0xf bank_mask:0xc
v_accvgpr_read_b32 v56, a48
v_accvgpr_read_b32 v57, a49
v_accvgpr_read_b32 v58, a50
v_accvgpr_read_b32 v59, a51
v_accvgpr_read_b32 v60, a52
v_accvgpr_read_b32 v61, a53
v_accvgpr_read_b32 v62, a54
v_accvgpr_read_b32 v63, a55
v_pk_mul_f32 v[56:57], v[56:57], v[10:11] op_sel_hi:[1,0]
v_pk_mul_f32 v[58:59], v[58:59], v[10:11] op_sel_hi:[1,0]
v_pk_mul_f32 v[60:61], v[60:61], v[10:11] op_sel_hi:[1,0]
v_pk_mul_f32 v[62:63], v[62:63], v[10:11] op_sel_hi:[1,0]
v_cvt_pk_bf16_f32 v184, v56, v57
v_cvt_pk_bf16_f32 v185, v58, v59
v_cvt_pk_bf16_f32 v186, v60, v61
v_cvt_pk_bf16_f32 v187, v62, v63
v_accvgpr_read_b32 v56, a56
v_accvgpr_read_b32 v57, a57
v_accvgpr_read_b32 v58, a58
v_accvgpr_read_b32 v59, a59
v_accvgpr_read_b32 v60, a60
v_accvgpr_read_b32 v61, a61
v_accvgpr_read_b32 v62, a62
v_accvgpr_read_b32 v63, a63
v_pk_mul_f32 v[56:57], v[56:57], v[10:11] op_sel_hi:[1,0]
v_pk_mul_f32 v[58:59], v[58:59], v[10:11] op_sel_hi:[1,0]
v_pk_mul_f32 v[60:61], v[60:61], v[10:11] op_sel_hi:[1,0]
v_pk_mul_f32 v[62:63], v[62:63], v[10:11] op_sel_hi:[1,0]
v_cvt_pk_bf16_f32 v56, v56, v57
v_cvt_pk_bf16_f32 v57, v58, v59
v_cvt_pk_bf16_f32 v58, v60, v61
v_cvt_pk_bf16_f32 v59, v62, v63
v_cndmask_b32_dpp v188, v184, v56, vcc row_ror:8 row_mask:0xf bank_mask:0xf
v_cndmask_b32_dpp v189, v185, v57, vcc row_ror:8 row_mask:0xf bank_mask:0xf
v_cndmask_b32_dpp v190, v186, v58, vcc row_ror:8 row_mask:0xf bank_mask:0xf
v_cndmask_b32_dpp v191, v187, v59, vcc row_ror:8 row_mask:0xf bank_mask:0xf
v_mov_b32_dpp v184, v56 row_ror:8 row_mask:0xf bank_mask:0xc
v_mov_b32_dpp v185, v57 row_ror:8 row_mask:0xf bank_mask:0xc
v_mov_b32_dpp v186, v58 row_ror:8 row_mask:0xf bank_mask:0xc
v_mov_b32_dpp v187, v59 row_ror:8 row_mask:0xf bank_mask:0xc
v_mfma_f32_16x16x32_bf16 v[36:39], a[212:215], a[164:167], v[36:39]
v_mfma_f32_16x16x32_bf16 v[36:39], a[216:219], a[168:171], v[36:39]
buffer_store_dwordx4 v[172:175], v6, s[16:19], s50 offen offset:2176 sc1
v_exp_f32 v45, v45
v_mfma_f32_16x16x32_bf16 v[36:39], a[220:223], a[172:175], v[36:39]
v_mfma_f32_16x16x32_bf16 a[80:83], a[240:243], v[48:51], a[80:83]
v_exp_f32 v46, v46
v_mfma_f32_16x16x32_bf16 a[84:87], a[244:247], v[48:51], a[84:87]
v_mfma_f32_16x16x32_bf16 a[88:91], a[248:251], v[48:51], a[88:91]
v_exp_f32 v47, v47
v_mfma_f32_16x16x32_bf16 a[92:95], a[252:255], v[48:51], a[92:95]
v_cvt_pk_bf16_f32 v54, v44, v45
v_cvt_pk_bf16_f32 v55, v46, v47
v_mfma_f32_16x16x32_bf16 v[40:43], a[192:195], a[176:179], 0
v_exp_f32 v32, v32
v_mfma_f32_16x16x32_bf16 v[40:43], a[196:199], a[180:183], v[40:43]
v_exp_f32 v33, v33
v_mfma_f32_16x16x32_bf16 v[40:43], a[200:203], a[184:187], v[40:43]
v_exp_f32 v34, v34
v_mfma_f32_16x16x32_bf16 v[40:43], a[204:207], a[188:191], v[40:43]
s_add_u32 s50, s24, 4096
buffer_store_dwordx4 v[176:179], v6, s[16:19], s50 offen offset:0 sc1
v_exp_f32 v35, v35
v_smfmac_f32_16x16x64_bf16 v[16:19], v[24:27], v[48:55], v28
v_exp_f32 v36, v36
v_mfma_f32_16x16x32_bf16 v[64:67], a[224:227], v[52:55], v[64:67]
ds_read_b128 a[192:195], v1 offset:42240
ds_read_b128 a[196:199], v1 offset:42304
ds_read_b64_tr_b16 a[224:225], v2 offset:33792
v_mfma_f32_16x16x32_bf16 v[68:71], a[228:231], v[52:55], v[68:71]
ds_read_b64_tr_b16 a[226:227], v2 offset:34048
v_cvt_pk_bf16_f32 v48, v32, v33
v_cvt_pk_bf16_f32 v49, v34, v35
v_mfma_f32_16x16x32_bf16 v[72:75], a[232:235], v[52:55], v[72:75]
ds_read_b128 a[200:203], v1 offset:42368
ds_read_b128 a[204:207], v1 offset:42432
ds_read_b64_tr_b16 a[228:229], v2 offset:33800
v_mfma_f32_16x16x32_bf16 v[76:79], a[236:239], v[52:55], v[76:79]
ds_read_b64_tr_b16 a[230:231], v2 offset:34056
v_exp_f32 v37, v37
v_mfma_f32_16x16x32_bf16 v[44:47], a[208:211], a[176:179], 0
v_add_f32 v11, v16, v17
v_mov_b64 v[16:17], 0
v_rcp_f32 v10, v11
v_subrev_u32 v11, s33, v11
v_max_u32 v9, v9, v11
v_accvgpr_read_b32 v56, a64
v_accvgpr_read_b32 v57, a65
v_accvgpr_read_b32 v58, a66
v_accvgpr_read_b32 v59, a67
v_accvgpr_read_b32 v60, a68
v_accvgpr_read_b32 v61, a69
v_accvgpr_read_b32 v62, a70
v_accvgpr_read_b32 v63, a71
v_pk_mul_f32 v[56:57], v[56:57], v[10:11] op_sel_hi:[1,0]
v_pk_mul_f32 v[58:59], v[58:59], v[10:11] op_sel_hi:[1,0]
v_pk_mul_f32 v[60:61], v[60:61], v[10:11] op_sel_hi:[1,0]
v_pk_mul_f32 v[62:63], v[62:63], v[10:11] op_sel_hi:[1,0]
v_cvt_pk_bf16_f32 v192, v56, v57
v_cvt_pk_bf16_f32 v193, v58, v59
v_cvt_pk_bf16_f32 v194, v60, v61
v_cvt_pk_bf16_f32 v195, v62, v63
v_accvgpr_read_b32 v56, a72
v_accvgpr_read_b32 v57, a73
v_accvgpr_read_b32 v58, a74
v_accvgpr_read_b32 v59, a75
v_accvgpr_read_b32 v60, a76
v_accvgpr_read_b32 v61, a77
v_accvgpr_read_b32 v62, a78
v_accvgpr_read_b32 v63, a79
v_pk_mul_f32 v[56:57], v[56:57], v[10:11] op_sel_hi:[1,0]
v_pk_mul_f32 v[58:59], v[58:59], v[10:11] op_sel_hi:[1,0]
v_pk_mul_f32 v[60:61], v[60:61], v[10:11] op_sel_hi:[1,0]
v_pk_mul_f32 v[62:63], v[62:63], v[10:11] op_sel_hi:[1,0]
v_cvt_pk_bf16_f32 v56, v56, v57
v_cvt_pk_bf16_f32 v57, v58, v59
v_cvt_pk_bf16_f32 v58, v60, v61
v_cvt_pk_bf16_f32 v59, v62, v63
v_cndmask_b32_dpp v196, v192, v56, vcc row_ror:8 row_mask:0xf bank_mask:0xf
v_cndmask_b32_dpp v197, v193, v57, vcc row_ror:8 row_mask:0xf bank_mask:0xf
v_cndmask_b32_dpp v198, v194, v58, vcc row_ror:8 row_mask:0xf bank_mask:0xf
v_cndmask_b32_dpp v199, v195, v59, vcc row_ror:8 row_mask:0xf bank_mask:0xf
v_mov_b32_dpp v192, v56 row_ror:8 row_mask:0xf bank_mask:0xc
v_mov_b32_dpp v193, v57 row_ror:8 row_mask:0xf bank_mask:0xc
v_mov_b32_dpp v194, v58 row_ror:8 row_mask:0xf bank_mask:0xc
v_mov_b32_dpp v195, v59 row_ror:8 row_mask:0xf bank_mask:0xc
v_accvgpr_read_b32 v56, a80
v_accvgpr_read_b32 v57, a81
v_accvgpr_read_b32 v58, a82
v_accvgpr_read_b32 v59, a83
v_accvgpr_read_b32 v60, a84
v_accvgpr_read_b32 v61, a85
v_accvgpr_read_b32 v62, a86
v_accvgpr_read_b32 v63, a87
v_pk_mul_f32 v[56:57], v[56:57], v[10:11] op_sel_hi:[1,0]
v_pk_mul_f32 v[58:59], v[58:59], v[10:11] op_sel_hi:[1,0]
v_pk_mul_f32 v[60:61], v[60:61], v[10:11] op_sel_hi:[1,0]
v_pk_mul_f32 v[62:63], v[62:63], v[10:11] op_sel_hi:[1,0]
v_cvt_pk_bf16_f32 v200, v56, v57
v_cvt_pk_bf16_f32 v201, v58, v59
v_cvt_pk_bf16_f32 v202, v60, v61
v_cvt_pk_bf16_f32 v203, v62, v63
v_accvgpr_read_b32 v56, a88
v_accvgpr_read_b32 v57, a89
v_accvgpr_read_b32 v58, a90
v_accvgpr_read_b32 v59, a91
v_accvgpr_read_b32 v60, a92
v_accvgpr_read_b32 v61, a93
v_accvgpr_read_b32 v62, a94
v_accvgpr_read_b32 v63, a95
v_pk_mul_f32 v[56:57], v[56:57], v[10:11] op_sel_hi:[1,0]
v_pk_mul_f32 v[58:59], v[58:59], v[10:11] op_sel_hi:[1,0]
v_pk_mul_f32 v[60:61], v[60:61], v[10:11] op_sel_hi:[1,0]
v_pk_mul_f32 v[62:63], v[62:63], v[10:11] op_sel_hi:[1,0]
v_cvt_pk_bf16_f32 v56, v56, v57
v_cvt_pk_bf16_f32 v57, v58, v59
v_cvt_pk_bf16_f32 v58, v60, v61
v_cvt_pk_bf16_f32 v59, v62, v63
v_cndmask_b32_dpp v204, v200, v56, vcc row_ror:8 row_mask:0xf bank_mask:0xf
v_cndmask_b32_dpp v205, v201, v57, vcc row_ror:8 row_mask:0xf bank_mask:0xf
v_cndmask_b32_dpp v206, v202, v58, vcc row_ror:8 row_mask:0xf bank_mask:0xf
v_cndmask_b32_dpp v207, v203, v59, vcc row_ror:8 row_mask:0xf bank_mask:0xf
v_mov_b32_dpp v200, v56 row_ror:8 row_mask:0xf bank_mask:0xc
v_mov_b32_dpp v201, v57 row_ror:8 row_mask:0xf bank_mask:0xc
v_mov_b32_dpp v202, v58 row_ror:8 row_mask:0xf bank_mask:0xc
v_mov_b32_dpp v203, v59 row_ror:8 row_mask:0xf bank_mask:0xc
v_mfma_f32_16x16x32_bf16 v[44:47], a[212:215], a[180:183], v[44:47]
ds_read_b64_tr_b16 a[232:233], v2 offset:33856
v_exp_f32 v38, v38
v_mfma_f32_16x16x32_bf16 v[44:47], a[216:219], a[184:187], v[44:47]
ds_read_b128 a[208:211], v1 offset:43264
ds_read_b128 a[212:215], v1 offset:43328
ds_read_b64_tr_b16 a[234:235], v2 offset:34112
v_mfma_f32_16x16x32_bf16 v[44:47], a[220:223], a[188:191], v[44:47]
buffer_store_dwordx4 v[180:183], v6, s[16:19], s50 offen offset:2048 sc1
v_exp_f32 v39, v39
v_mfma_f32_16x16x32_bf16 v[80:83], a[240:243], v[52:55], v[80:83]
ds_read_b128 a[216:219], v1 offset:43392
ds_read_b128 a[220:223], v1 offset:43456
v_mfma_f32_16x16x32_bf16 v[84:87], a[244:247], v[52:55], v[84:87]
ds_read_b64_tr_b16 a[236:237], v2 offset:33864
ds_read_b64_tr_b16 a[238:239], v2 offset:34120
v_mfma_f32_16x16x32_bf16 v[88:91], a[248:251], v[52:55], v[88:91]
ds_read_b64_tr_b16 a[248:249], v2 offset:33984
ds_read_b64_tr_b16 a[250:251], v2 offset:34240
v_mfma_f32_16x16x32_bf16 v[92:95], a[252:255], v[52:55], v[92:95]
s_waitcnt lgkmcnt(12)
ds_read_b64_tr_b16 a[252:253], v2 offset:33992
v_cvt_pk_bf16_f32 v50, v36, v37
v_cvt_pk_bf16_f32 v51, v38, v39
v_mfma_f32_16x16x32_bf16 v[32:35], a[192:195], a[160:163], 0
ds_read_b64_tr_b16 a[254:255], v2 offset:34248
v_exp_f32 v40, v40
v_mfma_f32_16x16x32_bf16 v[32:35], a[196:199], a[164:167], v[32:35]
ds_read_b64_tr_b16 a[240:241], v2 offset:33920
ds_read_b64_tr_b16 a[242:243], v2 offset:34176
v_mfma_f32_16x16x32_bf16 v[32:35], a[200:203], a[168:171], v[32:35]
v_exp_f32 v41, v41
v_mfma_f32_16x16x32_bf16 v[32:35], a[204:207], a[172:175], v[32:35]
s_waitcnt lgkmcnt(6)
ds_read_b64_tr_b16 a[244:245], v2 offset:33928
ds_read_b64_tr_b16 a[246:247], v2 offset:34184
v_mfma_f32_16x16x32_bf16 v[96:99], a[224:227], v[48:51], v[96:99]
buffer_store_dwordx4 v[184:187], v6, s[16:19], s50 offen offset:128 sc1
v_exp_f32 v42, v42
v_mfma_f32_16x16x32_bf16 v[100:103], a[228:231], v[48:51], v[100:103]
v_mfma_f32_16x16x32_bf16 v[104:107], a[232:235], v[48:51], v[104:107]
v_exp_f32 v43, v43
v_mfma_f32_16x16x32_bf16 v[108:111], a[236:239], v[48:51], v[108:111]
v_cvt_pk_bf16_f32 v52, v40, v41
v_cvt_pk_bf16_f32 v53, v42, v43
v_mfma_f32_16x16x32_bf16 v[36:39], a[208:211], a[160:163], 0
v_exp_f32 v44, v44
v_add_f32 v11, v18, v19
v_mov_b64 v[18:19], 0
v_rcp_f32 v10, v11
v_subrev_u32 v11, s33, v11
v_max_u32 v9, v9, v11
v_pk_mul_f32 v[64:65], v[64:65], v[10:11] op_sel_hi:[1,0]
v_pk_mul_f32 v[66:67], v[66:67], v[10:11] op_sel_hi:[1,0]
v_pk_mul_f32 v[68:69], v[68:69], v[10:11] op_sel_hi:[1,0]
v_pk_mul_f32 v[70:71], v[70:71], v[10:11] op_sel_hi:[1,0]
v_cvt_pk_bf16_f32 v208, v64, v65
v_cvt_pk_bf16_f32 v209, v66, v67
v_cvt_pk_bf16_f32 v210, v68, v69
v_cvt_pk_bf16_f32 v211, v70, v71
v_pk_mul_f32 v[72:73], v[72:73], v[10:11] op_sel_hi:[1,0]
v_pk_mul_f32 v[74:75], v[74:75], v[10:11] op_sel_hi:[1,0]
v_pk_mul_f32 v[76:77], v[76:77], v[10:11] op_sel_hi:[1,0]
v_pk_mul_f32 v[78:79], v[78:79], v[10:11] op_sel_hi:[1,0]
v_cvt_pk_bf16_f32 v56, v72, v73
v_cvt_pk_bf16_f32 v57, v74, v75
v_cvt_pk_bf16_f32 v58, v76, v77
v_cvt_pk_bf16_f32 v59, v78, v79
v_cndmask_b32_dpp v212, v208, v56, vcc row_ror:8 row_mask:0xf bank_mask:0xf
v_cndmask_b32_dpp v213, v209, v57, vcc row_ror:8 row_mask:0xf bank_mask:0xf
v_cndmask_b32_dpp v214, v210, v58, vcc row_ror:8 row_mask:0xf bank_mask:0xf
v_cndmask_b32_dpp v215, v211, v59, vcc row_ror:8 row_mask:0xf bank_mask:0xf
v_mov_b32_dpp v208, v56 row_ror:8 row_mask:0xf bank_mask:0xc
v_mov_b32_dpp v209, v57 row_ror:8 row_mask:0xf bank_mask:0xc
v_mov_b32_dpp v210, v58 row_ror:8 row_mask:0xf bank_mask:0xc
v_mov_b32_dpp v211, v59 row_ror:8 row_mask:0xf bank_mask:0xc
v_pk_mul_f32 v[80:81], v[80:81], v[10:11] op_sel_hi:[1,0]
v_pk_mul_f32 v[82:83], v[82:83], v[10:11] op_sel_hi:[1,0]
v_pk_mul_f32 v[84:85], v[84:85], v[10:11] op_sel_hi:[1,0]
v_pk_mul_f32 v[86:87], v[86:87], v[10:11] op_sel_hi:[1,0]
v_cvt_pk_bf16_f32 v216, v80, v81
v_cvt_pk_bf16_f32 v217, v82, v83
v_cvt_pk_bf16_f32 v218, v84, v85
v_cvt_pk_bf16_f32 v219, v86, v87
v_pk_mul_f32 v[88:89], v[88:89], v[10:11] op_sel_hi:[1,0]
v_pk_mul_f32 v[90:91], v[90:91], v[10:11] op_sel_hi:[1,0]
v_pk_mul_f32 v[92:93], v[92:93], v[10:11] op_sel_hi:[1,0]
v_pk_mul_f32 v[94:95], v[94:95], v[10:11] op_sel_hi:[1,0]
v_cvt_pk_bf16_f32 v56, v88, v89
v_cvt_pk_bf16_f32 v57, v90, v91
v_cvt_pk_bf16_f32 v58, v92, v93
v_cvt_pk_bf16_f32 v59, v94, v95
v_cndmask_b32_dpp v220, v216, v56, vcc row_ror:8 row_mask:0xf bank_mask:0xf
v_cndmask_b32_dpp v221, v217, v57, vcc row_ror:8 row_mask:0xf bank_mask:0xf
v_cndmask_b32_dpp v222, v218, v58, vcc row_ror:8 row_mask:0xf bank_mask:0xf
v_cndmask_b32_dpp v223, v219, v59, vcc row_ror:8 row_mask:0xf bank_mask:0xf
v_mov_b32_dpp v216, v56 row_ror:8 row_mask:0xf bank_mask:0xc
v_mov_b32_dpp v217, v57 row_ror:8 row_mask:0xf bank_mask:0xc
v_mov_b32_dpp v218, v58 row_ror:8 row_mask:0xf bank_mask:0xc
v_mov_b32_dpp v219, v59 row_ror:8 row_mask:0xf bank_mask:0xc
v_mfma_f32_16x16x32_bf16 v[36:39], a[212:215], a[164:167], v[36:39]
v_mfma_f32_16x16x32_bf16 v[36:39], a[216:219], a[168:171], v[36:39]
buffer_store_dwordx4 v[188:191], v6, s[16:19], s50 offen offset:2176 sc1
v_exp_f32 v45, v45
v_mfma_f32_16x16x32_bf16 v[36:39], a[220:223], a[172:175], v[36:39]
s_waitcnt lgkmcnt(0)
v_mfma_f32_16x16x32_bf16 v[112:115], a[240:243], v[48:51], v[112:115]
v_exp_f32 v46, v46
v_mfma_f32_16x16x32_bf16 v[116:119], a[244:247], v[48:51], v[116:119]
v_mfma_f32_16x16x32_bf16 v[120:123], a[248:251], v[48:51], v[120:123]
v_exp_f32 v47, v47
v_mfma_f32_16x16x32_bf16 v[124:127], a[252:255], v[48:51], v[124:127]
v_cvt_pk_bf16_f32 v54, v44, v45
v_cvt_pk_bf16_f32 v55, v46, v47
v_mfma_f32_16x16x32_bf16 v[40:43], a[192:195], a[176:179], 0
v_exp_f32 v32, v32
v_mfma_f32_16x16x32_bf16 v[40:43], a[196:199], a[180:183], v[40:43]
v_exp_f32 v33, v33
v_mfma_f32_16x16x32_bf16 v[40:43], a[200:203], a[184:187], v[40:43]
v_exp_f32 v34, v34
v_mfma_f32_16x16x32_bf16 v[40:43], a[204:207], a[188:191], v[40:43]
s_add_u32 s50, s24, 8192
buffer_store_dwordx4 v[192:195], v6, s[16:19], s50 offen offset:0 sc1
v_exp_f32 v35, v35
v_smfmac_f32_16x16x64_bf16 v[20:23], v[24:27], v[48:55], v28
v_exp_f32 v36, v36
v_mfma_f32_16x16x32_bf16 v[128:131], a[224:227], v[52:55], v[128:131]
ds_read_b128 a[192:195], v1 offset:50688
ds_read_b128 a[196:199], v1 offset:50752
ds_read_b64_tr_b16 a[226:227], v2 offset:42496
v_mfma_f32_16x16x32_bf16 v[132:135], a[228:231], v[52:55], v[132:135]
ds_read_b64_tr_b16 a[228:229], v2 offset:42248
v_cvt_pk_bf16_f32 v48, v32, v33
v_cvt_pk_bf16_f32 v49, v34, v35
v_mfma_f32_16x16x32_bf16 v[136:139], a[232:235], v[52:55], v[136:139]
ds_read_b128 a[200:203], v1 offset:50816
ds_read_b128 a[204:207], v1 offset:50880
ds_read_b64_tr_b16 a[230:231], v2 offset:42504
v_mfma_f32_16x16x32_bf16 v[140:143], a[236:239], v[52:55], v[140:143]
ds_read_b64_tr_b16 a[234:235], v2 offset:42560
v_exp_f32 v37, v37
v_mfma_f32_16x16x32_bf16 v[44:47], a[208:211], a[176:179], 0
ds_read_b128 a[208:211], v1 offset:51712
ds_read_b64_tr_b16 a[224:225], v2 offset:42240
v_mfma_f32_16x16x32_bf16 v[44:47], a[212:215], a[180:183], v[44:47]
buffer_store_dwordx4 v[196:199], v6, s[16:19], s50 offen offset:2048 sc1
v_exp_f32 v38, v38
v_mfma_f32_16x16x32_bf16 v[44:47], a[216:219], a[184:187], v[44:47]
ds_read_b128 a[212:215], v1 offset:51776
ds_read_b128 a[216:219], v1 offset:51840
v_mfma_f32_16x16x32_bf16 v[44:47], a[220:223], a[188:191], v[44:47]
v_exp_f32 v39, v39
v_mfma_f32_16x16x32_bf16 v[144:147], a[240:243], v[52:55], v[144:147]
ds_read_b128 a[220:223], v1 offset:51904
ds_read_b64_tr_b16 a[232:233], v2 offset:42304
v_mfma_f32_16x16x32_bf16 v[148:151], a[244:247], v[52:55], v[148:151]
ds_read_b64_tr_b16 a[236:237], v2 offset:42312
ds_read_b64_tr_b16 a[238:239], v2 offset:42568
v_mfma_f32_16x16x32_bf16 v[152:155], a[248:251], v[52:55], v[152:155]
ds_read_b64_tr_b16 a[248:249], v2 offset:42432
ds_read_b64_tr_b16 a[250:251], v2 offset:42688
v_mfma_f32_16x16x32_bf16 v[156:159], a[252:255], v[52:55], v[156:159]
s_waitcnt lgkmcnt(12)
ds_read_b64_tr_b16 a[252:253], v2 offset:42440
v_cvt_pk_bf16_f32 v50, v36, v37
v_cvt_pk_bf16_f32 v51, v38, v39
v_mfma_f32_16x16x32_bf16 v[32:35], a[192:195], a[160:163], 0
ds_read_b64_tr_b16 a[254:255], v2 offset:42696
v_exp_f32 v40, v40
v_mfma_f32_16x16x32_bf16 v[32:35], a[196:199], a[164:167], v[32:35]
ds_read_b64_tr_b16 a[240:241], v2 offset:42368
ds_read_b64_tr_b16 a[242:243], v2 offset:42624
v_mfma_f32_16x16x32_bf16 v[32:35], a[200:203], a[168:171], v[32:35]
buffer_store_dwordx4 v[200:203], v6, s[16:19], s50 offen offset:128 sc1
v_exp_f32 v41, v41
v_mfma_f32_16x16x32_bf16 v[32:35], a[204:207], a[172:175], v[32:35]
s_waitcnt lgkmcnt(6)
ds_read_b64_tr_b16 a[244:245], v2 offset:42376
ds_read_b64_tr_b16 a[246:247], v2 offset:42632
v_mfma_f32_16x16x32_bf16 v[96:99], a[224:227], v[48:51], v[96:99]
v_exp_f32 v42, v42
v_mfma_f32_16x16x32_bf16 v[100:103], a[228:231], v[48:51], v[100:103]
v_mfma_f32_16x16x32_bf16 v[104:107], a[232:235], v[48:51], v[104:107]
buffer_store_dwordx4 v[204:207], v6, s[16:19], s50 offen offset:2176 sc1
v_exp_f32 v43, v43
v_mfma_f32_16x16x32_bf16 v[108:111], a[236:239], v[48:51], v[108:111]
v_cvt_pk_bf16_f32 v52, v40, v41
v_cvt_pk_bf16_f32 v53, v42, v43
v_mfma_f32_16x16x32_bf16 v[36:39], a[208:211], a[160:163], 0
v_exp_f32 v44, v44
v_mfma_f32_16x16x32_bf16 v[36:39], a[212:215], a[164:167], v[36:39]
v_mfma_f32_16x16x32_bf16 v[36:39], a[216:219], a[168:171], v[36:39]
v_exp_f32 v45, v45
v_mfma_f32_16x16x32_bf16 v[36:39], a[220:223], a[172:175], v[36:39]
s_waitcnt lgkmcnt(0)
v_mfma_f32_16x16x32_bf16 v[112:115], a[240:243], v[48:51], v[112:115]
v_exp_f32 v46, v46
v_mfma_f32_16x16x32_bf16 v[116:119], a[244:247], v[48:51], v[116:119]
v_mfma_f32_16x16x32_bf16 v[120:123], a[248:251], v[48:51], v[120:123]
v_exp_f32 v47, v47
v_mfma_f32_16x16x32_bf16 v[124:127], a[252:255], v[48:51], v[124:127]
s_add_u32 s50, s24, 12288
buffer_store_dwordx4 v[208:211], v6, s[16:19], s50 offen offset:0 sc1
v_cvt_pk_bf16_f32 v54, v44, v45
v_cvt_pk_bf16_f32 v55, v46, v47
v_mfma_f32_16x16x32_bf16 v[40:43], a[192:195], a[176:179], 0
v_exp_f32 v32, v32
v_mfma_f32_16x16x32_bf16 v[40:43], a[196:199], a[180:183], v[40:43]
v_exp_f32 v33, v33
v_mfma_f32_16x16x32_bf16 v[40:43], a[200:203], a[184:187], v[40:43]
v_exp_f32 v34, v34
v_mfma_f32_16x16x32_bf16 v[40:43], a[204:207], a[188:191], v[40:43]
buffer_store_dwordx4 v[212:215], v6, s[16:19], s50 offen offset:2048 sc1
v_exp_f32 v35, v35
v_smfmac_f32_16x16x64_bf16 v[20:23], v[24:27], v[48:55], v28
v_exp_f32 v36, v36
v_mfma_f32_16x16x32_bf16 v[128:131], a[224:227], v[52:55], v[128:131]
ds_read_b128 a[192:195], v1 offset:59136
ds_read_b128 a[196:199], v1 offset:59200
ds_read_b64_tr_b16 a[226:227], v2 offset:50944
v_mfma_f32_16x16x32_bf16 v[132:135], a[228:231], v[52:55], v[132:135]
ds_read_b64_tr_b16 a[228:229], v2 offset:50696
v_cvt_pk_bf16_f32 v48, v32, v33
v_cvt_pk_bf16_f32 v49, v34, v35
v_mfma_f32_16x16x32_bf16 v[136:139], a[232:235], v[52:55], v[136:139]
ds_read_b128 a[200:203], v1 offset:59264
ds_read_b128 a[204:207], v1 offset:59328
ds_read_b64_tr_b16 a[230:231], v2 offset:50952
v_mfma_f32_16x16x32_bf16 v[140:143], a[236:239], v[52:55], v[140:143]
ds_read_b64_tr_b16 a[234:235], v2 offset:51008
v_exp_f32 v37, v37
v_mfma_f32_16x16x32_bf16 v[44:47], a[208:211], a[176:179], 0
ds_read_b128 a[208:211], v1 offset:60160
ds_read_b64_tr_b16 a[224:225], v2 offset:50688
v_mfma_f32_16x16x32_bf16 v[44:47], a[212:215], a[180:183], v[44:47]
v_exp_f32 v38, v38
v_mfma_f32_16x16x32_bf16 v[44:47], a[216:219], a[184:187], v[44:47]
ds_read_b128 a[212:215], v1 offset:60224
ds_read_b128 a[216:219], v1 offset:60288
v_mfma_f32_16x16x32_bf16 v[44:47], a[220:223], a[188:191], v[44:47]
buffer_store_dwordx4 v[216:219], v6, s[16:19], s50 offen offset:128 sc1
v_exp_f32 v39, v39
v_mfma_f32_16x16x32_bf16 v[144:147], a[240:243], v[52:55], v[144:147]
ds_read_b128 a[220:223], v1 offset:60352
ds_read_b64_tr_b16 a[232:233], v2 offset:50752
v_mfma_f32_16x16x32_bf16 v[148:151], a[244:247], v[52:55], v[148:151]
ds_read_b64_tr_b16 a[236:237], v2 offset:50760
ds_read_b64_tr_b16 a[238:239], v2 offset:51016
v_mfma_f32_16x16x32_bf16 v[152:155], a[248:251], v[52:55], v[152:155]
ds_read_b64_tr_b16 a[248:249], v2 offset:50880
ds_read_b64_tr_b16 a[250:251], v2 offset:51136
v_mfma_f32_16x16x32_bf16 v[156:159], a[252:255], v[52:55], v[156:159]
s_waitcnt lgkmcnt(12)
ds_read_b64_tr_b16 a[252:253], v2 offset:50888
v_cvt_pk_bf16_f32 v50, v36, v37
v_cvt_pk_bf16_f32 v51, v38, v39
v_mfma_f32_16x16x32_bf16 v[32:35], a[192:195], a[160:163], 0
ds_read_b64_tr_b16 a[254:255], v2 offset:51144
v_exp_f32 v40, v40
v_mfma_f32_16x16x32_bf16 v[32:35], a[196:199], a[164:167], v[32:35]
ds_read_b64_tr_b16 a[240:241], v2 offset:50816
ds_read_b64_tr_b16 a[242:243], v2 offset:51072
v_mfma_f32_16x16x32_bf16 v[32:35], a[200:203], a[168:171], v[32:35]
buffer_store_dwordx4 v[220:223], v6, s[16:19], s50 offen offset:2176 sc1
v_exp_f32 v41, v41
v_mfma_f32_16x16x32_bf16 v[32:35], a[204:207], a[172:175], v[32:35]
s_waitcnt lgkmcnt(6)
ds_read_b64_tr_b16 a[244:245], v2 offset:50824
ds_read_b64_tr_b16 a[246:247], v2 offset:51080
v_mfma_f32_16x16x32_bf16 v[96:99], a[224:227], v[48:51], v[96:99]
v_exp_f32 v42, v42
v_mfma_f32_16x16x32_bf16 v[100:103], a[228:231], v[48:51], v[100:103]
v_mfma_f32_16x16x32_bf16 v[104:107], a[232:235], v[48:51], v[104:107]
v_exp_f32 v43, v43
v_mfma_f32_16x16x32_bf16 v[108:111], a[236:239], v[48:51], v[108:111]
v_cvt_pk_bf16_f32 v52, v40, v41
v_cvt_pk_bf16_f32 v53, v42, v43
v_mfma_f32_16x16x32_bf16 v[36:39], a[208:211], a[160:163], 0
v_exp_f32 v44, v44
v_mfma_f32_16x16x32_bf16 v[36:39], a[212:215], a[164:167], v[36:39]
v_mfma_f32_16x16x32_bf16 v[36:39], a[216:219], a[168:171], v[36:39]
v_exp_f32 v45, v45
v_mfma_f32_16x16x32_bf16 v[36:39], a[220:223], a[172:175], v[36:39]
s_waitcnt lgkmcnt(0)
v_mfma_f32_16x16x32_bf16 v[112:115], a[240:243], v[48:51], v[112:115]
v_exp_f32 v46, v46
v_mfma_f32_16x16x32_bf16 v[116:119], a[244:247], v[48:51], v[116:119]
v_mfma_f32_16x16x32_bf16 v[120:123], a[248:251], v[48:51], v[120:123]
v_exp_f32 v47, v47
v_mfma_f32_16x16x32_bf16 v[124:127], a[252:255], v[48:51], v[124:127]
v_cvt_pk_bf16_f32 v54, v44, v45
v_cvt_pk_bf16_f32 v55, v46, v47
v_mfma_f32_16x16x32_bf16 v[40:43], a[192:195], a[176:179], 0
v_exp_f32 v32, v32
v_mfma_f32_16x16x32_bf16 v[40:43], a[196:199], a[180:183], v[40:43]
v_exp_f32 v33, v33
v_mfma_f32_16x16x32_bf16 v[40:43], a[200:203], a[184:187], v[40:43]
v_exp_f32 v34, v34
v_mfma_f32_16x16x32_bf16 v[40:43], a[204:207], a[188:191], v[40:43]
v_exp_f32 v35, v35
v_smfmac_f32_16x16x64_bf16 v[20:23], v[24:27], v[48:55], v28
v_exp_f32 v36, v36
v_mfma_f32_16x16x32_bf16 v[128:131], a[224:227], v[52:55], v[128:131]
ds_read_b64_tr_b16 a[224:225], v2 offset:59136
ds_read_b64_tr_b16 a[226:227], v2 offset:59392
v_mfma_f32_16x16x32_bf16 v[132:135], a[228:231], v[52:55], v[132:135]
v_cvt_pk_bf16_f32 v48, v32, v33
v_cvt_pk_bf16_f32 v49, v34, v35
v_mfma_f32_16x16x32_bf16 v[136:139], a[232:235], v[52:55], v[136:139]
ds_read_b64_tr_b16 a[228:229], v2 offset:59144
ds_read_b64_tr_b16 a[230:231], v2 offset:59400
v_mfma_f32_16x16x32_bf16 v[140:143], a[236:239], v[52:55], v[140:143]
v_exp_f32 v37, v37
v_mfma_f32_16x16x32_bf16 v[44:47], a[208:211], a[176:179], 0
ds_read_b64_tr_b16 a[232:233], v2 offset:59200
ds_read_b64_tr_b16 a[234:235], v2 offset:59456
v_mfma_f32_16x16x32_bf16 v[44:47], a[212:215], a[180:183], v[44:47]
v_exp_f32 v38, v38
v_mfma_f32_16x16x32_bf16 v[44:47], a[216:219], a[184:187], v[44:47]
ds_read_b64_tr_b16 a[236:237], v2 offset:59208
ds_read_b64_tr_b16 a[238:239], v2 offset:59464
v_mfma_f32_16x16x32_bf16 v[44:47], a[220:223], a[188:191], v[44:47]
v_exp_f32 v39, v39
v_mfma_f32_16x16x32_bf16 v[144:147], a[240:243], v[52:55], v[144:147]
ds_read_b64_tr_b16 a[240:241], v2 offset:59264
ds_read_b64_tr_b16 a[242:243], v2 offset:59520
v_mfma_f32_16x16x32_bf16 v[148:151], a[244:247], v[52:55], v[148:151]
v_mfma_f32_16x16x32_bf16 v[152:155], a[248:251], v[52:55], v[152:155]
ds_read_b64_tr_b16 a[244:245], v2 offset:59272
ds_read_b64_tr_b16 a[246:247], v2 offset:59528
ds_read_b64_tr_b16 a[248:249], v2 offset:59328
v_mfma_f32_16x16x32_bf16 v[156:159], a[252:255], v[52:55], v[156:159]
ds_read_b64_tr_b16 a[250:251], v2 offset:59584
v_cvt_pk_bf16_f32 v50, v36, v37
v_cvt_pk_bf16_f32 v51, v38, v39
v_exp_f32 v40, v40
ds_read_b64_tr_b16 a[252:253], v2 offset:59336
v_exp_f32 v41, v41
ds_read_b64_tr_b16 a[254:255], v2 offset:59592
s_waitcnt lgkmcnt(8)
v_mfma_f32_16x16x32_bf16 v[96:99], a[224:227], v[48:51], v[96:99]
v_exp_f32 v42, v42
v_mfma_f32_16x16x32_bf16 v[100:103], a[228:231], v[48:51], v[100:103]
v_mfma_f32_16x16x32_bf16 v[104:107], a[232:235], v[48:51], v[104:107]
v_exp_f32 v43, v43
v_mfma_f32_16x16x32_bf16 v[108:111], a[236:239], v[48:51], v[108:111]
v_cvt_pk_bf16_f32 v52, v40, v41
v_cvt_pk_bf16_f32 v53, v42, v43
v_exp_f32 v44, v44
v_exp_f32 v45, v45
s_waitcnt lgkmcnt(0)
v_mfma_f32_16x16x32_bf16 v[112:115], a[240:243], v[48:51], v[112:115]
v_exp_f32 v46, v46
v_mfma_f32_16x16x32_bf16 v[116:119], a[244:247], v[48:51], v[116:119]
v_mfma_f32_16x16x32_bf16 v[120:123], a[248:251], v[48:51], v[120:123]
v_exp_f32 v47, v47
v_mfma_f32_16x16x32_bf16 v[124:127], a[252:255], v[48:51], v[124:127]
v_cvt_pk_bf16_f32 v54, v44, v45
v_cvt_pk_bf16_f32 v55, v46, v47
s_nop 1
v_smfmac_f32_16x16x64_bf16 v[20:23], v[24:27], v[48:55], v28
v_mfma_f32_16x16x32_bf16 v[128:131], a[224:227], v[52:55], v[128:131]
v_mfma_f32_16x16x32_bf16 v[132:135], a[228:231], v[52:55], v[132:135]
v_mfma_f32_16x16x32_bf16 v[136:139], a[232:235], v[52:55], v[136:139]
v_mfma_f32_16x16x32_bf16 v[140:143], a[236:239], v[52:55], v[140:143]
s_nop 3
v_add_f32 v11, v20, v21
v_mov_b64 v[20:21], 0
v_rcp_f32 v10, v11
v_subrev_u32 v11, s33, v11
v_max_u32 v9, v9, v11
v_pk_mul_f32 v[96:97], v[96:97], v[10:11] op_sel_hi:[1,0]
v_pk_mul_f32 v[98:99], v[98:99], v[10:11] op_sel_hi:[1,0]
v_pk_mul_f32 v[100:101], v[100:101], v[10:11] op_sel_hi:[1,0]
v_pk_mul_f32 v[102:103], v[102:103], v[10:11] op_sel_hi:[1,0]
v_cvt_pk_bf16_f32 v224, v96, v97
v_cvt_pk_bf16_f32 v225, v98, v99
v_cvt_pk_bf16_f32 v226, v100, v101
v_cvt_pk_bf16_f32 v227, v102, v103
v_pk_mul_f32 v[104:105], v[104:105], v[10:11] op_sel_hi:[1,0]
v_pk_mul_f32 v[106:107], v[106:107], v[10:11] op_sel_hi:[1,0]
v_pk_mul_f32 v[108:109], v[108:109], v[10:11] op_sel_hi:[1,0]
v_pk_mul_f32 v[110:111], v[110:111], v[10:11] op_sel_hi:[1,0]
v_cvt_pk_bf16_f32 v56, v104, v105
v_cvt_pk_bf16_f32 v57, v106, v107
v_cvt_pk_bf16_f32 v58, v108, v109
v_cvt_pk_bf16_f32 v59, v110, v111
v_cndmask_b32_dpp v228, v224, v56, vcc row_ror:8 row_mask:0xf bank_mask:0xf
v_cndmask_b32_dpp v229, v225, v57, vcc row_ror:8 row_mask:0xf bank_mask:0xf
v_cndmask_b32_dpp v230, v226, v58, vcc row_ror:8 row_mask:0xf bank_mask:0xf
v_cndmask_b32_dpp v231, v227, v59, vcc row_ror:8 row_mask:0xf bank_mask:0xf
v_mov_b32_dpp v224, v56 row_ror:8 row_mask:0xf bank_mask:0xc
v_mov_b32_dpp v225, v57 row_ror:8 row_mask:0xf bank_mask:0xc
v_mov_b32_dpp v226, v58 row_ror:8 row_mask:0xf bank_mask:0xc
v_mov_b32_dpp v227, v59 row_ror:8 row_mask:0xf bank_mask:0xc
v_pk_mul_f32 v[112:113], v[112:113], v[10:11] op_sel_hi:[1,0]
v_pk_mul_f32 v[114:115], v[114:115], v[10:11] op_sel_hi:[1,0]
v_pk_mul_f32 v[116:117], v[116:117], v[10:11] op_sel_hi:[1,0]
v_pk_mul_f32 v[118:119], v[118:119], v[10:11] op_sel_hi:[1,0]
v_cvt_pk_bf16_f32 v232, v112, v113
v_cvt_pk_bf16_f32 v233, v114, v115
v_cvt_pk_bf16_f32 v234, v116, v117
v_cvt_pk_bf16_f32 v235, v118, v119
v_pk_mul_f32 v[120:121], v[120:121], v[10:11] op_sel_hi:[1,0]
v_pk_mul_f32 v[122:123], v[122:123], v[10:11] op_sel_hi:[1,0]
v_pk_mul_f32 v[124:125], v[124:125], v[10:11] op_sel_hi:[1,0]
v_pk_mul_f32 v[126:127], v[126:127], v[10:11] op_sel_hi:[1,0]
v_cvt_pk_bf16_f32 v56, v120, v121
v_cvt_pk_bf16_f32 v57, v122, v123
v_cvt_pk_bf16_f32 v58, v124, v125
v_cvt_pk_bf16_f32 v59, v126, v127
v_cndmask_b32_dpp v236, v232, v56, vcc row_ror:8 row_mask:0xf bank_mask:0xf
v_cndmask_b32_dpp v237, v233, v57, vcc row_ror:8 row_mask:0xf bank_mask:0xf
v_cndmask_b32_dpp v238, v234, v58, vcc row_ror:8 row_mask:0xf bank_mask:0xf
v_cndmask_b32_dpp v239, v235, v59, vcc row_ror:8 row_mask:0xf bank_mask:0xf
v_mov_b32_dpp v232, v56 row_ror:8 row_mask:0xf bank_mask:0xc
v_mov_b32_dpp v233, v57 row_ror:8 row_mask:0xf bank_mask:0xc
v_mov_b32_dpp v234, v58 row_ror:8 row_mask:0xf bank_mask:0xc
v_mov_b32_dpp v235, v59 row_ror:8 row_mask:0xf bank_mask:0xc
v_mfma_f32_16x16x32_bf16 v[144:147], a[240:243], v[52:55], v[144:147]
s_add_u32 s50, s24, 16384
buffer_store_dwordx4 v[224:227], v6, s[16:19], s50 offen offset:0 sc1
v_mfma_f32_16x16x32_bf16 v[148:151], a[244:247], v[52:55], v[148:151]
v_mfma_f32_16x16x32_bf16 v[152:155], a[248:251], v[52:55], v[152:155]
v_mfma_f32_16x16x32_bf16 v[156:159], a[252:255], v[52:55], v[156:159]
buffer_store_dwordx4 v[228:231], v6, s[16:19], s50 offen offset:2048 sc1
buffer_store_dwordx4 v[232:235], v6, s[16:19], s50 offen offset:128 sc1
buffer_store_dwordx4 v[236:239], v6, s[16:19], s50 offen offset:2176 sc1
v_add_f32 v11, v22, v23
v_mov_b64 v[22:23], 0
v_rcp_f32 v10, v11
v_subrev_u32 v11, s33, v11
v_max_u32 v9, v9, v11
v_cmp_lt_u32 s[54:55], s56, v9
v_pk_mul_f32 v[128:129], v[128:129], v[10:11] op_sel_hi:[1,0]
v_pk_mul_f32 v[130:131], v[130:131], v[10:11] op_sel_hi:[1,0]
v_pk_mul_f32 v[132:133], v[132:133], v[10:11] op_sel_hi:[1,0]
v_pk_mul_f32 v[134:135], v[134:135], v[10:11] op_sel_hi:[1,0]
v_cvt_pk_bf16_f32 v240, v128, v129
v_cvt_pk_bf16_f32 v241, v130, v131
v_cvt_pk_bf16_f32 v242, v132, v133
v_cvt_pk_bf16_f32 v243, v134, v135
v_pk_mul_f32 v[136:137], v[136:137], v[10:11] op_sel_hi:[1,0]
v_pk_mul_f32 v[138:139], v[138:139], v[10:11] op_sel_hi:[1,0]
v_pk_mul_f32 v[140:141], v[140:141], v[10:11] op_sel_hi:[1,0]
v_pk_mul_f32 v[142:143], v[142:143], v[10:11] op_sel_hi:[1,0]
v_cvt_pk_bf16_f32 v56, v136, v137
v_cvt_pk_bf16_f32 v57, v138, v139
v_cvt_pk_bf16_f32 v58, v140, v141
v_cvt_pk_bf16_f32 v59, v142, v143
v_cndmask_b32_dpp v244, v240, v56, vcc row_ror:8 row_mask:0xf bank_mask:0xf
v_cndmask_b32_dpp v245, v241, v57, vcc row_ror:8 row_mask:0xf bank_mask:0xf
v_cndmask_b32_dpp v246, v242, v58, vcc row_ror:8 row_mask:0xf bank_mask:0xf
v_cndmask_b32_dpp v247, v243, v59, vcc row_ror:8 row_mask:0xf bank_mask:0xf
v_mov_b32_dpp v240, v56 row_ror:8 row_mask:0xf bank_mask:0xc
v_mov_b32_dpp v241, v57 row_ror:8 row_mask:0xf bank_mask:0xc
v_mov_b32_dpp v242, v58 row_ror:8 row_mask:0xf bank_mask:0xc
v_mov_b32_dpp v243, v59 row_ror:8 row_mask:0xf bank_mask:0xc
v_pk_mul_f32 v[144:145], v[144:145], v[10:11] op_sel_hi:[1,0]
v_pk_mul_f32 v[146:147], v[146:147], v[10:11] op_sel_hi:[1,0]
v_pk_mul_f32 v[148:149], v[148:149], v[10:11] op_sel_hi:[1,0]
v_pk_mul_f32 v[150:151], v[150:151], v[10:11] op_sel_hi:[1,0]
v_cvt_pk_bf16_f32 v248, v144, v145
v_cvt_pk_bf16_f32 v249, v146, v147
v_cvt_pk_bf16_f32 v250, v148, v149
v_cvt_pk_bf16_f32 v251, v150, v151
v_pk_mul_f32 v[152:153], v[152:153], v[10:11] op_sel_hi:[1,0]
v_pk_mul_f32 v[154:155], v[154:155], v[10:11] op_sel_hi:[1,0]
v_pk_mul_f32 v[156:157], v[156:157], v[10:11] op_sel_hi:[1,0]
v_pk_mul_f32 v[158:159], v[158:159], v[10:11] op_sel_hi:[1,0]
v_cvt_pk_bf16_f32 v56, v152, v153
v_cvt_pk_bf16_f32 v57, v154, v155
v_cvt_pk_bf16_f32 v58, v156, v157
v_cvt_pk_bf16_f32 v59, v158, v159
v_cndmask_b32_dpp v252, v248, v56, vcc row_ror:8 row_mask:0xf bank_mask:0xf
v_cndmask_b32_dpp v253, v249, v57, vcc row_ror:8 row_mask:0xf bank_mask:0xf
v_cndmask_b32_dpp v254, v250, v58, vcc row_ror:8 row_mask:0xf bank_mask:0xf
v_cndmask_b32_dpp v255, v251, v59, vcc row_ror:8 row_mask:0xf bank_mask:0xf
v_mov_b32_dpp v248, v56 row_ror:8 row_mask:0xf bank_mask:0xc
v_mov_b32_dpp v249, v57 row_ror:8 row_mask:0xf bank_mask:0xc
v_mov_b32_dpp v250, v58 row_ror:8 row_mask:0xf bank_mask:0xc
v_mov_b32_dpp v251, v59 row_ror:8 row_mask:0xf bank_mask:0xc
s_cmp_lg_u64 s[54:55], 0
s_cselect_b32 s37, s38, 0
s_or_b32 s29, s29, s37
s_lshl_b32 s38, s38, 1
s_add_u32 s50, s24, 20480
buffer_store_dwordx4 v[240:243], v6, s[16:19], s50 offen offset:0 sc1
buffer_store_dwordx4 v[244:247], v6, s[16:19], s50 offen offset:2048 sc1
buffer_store_dwordx4 v[248:251], v6, s[16:19], s50 offen offset:128 sc1
buffer_store_dwordx4 v[252:255], v6, s[16:19], s50 offen offset:2176 sc1
s_cmp_eq_u32 s29, 0
s_cbranch_scc0 Lslow
Lfin:
Lend:
s_endpgm
Lslow:
s_waitcnt vmcnt(0) lgkmcnt(0)
s_barrier
s_mov_b32 s6, 100663296
s_mov_b32 s10, 67108864
s_mov_b32 s14, 67108864
s_mov_b32 s18, 100663296
s_mul_i32 s21, s20, 16896
s_add_u32 s22, s21, 67584
v_add_u32 v1, s21, v1
v_add_u32 v2, s21, v2
s_lshl_b32 s37, s20, 11
v_subrev_u32 v3, s37, v3
s_lshl_b32 s37, s20, 8
v_subrev_u32 v4, s37, v4
v_mbcnt_lo_u32_b32 v26, -1, 0
v_mbcnt_hi_u32_b32 v26, -1, v26
v_and_b32 v6, 15, v26
s_mul_i32 s37, s20, 96
v_add_u32 v6, s37, v6
v_lshlrev_b32 v6, 8, v6
v_lshrrev_b32 v26, 4, v26
v_lshl_add_u32 v6, v26, 4, v6
s_mov_b32 s24, s35
s_mov_b32 s27, s36
Lslow_item:
s_and_b32 s37, s29, 1
s_cbranch_scc0 Lslow_next
s_add_u32 s28, s24, 0
buffer_load_dwordx4 a[96:99], v6, s[4:7], s28 offen offset:0
buffer_load_dwordx4 a[100:103], v6, s[4:7], s28 offen offset:64
buffer_load_dwordx4 a[104:107], v6, s[4:7], s28 offen offset:128
buffer_load_dwordx4 a[108:111], v6, s[4:7], s28 offen offset:192
s_add_u32 s28, s24, 4096
buffer_load_dwordx4 a[112:115], v6, s[4:7], s28 offen offset:0
buffer_load_dwordx4 a[116:119], v6, s[4:7], s28 offen offset:64
buffer_load_dwordx4 a[120:123], v6, s[4:7], s28 offen offset:128
buffer_load_dwordx4 a[124:127], v6, s[4:7], s28 offen offset:192
s_add_u32 s28, s24, 8192
buffer_load_dwordx4 a[128:131], v6, s[4:7], s28 offen offset:0
buffer_load_dwordx4 a[132:135], v6, s[4:7], s28 offen offset:64
buffer_load_dwordx4 a[136:139], v6, s[4:7], s28 offen offset:128
buffer_load_dwordx4 a[140:143], v6, s[4:7], s28 offen offset:192
s_add_u32 s28, s24, 12288
buffer_load_dwordx4 a[144:147], v6, s[4:7], s28 offen offset:0
buffer_load_dwordx4 a[148:151], v6, s[4:7], s28 offen offset:64
buffer_load_dwordx4 a[152:155], v6, s[4:7], s28 offen offset:128
buffer_load_dwordx4 a[156:159], v6, s[4:7], s28 offen offset:192
s_add_u32 s28, s24, 16384
buffer_load_dwordx4 a[160:163], v6, s[4:7], s28 offen offset:0
buffer_load_dwordx4 a[164:167], v6, s[4:7], s28 offen offset:64
buffer_load_dwordx4 a[168:171], v6, s[4:7], s28 offen offset:128
buffer_load_dwordx4 a[172:175], v6, s[4:7], s28 offen offset:192
s_add_u32 s28, s24, 20480
buffer_load_dwordx4 a[176:179], v6, s[4:7], s28 offen offset:0
buffer_load_dwordx4 a[180:183], v6, s[4:7], s28 offen offset:64
buffer_load_dwordx4 a[184:187], v6, s[4:7], s28 offen offset:128
buffer_load_dwordx4 a[188:191], v6, s[4:7], s28 offen offset:192
v_mov_b32 v12, 0xff800000
v_mov_b32 v13, 0xff800000
v_mov_b32 v14, 0xff800000
v_mov_b32 v15, 0xff800000
v_mov_b32 v16, 0xff800000
v_mov_b32 v17, 0xff800000
s_mov_b32 s34, s27
s_mov_b32 s23, 0
Lslow_p1:
s_add_u32 m0, s21, 0
s_add_u32 s26, s34, 0
buffer_load_dwordx4 v3, s[8:11], s26 offen offset:0 nt lds
buffer_load_dwordx4 v3, s[8:11], s26 offen offset:1024 nt lds
s_add_u32 m0, s21, 2112
s_add_u32 s26, s34, 2048
buffer_load_dwordx4 v3, s[8:11], s26 offen offset:0 nt lds
buffer_load_dwordx4 v3, s[8:11], s26 offen offset:1024 nt lds
s_add_u32 m0, s21, 4224
s_add_u32 s26, s34, 4096
buffer_load_dwordx4 v3, s[8:11], s26 offen offset:0 nt lds
buffer_load_dwordx4 v3, s[8:11], s26 offen offset:1024 nt lds
s_add_u32 m0, s21, 6336
s_add_u32 s26, s34, 6144
buffer_load_dwordx4 v3, s[8:11], s26 offen offset:0 nt lds
buffer_load_dwordx4 v3, s[8:11], s26 offen offset:1024 nt lds
s_waitcnt vmcnt(0)
ds_read_b128 a[192:195], v1 offset:0
ds_read_b128 a[196:199], v1 offset:64
ds_read_b128 a[200:203], v1 offset:128
ds_read_b128 a[204:207], v1 offset:192
ds_read_b128 a[208:211], v1 offset:1024
ds_read_b128 a[212:215], v1 offset:1088
ds_read_b128 a[216:219], v1 offset:1152
ds_read_b128 a[220:223], v1 offset:1216
s_waitcnt lgkmcnt(0)
v_mfma_f32_16x16x32_bf16 v[32:35], a[192:195], a[96:99], 0
v_mfma_f32_16x16x32_bf16 v[32:35], a[196:199], a[100:103], v[32:35]
v_mfma_f32_16x16x32_bf16 v[32:35], a[200:203], a[104:107], v[32:35]
v_mfma_f32_16x16x32_bf16 v[32:35], a[204:207], a[108:111], v[32:35]
v_mfma_f32_16x16x32_bf16 v[36:39], a[208:211], a[96:99], 0
v_mfma_f32_16x16x32_bf16 v[36:39], a[212:215], a[100:103], v[36:39]
v_mfma_f32_16x16x32_bf16 v[36:39], a[216:219], a[104:107], v[36:39]
v_mfma_f32_16x16x32_bf16 v[36:39], a[220:223], a[108:111], v[36:39]
s_nop 3
v_max3_f32 v12, v12, v32, v33
v_max3_f32 v12, v12, v34, v35
s_nop 1
v_max3_f32 v12, v12, v36, v37
v_max3_f32 v12, v12, v38, v39
v_mfma_f32_16x16x32_bf16 v[40:43], a[192:195], a[112:115], 0
v_mfma_f32_16x16x32_bf16 v[40:43], a[196:199], a[116:119], v[40:43]
v_mfma_f32_16x16x32_bf16 v[40:43], a[200:203], a[120:123], v[40:43]
v_mfma_f32_16x16x32_bf16 v[40:43], a[204:207], a[124:127], v[40:43]
v_mfma_f32_16x16x32_bf16 v[44:47], a[208:211], a[112:115], 0
v_mfma_f32_16x16x32_bf16 v[44:47], a[212:215], a[116:119], v[44:47]
v_mfma_f32_16x16x32_bf16 v[44:47], a[216:219], a[120:123], v[44:47]
v_mfma_f32_16x16x32_bf16 v[44:47], a[220:223], a[124:127], v[44:47]
s_nop 3
v_max3_f32 v13, v13, v40, v41
v_max3_f32 v13, v13, v42, v43
s_nop 1
v_max3_f32 v13, v13, v44, v45
v_max3_f32 v13, v13, v46, v47
v_mfma_f32_16x16x32_bf16 v[32:35], a[192:195], a[128:131], 0
v_mfma_f32_16x16x32_bf16 v[32:35], a[196:199], a[132:135], v[32:35]
v_mfma_f32_16x16x32_bf16 v[32:35], a[200:203], a[136:139], v[32:35]
v_mfma_f32_16x16x32_bf16 v[32:35], a[204:207], a[140:143], v[32:35]
v_mfma_f32_16x16x32_bf16 v[36:39], a[208:211], a[128:131], 0
v_mfma_f32_16x16x32_bf16 v[36:39], a[212:215], a[132:135], v[36:39]
v_mfma_f32_16x16x32_bf16 v[36:39], a[216:219], a[136:139], v[36:39]
v_mfma_f32_16x16x32_bf16 v[36:39], a[220:223], a[140:143], v[36:39]
s_nop 3
v_max3_f32 v14, v14, v32, v33
v_max3_f32 v14, v14, v34, v35
s_nop 1
v_max3_f32 v14, v14, v36, v37
v_max3_f32 v14, v14, v38, v39
v_mfma_f32_16x16x32_bf16 v[40:43], a[192:195], a[144:147], 0
v_mfma_f32_16x16x32_bf16 v[40:43], a[196:199], a[148:151], v[40:43]
v_mfma_f32_16x16x32_bf16 v[40:43], a[200:203], a[152:155], v[40:43]
v_mfma_f32_16x16x32_bf16 v[40:43], a[204:207], a[156:159], v[40:43]
v_mfma_f32_16x16x32_bf16 v[44:47], a[208:211], a[144:147], 0
v_mfma_f32_16x16x32_bf16 v[44:47], a[212:215], a[148:151], v[44:47]
v_mfma_f32_16x16x32_bf16 v[44:47], a[216:219], a[152:155], v[44:47]
v_mfma_f32_16x16x32_bf16 v[44:47], a[220:223], a[156:159], v[44:47]
s_nop 3
v_max3_f32 v15, v15, v40, v41
v_max3_f32 v15, v15, v42, v43
s_nop 1
v_max3_f32 v15, v15, v44, v45
v_max3_f32 v15, v15, v46, v47
v_mfma_f32_16x16x32_bf16 v[32:35], a[192:195], a[160:163], 0
v_mfma_f32_16x16x32_bf16 v[32:35], a[196:199], a[164:167], v[32:35]
v_mfma_f32_16x16x32_bf16 v[32:35], a[200:203], a[168:171], v[32:35]
v_mfma_f32_16x16x32_bf16 v[32:35], a[204:207], a[172:175], v[32:35]
v_mfma_f32_16x16x32_bf16 v[36:39], a[208:211], a[160:163], 0
v_mfma_f32_16x16x32_bf16 v[36:39], a[212:215], a[164:167], v[36:39]
v_mfma_f32_16x16x32_bf16 v[36:39], a[216:219], a[168:171], v[36:39]
v_mfma_f32_16x16x32_bf16 v[36:39], a[220:223], a[172:175], v[36:39]
s_nop 3
v_max3_f32 v16, v16, v32, v33
v_max3_f32 v16, v16, v34, v35
s_nop 1
v_max3_f32 v16, v16, v36, v37
v_max3_f32 v16, v16, v38, v39
v_mfma_f32_16x16x32_bf16 v[40:43], a[192:195], a[176:179], 0
v_mfma_f32_16x16x32_bf16 v[40:43], a[196:199], a[180:183], v[40:43]
v_mfma_f32_16x16x32_bf16 v[40:43], a[200:203], a[184:187], v[40:43]
v_mfma_f32_16x16x32_bf16 v[40:43], a[204:207], a[188:191], v[40:43]
v_mfma_f32_16x16x32_bf16 v[44:47], a[208:211], a[176:179], 0
v_mfma_f32_16x16x32_bf16 v[44:47], a[212:215], a[180:183], v[44:47]
v_mfma_f32_16x16x32_bf16 v[44:47], a[216:219], a[184:187], v[44:47]
v_mfma_f32_16x16x32_bf16 v[44:47], a[220:223], a[188:191], v[44:47]
s_nop 3
v_max3_f32 v17, v17, v40, v41
v_max3_f32 v17, v17, v42, v43
s_nop 1
v_max3_f32 v17, v17, v44, v45
v_max3_f32 v17, v17, v46, v47
s_add_u32 s34, s34, 8192
s_add_u32 s23, s23, 1
s_cmp_lt_u32 s23, 16
s_cbranch_scc1 Lslow_p1
v_mov_b32 v26, v12
v_mov_b32 v27, v13
v_mov_b32 v28, v14
v_mov_b32 v29, v15
v_mov_b32 v30, v16
v_mov_b32 v31, v17
v_permlane32_swap_b32 v12, v26
v_permlane32_swap_b32 v13, v27
v_permlane32_swap_b32 v14, v28
v_permlane32_swap_b32 v15, v29
v_permlane32_swap_b32 v16, v30
v_permlane32_swap_b32 v17, v31
v_max_f32 v12, v12, v26
v_max_f32 v13, v13, v27
v_max_f32 v14, v14, v28
v_max_f32 v15, v15, v29
v_max_f32 v16, v16, v30
v_max_f32 v17, v17, v31
v_mov_b32 v26, v12
v_mov_b32 v27, v13
v_mov_b32 v28, v14
v_mov_b32 v29, v15
v_mov_b32 v30, v16
v_mov_b32 v31, v17
v_permlane16_swap_b32 v12, v26
v_permlane16_swap_b32 v13, v27
v_permlane16_swap_b32 v14, v28
v_permlane16_swap_b32 v15, v29
v_permlane16_swap_b32 v16, v30
v_permlane16_swap_b32 v17, v31
v_max_f32 v12, v12, v26
v_max_f32 v13, v13, v27
v_max_f32 v14, v14, v28
v_max_f32 v15, v15, v29
v_max_f32 v16, v16, v30
v_max_f32 v17, v17, v31
v_mul_f32 v20, s30, v12
v_mov_b32 v12, 0
v_mul_f32 v21, s30, v13
v_mov_b32 v13, 0
v_mul_f32 v22, s30, v14
v_mov_b32 v14, 0
v_mul_f32 v23, s30, v15
v_mov_b32 v15, 0
v_mul_f32 v24, s30, v16
v_mov_b32 v16, 0
v_mul_f32 v25, s30, v17
v_mov_b32 v17, 0
v_accvgpr_write_b32 a0, 0
v_accvgpr_write_b32 a1, 0
v_accvgpr_write_b32 a2, 0
v_accvgpr_write_b32 a3, 0
v_accvgpr_write_b32 a4, 0
v_accvgpr_write_b32 a5, 0
v_accvgpr_write_b32 a6, 0
v_accvgpr_write_b32 a7, 0
v_accvgpr_write_b32 a8, 0
v_accvgpr_write_b32 a9, 0
v_accvgpr_write_b32 a10, 0
v_accvgpr_write_b32 a11, 0
v_accvgpr_write_b32 a12, 0
v_accvgpr_write_b32 a13, 0
v_accvgpr_write_b32 a14, 0
v_accvgpr_write_b32 a15, 0
v_accvgpr_write_b32 a16, 0
v_accvgpr_write_b32 a17, 0
v_accvgpr_write_b32 a18, 0
v_accvgpr_write_b32 a19, 0
v_accvgpr_write_b32 a20, 0
v_accvgpr_write_b32 a21, 0
v_accvgpr_write_b32 a22, 0
v_accvgpr_write_b32 a23, 0
v_accvgpr_write_b32 a24, 0
v_accvgpr_write_b32 a25, 0
v_accvgpr_write_b32 a26, 0
v_accvgpr_write_b32 a27, 0
v_accvgpr_write_b32 a28, 0
v_accvgpr_write_b32 a29, 0
v_accvgpr_write_b32 a30, 0
v_accvgpr_write_b32 a31, 0
v_accvgpr_write_b32 a32, 0
v_accvgpr_write_b32 a33, 0
v_accvgpr_write_b32 a34, 0
v_accvgpr_write_b32 a35, 0
v_accvgpr_write_b32 a36, 0
v_accvgpr_write_b32 a37, 0
v_accvgpr_write_b32 a38, 0
v_accvgpr_write_b32 a39, 0
v_accvgpr_write_b32 a40, 0
v_accvgpr_write_b32 a41, 0
v_accvgpr_write_b32 a42, 0
v_accvgpr_write_b32 a43, 0
v_accvgpr_write_b32 a44, 0
v_accvgpr_write_b32 a45, 0
v_accvgpr_write_b32 a46, 0
v_accvgpr_write_b32 a47, 0
v_accvgpr_write_b32 a48, 0
v_accvgpr_write_b32 a49, 0
v_accvgpr_write_b32 a50, 0
v_accvgpr_write_b32 a51, 0
v_accvgpr_write_b32 a52, 0
v_accvgpr_write_b32 a53, 0
v_accvgpr_write_b32 a54, 0
v_accvgpr_write_b32 a55, 0
v_accvgpr_write_b32 a56, 0
v_accvgpr_write_b32 a57, 0
v_accvgpr_write_b32 a58, 0
v_accvgpr_write_b32 a59, 0
v_accvgpr_write_b32 a60, 0
v_accvgpr_write_b32 a61, 0
v_accvgpr_write_b32 a62, 0
v_accvgpr_write_b32 a63, 0
v_accvgpr_write_b32 a64, 0
v_accvgpr_write_b32 a65, 0
v_accvgpr_write_b32 a66, 0
v_accvgpr_write_b32 a67, 0
v_accvgpr_write_b32 a68, 0
v_accvgpr_write_b32 a69, 0
v_accvgpr_write_b32 a70, 0
v_accvgpr_write_b32 a71, 0
v_accvgpr_write_b32 a72, 0
v_accvgpr_write_b32 a73, 0
v_accvgpr_write_b32 a74, 0
v_accvgpr_write_b32 a75, 0
v_accvgpr_write_b32 a76, 0
v_accvgpr_write_b32 a77, 0
v_accvgpr_write_b32 a78, 0
v_accvgpr_write_b32 a79, 0
v_accvgpr_write_b32 a80, 0
v_accvgpr_write_b32 a81, 0
v_accvgpr_write_b32 a82, 0
v_accvgpr_write_b32 a83, 0
v_accvgpr_write_b32 a84, 0
v_accvgpr_write_b32 a85, 0
v_accvgpr_write_b32 a86, 0
v_accvgpr_write_b32 a87, 0
v_accvgpr_write_b32 a88, 0
v_accvgpr_write_b32 a89, 0
v_accvgpr_write_b32 a90, 0
v_accvgpr_write_b32 a91, 0
v_accvgpr_write_b32 a92, 0
v_accvgpr_write_b32 a93, 0
v_accvgpr_write_b32 a94, 0
v_accvgpr_write_b32 a95, 0
v_mov_b32 v64, 0
v_mov_b32 v65, 0
v_mov_b32 v66, 0
v_mov_b32 v67, 0
v_mov_b32 v68, 0
v_mov_b32 v69, 0
v_mov_b32 v70, 0
v_mov_b32 v71, 0
v_mov_b32 v72, 0
v_mov_b32 v73, 0
v_mov_b32 v74, 0
v_mov_b32 v75, 0
v_mov_b32 v76, 0
v_mov_b32 v77, 0
v_mov_b32 v78, 0
v_mov_b32 v79, 0
v_mov_b32 v80, 0
v_mov_b32 v81, 0
v_mov_b32 v82, 0
v_mov_b32 v83, 0
v_mov_b32 v84, 0
v_mov_b32 v85, 0
v_mov_b32 v86, 0
v_mov_b32 v87, 0
v_mov_b32 v88, 0
v_mov_b32 v89, 0
v_mov_b32 v90, 0
v_mov_b32 v91, 0
v_mov_b32 v92, 0
v_mov_b32 v93, 0
v_mov_b32 v94, 0
v_mov_b32 v95, 0
v_mov_b32 v96, 0
v_mov_b32 v97, 0
v_mov_b32 v98, 0
v_mov_b32 v99, 0
v_mov_b32 v100, 0
v_mov_b32 v101, 0
v_mov_b32 v102, 0
v_mov_b32 v103, 0
v_mov_b32 v104, 0
v_mov_b32 v105, 0
v_mov_b32 v106, 0
v_mov_b32 v107, 0
v_mov_b32 v108, 0
v_mov_b32 v109, 0
v_mov_b32 v110, 0
v_mov_b32 v111, 0
v_mov_b32 v112, 0
v_mov_b32 v113, 0
v_mov_b32 v114, 0
v_mov_b32 v115, 0
v_mov_b32 v116, 0
v_mov_b32 v117, 0
v_mov_b32 v118, 0
v_mov_b32 v119, 0
v_mov_b32 v120, 0
v_mov_b32 v121, 0
v_mov_b32 v122, 0
v_mov_b32 v123, 0
v_mov_b32 v124, 0
v_mov_b32 v125, 0
v_mov_b32 v126, 0
v_mov_b32 v127, 0
v_mov_b32 v128, 0
v_mov_b32 v129, 0
v_mov_b32 v130, 0
v_mov_b32 v131, 0
v_mov_b32 v132, 0
v_mov_b32 v133, 0
v_mov_b32 v134, 0
v_mov_b32 v135, 0
v_mov_b32 v136, 0
v_mov_b32 v137, 0
v_mov_b32 v138, 0
v_mov_b32 v139, 0
v_mov_b32 v140, 0
v_mov_b32 v141, 0
v_mov_b32 v142, 0
v_mov_b32 v143, 0
v_mov_b32 v144, 0
v_mov_b32 v145, 0
v_mov_b32 v146, 0
v_mov_b32 v147, 0
v_mov_b32 v148, 0
v_mov_b32 v149, 0
v_mov_b32 v150, 0
v_mov_b32 v151, 0
v_mov_b32 v152, 0
v_mov_b32 v153, 0
v_mov_b32 v154, 0
v_mov_b32 v155, 0
v_mov_b32 v156, 0
v_mov_b32 v157, 0
v_mov_b32 v158, 0
v_mov_b32 v159, 0
s_mov_b32 s34, s27
s_mov_b32 s23, 0
Lslow_p2:
s_add_u32 m0, s21, 0
s_add_u32 s26, s34, 0
buffer_load_dwordx4 v3, s[8:11], s26 offen offset:0 nt lds
buffer_load_dwordx4 v3, s[8:11], s26 offen offset:1024 nt lds
s_add_u32 m0, s22, 0
s_add_u32 s26, s34, 0
buffer_load_dwordx4 v4, s[12:15], s26 offen offset:0 nt lds
s_sub_u32 m0, m0, 1016
s_nop 0
buffer_load_dwordx4 v4, s[12:15], s26 offen offset:2048 nt lds
s_add_u32 m0, s21, 2112
s_add_u32 s26, s34, 2048
buffer_load_dwordx4 v3, s[8:11], s26 offen offset:0 nt lds
buffer_load_dwordx4 v3, s[8:11], s26 offen offset:1024 nt lds
s_add_u32 m0, s22, 2112
s_add_u32 s26, s34, 256
buffer_load_dwordx4 v4, s[12:15], s26 offen offset:0 nt lds
s_sub_u32 m0, m0, 1016
s_nop 0
buffer_load_dwordx4 v4, s[12:15], s26 offen offset:2048 nt lds
s_add_u32 m0, s21, 4224
s_add_u32 s26, s34, 4096
buffer_load_dwordx4 v3, s[8:11], s26 offen offset:0 nt lds
buffer_load_dwordx4 v3, s[8:11], s26 offen offset:1024 nt lds
s_add_u32 m0, s22, 4224
s_add_u32 s26, s34, 512
buffer_load_dwordx4 v4, s[12:15], s26 offen offset:0 nt lds
s_sub_u32 m0, m0, 1016
s_nop 0
buffer_load_dwordx4 v4, s[12:15], s26 offen offset:2048 nt lds
s_add_u32 m0, s21, 6336
s_add_u32 s26, s34, 6144
buffer_load_dwordx4 v3, s[8:11], s26 offen offset:0 nt lds
buffer_load_dwordx4 v3, s[8:11], s26 offen offset:1024 nt lds
s_add_u32 m0, s22, 6336
s_add_u32 s26, s34, 768
buffer_load_dwordx4 v4, s[12:15], s26 offen offset:0 nt lds
s_sub_u32 m0, m0, 1016
s_nop 0
buffer_load_dwordx4 v4, s[12:15], s26 offen offset:2048 nt lds
s_waitcnt vmcnt(0)
ds_read_b128 a[192:195], v1 offset:0
ds_read_b128 a[196:199], v1 offset:64
ds_read_b128 a[200:203], v1 offset:128
ds_read_b128 a[204:207], v1 offset:192
ds_read_b128 a[208:211], v1 offset:1024
ds_read_b128 a[212:215], v1 offset:1088
ds_read_b128 a[216:219], v1 offset:1152
ds_read_b128 a[220:223], v1 offset:1216
s_waitcnt lgkmcnt(0)
ds_read_b64_tr_b16 a[224:225], v2 offset:0
ds_read_b64_tr_b16 a[226:227], v2 offset:256
ds_read_b64_tr_b16 a[228:229], v2 offset:8
ds_read_b64_tr_b16 a[230:231], v2 offset:264
ds_read_b64_tr_b16 a[232:233], v2 offset:64
ds_read_b64_tr_b16 a[234:235], v2 offset:320
ds_read_b64_tr_b16 a[236:237], v2 offset:72
ds_read_b64_tr_b16 a[238:239], v2 offset:328
ds_read_b64_tr_b16 a[240:241], v2 offset:128
ds_read_b64_tr_b16 a[242:243], v2 offset:384
ds_read_b64_tr_b16 a[244:245], v2 offset:136
ds_read_b64_tr_b16 a[246:247], v2 offset:392
ds_read_b64_tr_b16 a[248:249], v2 offset:192
ds_read_b64_tr_b16 a[250:251], v2 offset:448
ds_read_b64_tr_b16 a[252:253], v2 offset:200
ds_read_b64_tr_b16 a[254:255], v2 offset:456
s_waitcnt lgkmcnt(0)
v_mfma_f32_16x16x32_bf16 v[32:35], a[192:195], a[96:99], 0
v_mfma_f32_16x16x32_bf16 v[32:35], a[196:199], a[100:103], v[32:35]
v_mfma_f32_16x16x32_bf16 v[32:35], a[200:203], a[104:107], v[32:35]
v_mfma_f32_16x16x32_bf16 v[32:35], a[204:207], a[108:111], v[32:35]
v_mfma_f32_16x16x32_bf16 v[36:39], a[208:211], a[96:99], 0
v_mfma_f32_16x16x32_bf16 v[36:39], a[212:215], a[100:103], v[36:39]
v_mfma_f32_16x16x32_bf16 v[36:39], a[216:219], a[104:107], v[36:39]
v_mfma_f32_16x16x32_bf16 v[36:39], a[220:223], a[108:111], v[36:39]
s_nop 3
v_fma_f32 v32, v32, s30, -v20
v_fma_f32 v33, v33, s30, -v20
v_fma_f32 v34, v34, s30, -v20
v_fma_f32 v35, v35, s30, -v20
v_fma_f32 v36, v36, s30, -v20
v_fma_f32 v37, v37, s30, -v20
v_fma_f32 v38, v38, s30, -v20
v_fma_f32 v39, v39, s30, -v20
v_exp_f32 v32, v32
v_exp_f32 v33, v33
v_exp_f32 v34, v34
v_exp_f32 v35, v35
v_exp_f32 v36, v36
v_exp_f32 v37, v37
v_exp_f32 v38, v38
v_exp_f32 v39, v39
v_add_f32 v12, v12, v32
v_add_f32 v12, v12, v33
v_add_f32 v12, v12, v34
v_add_f32 v12, v12, v35
v_add_f32 v12, v12, v36
v_add_f32 v12, v12, v37
v_add_f32 v12, v12, v38
v_add_f32 v12, v12, v39
v_cvt_pk_bf16_f32 v48, v32, v33
v_cvt_pk_bf16_f32 v49, v34, v35
v_cvt_pk_bf16_f32 v50, v36, v37
v_cvt_pk_bf16_f32 v51, v38, v39
s_nop 1
v_mfma_f32_16x16x32_bf16 a[0:3], a[224:227], v[48:51], a[0:3]
v_mfma_f32_16x16x32_bf16 a[4:7], a[228:231], v[48:51], a[4:7]
v_mfma_f32_16x16x32_bf16 a[8:11], a[232:235], v[48:51], a[8:11]
v_mfma_f32_16x16x32_bf16 a[12:15], a[236:239], v[48:51], a[12:15]
v_mfma_f32_16x16x32_bf16 a[16:19], a[240:243], v[48:51], a[16:19]
v_mfma_f32_16x16x32_bf16 a[20:23], a[244:247], v[48:51], a[20:23]
v_mfma_f32_16x16x32_bf16 a[24:27], a[248:251], v[48:51], a[24:27]
v_mfma_f32_16x16x32_bf16 a[28:31], a[252:255], v[48:51], a[28:31]
v_mfma_f32_16x16x32_bf16 v[40:43], a[192:195], a[112:115], 0
v_mfma_f32_16x16x32_bf16 v[40:43], a[196:199], a[116:119], v[40:43]
v_mfma_f32_16x16x32_bf16 v[40:43], a[200:203], a[120:123], v[40:43]
v_mfma_f32_16x16x32_bf16 v[40:43], a[204:207], a[124:127], v[40:43]
v_mfma_f32_16x16x32_bf16 v[44:47], a[208:211], a[112:115], 0
v_mfma_f32_16x16x32_bf16 v[44:47], a[212:215], a[116:119], v[44:47]
v_mfma_f32_16x16x32_bf16 v[44:47], a[216:219], a[120:123], v[44:47]
v_mfma_f32_16x16x32_bf16 v[44:47], a[220:223], a[124:127], v[44:47]
s_nop 3
v_fma_f32 v40, v40, s30, -v21
v_fma_f32 v41, v41, s30, -v21
v_fma_f32 v42, v42, s30, -v21
v_fma_f32 v43, v43, s30, -v21
v_fma_f32 v44, v44, s30, -v21
v_fma_f32 v45, v45, s30, -v21
v_fma_f32 v46, v46, s30, -v21
v_fma_f32 v47, v47, s30, -v21
v_exp_f32 v40, v40
v_exp_f32 v41, v41
v_exp_f32 v42, v42
v_exp_f32 v43, v43
v_exp_f32 v44, v44
v_exp_f32 v45, v45
v_exp_f32 v46, v46
v_exp_f32 v47, v47
v_add_f32 v13, v13, v40
v_add_f32 v13, v13, v41
v_add_f32 v13, v13, v42
v_add_f32 v13, v13, v43
v_add_f32 v13, v13, v44
v_add_f32 v13, v13, v45
v_add_f32 v13, v13, v46
v_add_f32 v13, v13, v47
v_cvt_pk_bf16_f32 v52, v40, v41
v_cvt_pk_bf16_f32 v53, v42, v43
v_cvt_pk_bf16_f32 v54, v44, v45
v_cvt_pk_bf16_f32 v55, v46, v47
s_nop 1
v_mfma_f32_16x16x32_bf16 a[32:35], a[224:227], v[52:55], a[32:35]
v_mfma_f32_16x16x32_bf16 a[36:39], a[228:231], v[52:55], a[36:39]
v_mfma_f32_16x16x32_bf16 a[40:43], a[232:235], v[52:55], a[40:43]
v_mfma_f32_16x16x32_bf16 a[44:47], a[236:239], v[52:55], a[44:47]
v_mfma_f32_16x16x32_bf16 a[48:51], a[240:243], v[52:55], a[48:51]
v_mfma_f32_16x16x32_bf16 a[52:55], a[244:247], v[52:55], a[52:55]
v_mfma_f32_16x16x32_bf16 a[56:59], a[248:251], v[52:55], a[56:59]
v_mfma_f32_16x16x32_bf16 a[60:63], a[252:255], v[52:55], a[60:63]
v_mfma_f32_16x16x32_bf16 v[32:35], a[192:195], a[128:131], 0
v_mfma_f32_16x16x32_bf16 v[32:35], a[196:199], a[132:135], v[32:35]
v_mfma_f32_16x16x32_bf16 v[32:35], a[200:203], a[136:139], v[32:35]
v_mfma_f32_16x16x32_bf16 v[32:35], a[204:207], a[140:143], v[32:35]
v_mfma_f32_16x16x32_bf16 v[36:39], a[208:211], a[128:131], 0
v_mfma_f32_16x16x32_bf16 v[36:39], a[212:215], a[132:135], v[36:39]
v_mfma_f32_16x16x32_bf16 v[36:39], a[216:219], a[136:139], v[36:39]
v_mfma_f32_16x16x32_bf16 v[36:39], a[220:223], a[140:143], v[36:39]
s_nop 3
v_fma_f32 v32, v32, s30, -v22
v_fma_f32 v33, v33, s30, -v22
v_fma_f32 v34, v34, s30, -v22
v_fma_f32 v35, v35, s30, -v22
v_fma_f32 v36, v36, s30, -v22
v_fma_f32 v37, v37, s30, -v22
v_fma_f32 v38, v38, s30, -v22
v_fma_f32 v39, v39, s30, -v22
v_exp_f32 v32, v32
v_exp_f32 v33, v33
v_exp_f32 v34, v34
v_exp_f32 v35, v35
v_exp_f32 v36, v36
v_exp_f32 v37, v37
v_exp_f32 v38, v38
v_exp_f32 v39, v39
v_add_f32 v14, v14, v32
v_add_f32 v14, v14, v33
v_add_f32 v14, v14, v34
v_add_f32 v14, v14, v35
v_add_f32 v14, v14, v36
v_add_f32 v14, v14, v37
v_add_f32 v14, v14, v38
v_add_f32 v14, v14, v39
v_cvt_pk_bf16_f32 v48, v32, v33
v_cvt_pk_bf16_f32 v49, v34, v35
v_cvt_pk_bf16_f32 v50, v36, v37
v_cvt_pk_bf16_f32 v51, v38, v39
s_nop 1
v_mfma_f32_16x16x32_bf16 a[64:67], a[224:227], v[48:51], a[64:67]
v_mfma_f32_16x16x32_bf16 a[68:71], a[228:231], v[48:51], a[68:71]
v_mfma_f32_16x16x32_bf16 a[72:75], a[232:235], v[48:51], a[72:75]
v_mfma_f32_16x16x32_bf16 a[76:79], a[236:239], v[48:51], a[76:79]
v_mfma_f32_16x16x32_bf16 a[80:83], a[240:243], v[48:51], a[80:83]
v_mfma_f32_16x16x32_bf16 a[84:87], a[244:247], v[48:51], a[84:87]
v_mfma_f32_16x16x32_bf16 a[88:91], a[248:251], v[48:51], a[88:91]
v_mfma_f32_16x16x32_bf16 a[92:95], a[252:255], v[48:51], a[92:95]
v_mfma_f32_16x16x32_bf16 v[40:43], a[192:195], a[144:147], 0
v_mfma_f32_16x16x32_bf16 v[40:43], a[196:199], a[148:151], v[40:43]
v_mfma_f32_16x16x32_bf16 v[40:43], a[200:203], a[152:155], v[40:43]
v_mfma_f32_16x16x32_bf16 v[40:43], a[204:207], a[156:159], v[40:43]
v_mfma_f32_16x16x32_bf16 v[44:47], a[208:211], a[144:147], 0
v_mfma_f32_16x16x32_bf16 v[44:47], a[212:215], a[148:151], v[44:47]
v_mfma_f32_16x16x32_bf16 v[44:47], a[216:219], a[152:155], v[44:47]
v_mfma_f32_16x16x32_bf16 v[44:47], a[220:223], a[156:159], v[44:47]
s_nop 3
v_fma_f32 v40, v40, s30, -v23
v_fma_f32 v41, v41, s30, -v23
v_fma_f32 v42, v42, s30, -v23
v_fma_f32 v43, v43, s30, -v23
v_fma_f32 v44, v44, s30, -v23
v_fma_f32 v45, v45, s30, -v23
v_fma_f32 v46, v46, s30, -v23
v_fma_f32 v47, v47, s30, -v23
v_exp_f32 v40, v40
v_exp_f32 v41, v41
v_exp_f32 v42, v42
v_exp_f32 v43, v43
v_exp_f32 v44, v44
v_exp_f32 v45, v45
v_exp_f32 v46, v46
v_exp_f32 v47, v47
v_add_f32 v15, v15, v40
v_add_f32 v15, v15, v41
v_add_f32 v15, v15, v42
v_add_f32 v15, v15, v43
v_add_f32 v15, v15, v44
v_add_f32 v15, v15, v45
v_add_f32 v15, v15, v46
v_add_f32 v15, v15, v47
v_cvt_pk_bf16_f32 v52, v40, v41
v_cvt_pk_bf16_f32 v53, v42, v43
v_cvt_pk_bf16_f32 v54, v44, v45
v_cvt_pk_bf16_f32 v55, v46, v47
s_nop 1
v_mfma_f32_16x16x32_bf16 v[64:67], a[224:227], v[52:55], v[64:67]
v_mfma_f32_16x16x32_bf16 v[68:71], a[228:231], v[52:55], v[68:71]
v_mfma_f32_16x16x32_bf16 v[72:75], a[232:235], v[52:55], v[72:75]
v_mfma_f32_16x16x32_bf16 v[76:79], a[236:239], v[52:55], v[76:79]
v_mfma_f32_16x16x32_bf16 v[80:83], a[240:243], v[52:55], v[80:83]
v_mfma_f32_16x16x32_bf16 v[84:87], a[244:247], v[52:55], v[84:87]
v_mfma_f32_16x16x32_bf16 v[88:91], a[248:251], v[52:55], v[88:91]
v_mfma_f32_16x16x32_bf16 v[92:95], a[252:255], v[52:55], v[92:95]
v_mfma_f32_16x16x32_bf16 v[32:35], a[192:195], a[160:163], 0
v_mfma_f32_16x16x32_bf16 v[32:35], a[196:199], a[164:167], v[32:35]
v_mfma_f32_16x16x32_bf16 v[32:35], a[200:203], a[168:171], v[32:35]
v_mfma_f32_16x16x32_bf16 v[32:35], a[204:207], a[172:175], v[32:35]
v_mfma_f32_16x16x32_bf16 v[36:39], a[208:211], a[160:163], 0
v_mfma_f32_16x16x32_bf16 v[36:39], a[212:215], a[164:167], v[36:39]
v_mfma_f32_16x16x32_bf16 v[36:39], a[216:219], a[168:171], v[36:39]
v_mfma_f32_16x16x32_bf16 v[36:39], a[220:223], a[172:175], v[36:39]
s_nop 3
v_fma_f32 v32, v32, s30, -v24
v_fma_f32 v33, v33, s30, -v24
v_fma_f32 v34, v34, s30, -v24
v_fma_f32 v35, v35, s30, -v24
v_fma_f32 v36, v36, s30, -v24
v_fma_f32 v37, v37, s30, -v24
v_fma_f32 v38, v38, s30, -v24
v_fma_f32 v39, v39, s30, -v24
v_exp_f32 v32, v32
v_exp_f32 v33, v33
v_exp_f32 v34, v34
v_exp_f32 v35, v35
v_exp_f32 v36, v36
v_exp_f32 v37, v37
v_exp_f32 v38, v38
v_exp_f32 v39, v39
v_add_f32 v16, v16, v32
v_add_f32 v16, v16, v33
v_add_f32 v16, v16, v34
v_add_f32 v16, v16, v35
v_add_f32 v16, v16, v36
v_add_f32 v16, v16, v37
v_add_f32 v16, v16, v38
v_add_f32 v16, v16, v39
v_cvt_pk_bf16_f32 v48, v32, v33
v_cvt_pk_bf16_f32 v49, v34, v35
v_cvt_pk_bf16_f32 v50, v36, v37
v_cvt_pk_bf16_f32 v51, v38, v39
s_nop 1
v_mfma_f32_16x16x32_bf16 v[96:99], a[224:227], v[48:51], v[96:99]
v_mfma_f32_16x16x32_bf16 v[100:103], a[228:231], v[48:51], v[100:103]
v_mfma_f32_16x16x32_bf16 v[104:107], a[232:235], v[48:51], v[104:107]
v_mfma_f32_16x16x32_bf16 v[108:111], a[236:239], v[48:51], v[108:111]
v_mfma_f32_16x16x32_bf16 v[112:115], a[240:243], v[48:51], v[112:115]
v_mfma_f32_16x16x32_bf16 v[116:119], a[244:247], v[48:51], v[116:119]
v_mfma_f32_16x16x32_bf16 v[120:123], a[248:251], v[48:51], v[120:123]
v_mfma_f32_16x16x32_bf16 v[124:127], a[252:255], v[48:51], v[124:127]
v_mfma_f32_16x16x32_bf16 v[40:43], a[192:195], a[176:179], 0
v_mfma_f32_16x16x32_bf16 v[40:43], a[196:199], a[180:183], v[40:43]
v_mfma_f32_16x16x32_bf16 v[40:43], a[200:203], a[184:187], v[40:43]
v_mfma_f32_16x16x32_bf16 v[40:43], a[204:207], a[188:191], v[40:43]
v_mfma_f32_16x16x32_bf16 v[44:47], a[208:211], a[176:179], 0
v_mfma_f32_16x16x32_bf16 v[44:47], a[212:215], a[180:183], v[44:47]
v_mfma_f32_16x16x32_bf16 v[44:47], a[216:219], a[184:187], v[44:47]
v_mfma_f32_16x16x32_bf16 v[44:47], a[220:223], a[188:191], v[44:47]
s_nop 3
v_fma_f32 v40, v40, s30, -v25
v_fma_f32 v41, v41, s30, -v25
v_fma_f32 v42, v42, s30, -v25
v_fma_f32 v43, v43, s30, -v25
v_fma_f32 v44, v44, s30, -v25
v_fma_f32 v45, v45, s30, -v25
v_fma_f32 v46, v46, s30, -v25
v_fma_f32 v47, v47, s30, -v25
v_exp_f32 v40, v40
v_exp_f32 v41, v41
v_exp_f32 v42, v42
v_exp_f32 v43, v43
v_exp_f32 v44, v44
v_exp_f32 v45, v45
v_exp_f32 v46, v46
v_exp_f32 v47, v47
v_add_f32 v17, v17, v40
v_add_f32 v17, v17, v41
v_add_f32 v17, v17, v42
v_add_f32 v17, v17, v43
v_add_f32 v17, v17, v44
v_add_f32 v17, v17, v45
v_add_f32 v17, v17, v46
v_add_f32 v17, v17, v47
v_cvt_pk_bf16_f32 v52, v40, v41
v_cvt_pk_bf16_f32 v53, v42, v43
v_cvt_pk_bf16_f32 v54, v44, v45
v_cvt_pk_bf16_f32 v55, v46, v47
s_nop 1
v_mfma_f32_16x16x32_bf16 v[128:131], a[224:227], v[52:55], v[128:131]
v_mfma_f32_16x16x32_bf16 v[132:135], a[228:231], v[52:55], v[132:135]
v_mfma_f32_16x16x32_bf16 v[136:139], a[232:235], v[52:55], v[136:139]
v_mfma_f32_16x16x32_bf16 v[140:143], a[236:239], v[52:55], v[140:143]
v_mfma_f32_16x16x32_bf16 v[144:147], a[240:243], v[52:55], v[144:147]
v_mfma_f32_16x16x32_bf16 v[148:151], a[244:247], v[52:55], v[148:151]
v_mfma_f32_16x16x32_bf16 v[152:155], a[248:251], v[52:55], v[152:155]
v_mfma_f32_16x16x32_bf16 v[156:159], a[252:255], v[52:55], v[156:159]
s_add_u32 s34, s34, 8192
s_add_u32 s23, s23, 1
s_cmp_lt_u32 s23, 16
s_cbranch_scc1 Lslow_p2
v_mov_b32 v26, v12
v_mov_b32 v27, v13
v_mov_b32 v28, v14
v_mov_b32 v29, v15
v_mov_b32 v30, v16
v_mov_b32 v31, v17
v_permlane32_swap_b32 v12, v26
v_permlane32_swap_b32 v13, v27
v_permlane32_swap_b32 v14, v28
v_permlane32_swap_b32 v15, v29
v_permlane32_swap_b32 v16, v30
v_permlane32_swap_b32 v17, v31
v_add_f32 v12, v12, v26
v_add_f32 v13, v13, v27
v_add_f32 v14, v14, v28
v_add_f32 v15, v15, v29
v_add_f32 v16, v16, v30
v_add_f32 v17, v17, v31
v_mov_b32 v26, v12
v_mov_b32 v27, v13
v_mov_b32 v28, v14
v_mov_b32 v29, v15
v_mov_b32 v30, v16
v_mov_b32 v31, v17
v_permlane16_swap_b32 v12, v26
v_permlane16_swap_b32 v13, v27
v_permlane16_swap_b32 v14, v28
v_permlane16_swap_b32 v15, v29
v_permlane16_swap_b32 v16, v30
v_permlane16_swap_b32 v17, v31
v_add_f32 v12, v12, v26
v_add_f32 v13, v13, v27
v_add_f32 v14, v14, v28
v_add_f32 v15, v15, v29
v_add_f32 v16, v16, v30
v_add_f32 v17, v17, v31
v_rcp_f32 v10, v12
s_add_u32 s50, s24, 0
v_accvgpr_read_b32 v56, a0
v_accvgpr_read_b32 v57, a1
v_accvgpr_read_b32 v58, a2
v_accvgpr_read_b32 v59, a3
v_accvgpr_read_b32 v60, a4
v_accvgpr_read_b32 v61, a5
v_accvgpr_read_b32 v62, a6
v_accvgpr_read_b32 v63, a7
v_pk_mul_f32 v[56:57], v[56:57], v[10:11] op_sel_hi:[1,0]
v_pk_mul_f32 v[58:59], v[58:59], v[10:11] op_sel_hi:[1,0]
v_pk_mul_f32 v[60:61], v[60:61], v[10:11] op_sel_hi:[1,0]
v_pk_mul_f32 v[62:63], v[62:63], v[10:11] op_sel_hi:[1,0]
v_cvt_pk_bf16_f32 v160, v56, v57
v_cvt_pk_bf16_f32 v161, v58, v59
v_cvt_pk_bf16_f32 v162, v60, v61
v_cvt_pk_bf16_f32 v163, v62, v63
buffer_store_dwordx4 v[160:163], v6, s[16:19], s50 offen offset:0
v_accvgpr_read_b32 v56, a8
v_accvgpr_read_b32 v57, a9
v_accvgpr_read_b32 v58, a10
v_accvgpr_read_b32 v59, a11
v_accvgpr_read_b32 v60, a12
v_accvgpr_read_b32 v61, a13
v_accvgpr_read_b32 v62, a14
v_accvgpr_read_b32 v63, a15
v_pk_mul_f32 v[56:57], v[56:57], v[10:11] op_sel_hi:[1,0]
v_pk_mul_f32 v[58:59], v[58:59], v[10:11] op_sel_hi:[1,0]
v_pk_mul_f32 v[60:61], v[60:61], v[10:11] op_sel_hi:[1,0]
v_pk_mul_f32 v[62:63], v[62:63], v[10:11] op_sel_hi:[1,0]
v_cvt_pk_bf16_f32 v164, v56, v57
v_cvt_pk_bf16_f32 v165, v58, v59
v_cvt_pk_bf16_f32 v166, v60, v61
v_cvt_pk_bf16_f32 v167, v62, v63
buffer_store_dwordx4 v[164:167], v6, s[16:19], s50 offen offset:64
v_accvgpr_read_b32 v56, a16
v_accvgpr_read_b32 v57, a17
v_accvgpr_read_b32 v58, a18
v_accvgpr_read_b32 v59, a19
v_accvgpr_read_b32 v60, a20
v_accvgpr_read_b32 v61, a21
v_accvgpr_read_b32 v62, a22
v_accvgpr_read_b32 v63, a23
v_pk_mul_f32 v[56:57], v[56:57], v[10:11] op_sel_hi:[1,0]
v_pk_mul_f32 v[58:59], v[58:59], v[10:11] op_sel_hi:[1,0]
v_pk_mul_f32 v[60:61], v[60:61], v[10:11] op_sel_hi:[1,0]
v_pk_mul_f32 v[62:63], v[62:63], v[10:11] op_sel_hi:[1,0]
v_cvt_pk_bf16_f32 v168, v56, v57
v_cvt_pk_bf16_f32 v169, v58, v59
v_cvt_pk_bf16_f32 v170, v60, v61
v_cvt_pk_bf16_f32 v171, v62, v63
buffer_store_dwordx4 v[168:171], v6, s[16:19], s50 offen offset:128
v_accvgpr_read_b32 v56, a24
v_accvgpr_read_b32 v57, a25
v_accvgpr_read_b32 v58, a26
v_accvgpr_read_b32 v59, a27
v_accvgpr_read_b32 v60, a28
v_accvgpr_read_b32 v61, a29
v_accvgpr_read_b32 v62, a30
v_accvgpr_read_b32 v63, a31
v_pk_mul_f32 v[56:57], v[56:57], v[10:11] op_sel_hi:[1,0]
v_pk_mul_f32 v[58:59], v[58:59], v[10:11] op_sel_hi:[1,0]
v_pk_mul_f32 v[60:61], v[60:61], v[10:11] op_sel_hi:[1,0]
v_pk_mul_f32 v[62:63], v[62:63], v[10:11] op_sel_hi:[1,0]
v_cvt_pk_bf16_f32 v172, v56, v57
v_cvt_pk_bf16_f32 v173, v58, v59
v_cvt_pk_bf16_f32 v174, v60, v61
v_cvt_pk_bf16_f32 v175, v62, v63
buffer_store_dwordx4 v[172:175], v6, s[16:19], s50 offen offset:192
v_rcp_f32 v10, v13
s_add_u32 s50, s24, 4096
v_accvgpr_read_b32 v56, a32
v_accvgpr_read_b32 v57, a33
v_accvgpr_read_b32 v58, a34
v_accvgpr_read_b32 v59, a35
v_accvgpr_read_b32 v60, a36
v_accvgpr_read_b32 v61, a37
v_accvgpr_read_b32 v62, a38
v_accvgpr_read_b32 v63, a39
v_pk_mul_f32 v[56:57], v[56:57], v[10:11] op_sel_hi:[1,0]
v_pk_mul_f32 v[58:59], v[58:59], v[10:11] op_sel_hi:[1,0]
v_pk_mul_f32 v[60:61], v[60:61], v[10:11] op_sel_hi:[1,0]
v_pk_mul_f32 v[62:63], v[62:63], v[10:11] op_sel_hi:[1,0]
v_cvt_pk_bf16_f32 v176, v56, v57
v_cvt_pk_bf16_f32 v177, v58, v59
v_cvt_pk_bf16_f32 v178, v60, v61
v_cvt_pk_bf16_f32 v179, v62, v63
buffer_store_dwordx4 v[176:179], v6, s[16:19], s50 offen offset:0
v_accvgpr_read_b32 v56, a40
v_accvgpr_read_b32 v57, a41
v_accvgpr_read_b32 v58, a42
v_accvgpr_read_b32 v59, a43
v_accvgpr_read_b32 v60, a44
v_accvgpr_read_b32 v61, a45
v_accvgpr_read_b32 v62, a46
v_accvgpr_read_b32 v63, a47
v_pk_mul_f32 v[56:57], v[56:57], v[10:11] op_sel_hi:[1,0]
v_pk_mul_f32 v[58:59], v[58:59], v[10:11] op_sel_hi:[1,0]
v_pk_mul_f32 v[60:61], v[60:61], v[10:11] op_sel_hi:[1,0]
v_pk_mul_f32 v[62:63], v[62:63], v[10:11] op_sel_hi:[1,0]
v_cvt_pk_bf16_f32 v180, v56, v57
v_cvt_pk_bf16_f32 v181, v58, v59
v_cvt_pk_bf16_f32 v182, v60, v61
v_cvt_pk_bf16_f32 v183, v62, v63
buffer_store_dwordx4 v[180:183], v6, s[16:19], s50 offen offset:64
v_accvgpr_read_b32 v56, a48
v_accvgpr_read_b32 v57, a49
v_accvgpr_read_b32 v58, a50
v_accvgpr_read_b32 v59, a51
v_accvgpr_read_b32 v60, a52
v_accvgpr_read_b32 v61, a53
v_accvgpr_read_b32 v62, a54
v_accvgpr_read_b32 v63, a55
v_pk_mul_f32 v[56:57], v[56:57], v[10:11] op_sel_hi:[1,0]
v_pk_mul_f32 v[58:59], v[58:59], v[10:11] op_sel_hi:[1,0]
v_pk_mul_f32 v[60:61], v[60:61], v[10:11] op_sel_hi:[1,0]
v_pk_mul_f32 v[62:63], v[62:63], v[10:11] op_sel_hi:[1,0]
v_cvt_pk_bf16_f32 v184, v56, v57
v_cvt_pk_bf16_f32 v185, v58, v59
v_cvt_pk_bf16_f32 v186, v60, v61
v_cvt_pk_bf16_f32 v187, v62, v63
buffer_store_dwordx4 v[184:187], v6, s[16:19], s50 offen offset:128
v_accvgpr_read_b32 v56, a56
v_accvgpr_read_b32 v57, a57
v_accvgpr_read_b32 v58, a58
v_accvgpr_read_b32 v59, a59
v_accvgpr_read_b32 v60, a60
v_accvgpr_read_b32 v61, a61
v_accvgpr_read_b32 v62, a62
v_accvgpr_read_b32 v63, a63
v_pk_mul_f32 v[56:57], v[56:57], v[10:11] op_sel_hi:[1,0]
v_pk_mul_f32 v[58:59], v[58:59], v[10:11] op_sel_hi:[1,0]
v_pk_mul_f32 v[60:61], v[60:61], v[10:11] op_sel_hi:[1,0]
v_pk_mul_f32 v[62:63], v[62:63], v[10:11] op_sel_hi:[1,0]
v_cvt_pk_bf16_f32 v188, v56, v57
v_cvt_pk_bf16_f32 v189, v58, v59
v_cvt_pk_bf16_f32 v190, v60, v61
v_cvt_pk_bf16_f32 v191, v62, v63
buffer_store_dwordx4 v[188:191], v6, s[16:19], s50 offen offset:192
v_rcp_f32 v10, v14
s_add_u32 s50, s24, 8192
v_accvgpr_read_b32 v56, a64
v_accvgpr_read_b32 v57, a65
v_accvgpr_read_b32 v58, a66
v_accvgpr_read_b32 v59, a67
v_accvgpr_read_b32 v60, a68
v_accvgpr_read_b32 v61, a69
v_accvgpr_read_b32 v62, a70
v_accvgpr_read_b32 v63, a71
v_pk_mul_f32 v[56:57], v[56:57], v[10:11] op_sel_hi:[1,0]
v_pk_mul_f32 v[58:59], v[58:59], v[10:11] op_sel_hi:[1,0]
v_pk_mul_f32 v[60:61], v[60:61], v[10:11] op_sel_hi:[1,0]
v_pk_mul_f32 v[62:63], v[62:63], v[10:11] op_sel_hi:[1,0]
v_cvt_pk_bf16_f32 v192, v56, v57
v_cvt_pk_bf16_f32 v193, v58, v59
v_cvt_pk_bf16_f32 v194, v60, v61
v_cvt_pk_bf16_f32 v195, v62, v63
buffer_store_dwordx4 v[192:195], v6, s[16:19], s50 offen offset:0
v_accvgpr_read_b32 v56, a72
v_accvgpr_read_b32 v57, a73
v_accvgpr_read_b32 v58, a74
v_accvgpr_read_b32 v59, a75
v_accvgpr_read_b32 v60, a76
v_accvgpr_read_b32 v61, a77
v_accvgpr_read_b32 v62, a78
v_accvgpr_read_b32 v63, a79
v_pk_mul_f32 v[56:57], v[56:57], v[10:11] op_sel_hi:[1,0]
v_pk_mul_f32 v[58:59], v[58:59], v[10:11] op_sel_hi:[1,0]
v_pk_mul_f32 v[60:61], v[60:61], v[10:11] op_sel_hi:[1,0]
v_pk_mul_f32 v[62:63], v[62:63], v[10:11] op_sel_hi:[1,0]
v_cvt_pk_bf16_f32 v196, v56, v57
v_cvt_pk_bf16_f32 v197, v58, v59
v_cvt_pk_bf16_f32 v198, v60, v61
v_cvt_pk_bf16_f32 v199, v62, v63
buffer_store_dwordx4 v[196:199], v6, s[16:19], s50 offen offset:64
v_accvgpr_read_b32 v56, a80
v_accvgpr_read_b32 v57, a81
v_accvgpr_read_b32 v58, a82
v_accvgpr_read_b32 v59, a83
v_accvgpr_read_b32 v60, a84
v_accvgpr_read_b32 v61, a85
v_accvgpr_read_b32 v62, a86
v_accvgpr_read_b32 v63, a87
v_pk_mul_f32 v[56:57], v[56:57], v[10:11] op_sel_hi:[1,0]
v_pk_mul_f32 v[58:59], v[58:59], v[10:11] op_sel_hi:[1,0]
v_pk_mul_f32 v[60:61], v[60:61], v[10:11] op_sel_hi:[1,0]
v_pk_mul_f32 v[62:63], v[62:63], v[10:11] op_sel_hi:[1,0]
v_cvt_pk_bf16_f32 v200, v56, v57
v_cvt_pk_bf16_f32 v201, v58, v59
v_cvt_pk_bf16_f32 v202, v60, v61
v_cvt_pk_bf16_f32 v203, v62, v63
buffer_store_dwordx4 v[200:203], v6, s[16:19], s50 offen offset:128
v_accvgpr_read_b32 v56, a88
v_accvgpr_read_b32 v57, a89
v_accvgpr_read_b32 v58, a90
v_accvgpr_read_b32 v59, a91
v_accvgpr_read_b32 v60, a92
v_accvgpr_read_b32 v61, a93
v_accvgpr_read_b32 v62, a94
v_accvgpr_read_b32 v63, a95
v_pk_mul_f32 v[56:57], v[56:57], v[10:11] op_sel_hi:[1,0]
v_pk_mul_f32 v[58:59], v[58:59], v[10:11] op_sel_hi:[1,0]
v_pk_mul_f32 v[60:61], v[60:61], v[10:11] op_sel_hi:[1,0]
v_pk_mul_f32 v[62:63], v[62:63], v[10:11] op_sel_hi:[1,0]
v_cvt_pk_bf16_f32 v204, v56, v57
v_cvt_pk_bf16_f32 v205, v58, v59
v_cvt_pk_bf16_f32 v206, v60, v61
v_cvt_pk_bf16_f32 v207, v62, v63
buffer_store_dwordx4 v[204:207], v6, s[16:19], s50 offen offset:192
v_rcp_f32 v10, v15
s_add_u32 s50, s24, 12288
v_pk_mul_f32 v[64:65], v[64:65], v[10:11] op_sel_hi:[1,0]
v_pk_mul_f32 v[66:67], v[66:67], v[10:11] op_sel_hi:[1,0]
v_pk_mul_f32 v[68:69], v[68:69], v[10:11] op_sel_hi:[1,0]
v_pk_mul_f32 v[70:71], v[70:71], v[10:11] op_sel_hi:[1,0]
v_cvt_pk_bf16_f32 v208, v64, v65
v_cvt_pk_bf16_f32 v209, v66, v67
v_cvt_pk_bf16_f32 v210, v68, v69
v_cvt_pk_bf16_f32 v211, v70, v71
buffer_store_dwordx4 v[208:211], v6, s[16:19], s50 offen offset:0
v_pk_mul_f32 v[72:73], v[72:73], v[10:11] op_sel_hi:[1,0]
v_pk_mul_f32 v[74:75], v[74:75], v[10:11] op_sel_hi:[1,0]
v_pk_mul_f32 v[76:77], v[76:77], v[10:11] op_sel_hi:[1,0]
v_pk_mul_f32 v[78:79], v[78:79], v[10:11] op_sel_hi:[1,0]
v_cvt_pk_bf16_f32 v212, v72, v73
v_cvt_pk_bf16_f32 v213, v74, v75
v_cvt_pk_bf16_f32 v214, v76, v77
v_cvt_pk_bf16_f32 v215, v78, v79
buffer_store_dwordx4 v[212:215], v6, s[16:19], s50 offen offset:64
v_pk_mul_f32 v[80:81], v[80:81], v[10:11] op_sel_hi:[1,0]
v_pk_mul_f32 v[82:83], v[82:83], v[10:11] op_sel_hi:[1,0]
v_pk_mul_f32 v[84:85], v[84:85], v[10:11] op_sel_hi:[1,0]
v_pk_mul_f32 v[86:87], v[86:87], v[10:11] op_sel_hi:[1,0]
v_cvt_pk_bf16_f32 v216, v80, v81
v_cvt_pk_bf16_f32 v217, v82, v83
v_cvt_pk_bf16_f32 v218, v84, v85
v_cvt_pk_bf16_f32 v219, v86, v87
buffer_store_dwordx4 v[216:219], v6, s[16:19], s50 offen offset:128
v_pk_mul_f32 v[88:89], v[88:89], v[10:11] op_sel_hi:[1,0]
v_pk_mul_f32 v[90:91], v[90:91], v[10:11] op_sel_hi:[1,0]
v_pk_mul_f32 v[92:93], v[92:93], v[10:11] op_sel_hi:[1,0]
v_pk_mul_f32 v[94:95], v[94:95], v[10:11] op_sel_hi:[1,0]
v_cvt_pk_bf16_f32 v220, v88, v89
v_cvt_pk_bf16_f32 v221, v90, v91
v_cvt_pk_bf16_f32 v222, v92, v93
v_cvt_pk_bf16_f32 v223, v94, v95
buffer_store_dwordx4 v[220:223], v6, s[16:19], s50 offen offset:192
v_rcp_f32 v10, v16
s_add_u32 s50, s24, 16384
v_pk_mul_f32 v[96:97], v[96:97], v[10:11] op_sel_hi:[1,0]
v_pk_mul_f32 v[98:99], v[98:99], v[10:11] op_sel_hi:[1,0]
v_pk_mul_f32 v[100:101], v[100:101], v[10:11] op_sel_hi:[1,0]
v_pk_mul_f32 v[102:103], v[102:103], v[10:11] op_sel_hi:[1,0]
v_cvt_pk_bf16_f32 v224, v96, v97
v_cvt_pk_bf16_f32 v225, v98, v99
v_cvt_pk_bf16_f32 v226, v100, v101
v_cvt_pk_bf16_f32 v227, v102, v103
buffer_store_dwordx4 v[224:227], v6, s[16:19], s50 offen offset:0
v_pk_mul_f32 v[104:105], v[104:105], v[10:11] op_sel_hi:[1,0]
v_pk_mul_f32 v[106:107], v[106:107], v[10:11] op_sel_hi:[1,0]
v_pk_mul_f32 v[108:109], v[108:109], v[10:11] op_sel_hi:[1,0]
v_pk_mul_f32 v[110:111], v[110:111], v[10:11] op_sel_hi:[1,0]
v_cvt_pk_bf16_f32 v228, v104, v105
v_cvt_pk_bf16_f32 v229, v106, v107
v_cvt_pk_bf16_f32 v230, v108, v109
v_cvt_pk_bf16_f32 v231, v110, v111
buffer_store_dwordx4 v[228:231], v6, s[16:19], s50 offen offset:64
v_pk_mul_f32 v[112:113], v[112:113], v[10:11] op_sel_hi:[1,0]
v_pk_mul_f32 v[114:115], v[114:115], v[10:11] op_sel_hi:[1,0]
v_pk_mul_f32 v[116:117], v[116:117], v[10:11] op_sel_hi:[1,0]
v_pk_mul_f32 v[118:119], v[118:119], v[10:11] op_sel_hi:[1,0]
v_cvt_pk_bf16_f32 v232, v112, v113
v_cvt_pk_bf16_f32 v233, v114, v115
v_cvt_pk_bf16_f32 v234, v116, v117
v_cvt_pk_bf16_f32 v235, v118, v119
buffer_store_dwordx4 v[232:235], v6, s[16:19], s50 offen offset:128
v_pk_mul_f32 v[120:121], v[120:121], v[10:11] op_sel_hi:[1,0]
v_pk_mul_f32 v[122:123], v[122:123], v[10:11] op_sel_hi:[1,0]
v_pk_mul_f32 v[124:125], v[124:125], v[10:11] op_sel_hi:[1,0]
v_pk_mul_f32 v[126:127], v[126:127], v[10:11] op_sel_hi:[1,0]
v_cvt_pk_bf16_f32 v236, v120, v121
v_cvt_pk_bf16_f32 v237, v122, v123
v_cvt_pk_bf16_f32 v238, v124, v125
v_cvt_pk_bf16_f32 v239, v126, v127
buffer_store_dwordx4 v[236:239], v6, s[16:19], s50 offen offset:192
v_rcp_f32 v10, v17
s_add_u32 s50, s24, 20480
v_pk_mul_f32 v[128:129], v[128:129], v[10:11] op_sel_hi:[1,0]
v_pk_mul_f32 v[130:131], v[130:131], v[10:11] op_sel_hi:[1,0]
v_pk_mul_f32 v[132:133], v[132:133], v[10:11] op_sel_hi:[1,0]
v_pk_mul_f32 v[134:135], v[134:135], v[10:11] op_sel_hi:[1,0]
v_cvt_pk_bf16_f32 v240, v128, v129
v_cvt_pk_bf16_f32 v241, v130, v131
v_cvt_pk_bf16_f32 v242, v132, v133
v_cvt_pk_bf16_f32 v243, v134, v135
buffer_store_dwordx4 v[240:243], v6, s[16:19], s50 offen offset:0
v_pk_mul_f32 v[136:137], v[136:137], v[10:11] op_sel_hi:[1,0]
v_pk_mul_f32 v[138:139], v[138:139], v[10:11] op_sel_hi:[1,0]
v_pk_mul_f32 v[140:141], v[140:141], v[10:11] op_sel_hi:[1,0]
v_pk_mul_f32 v[142:143], v[142:143], v[10:11] op_sel_hi:[1,0]
v_cvt_pk_bf16_f32 v244, v136, v137
v_cvt_pk_bf16_f32 v245, v138, v139
v_cvt_pk_bf16_f32 v246, v140, v141
v_cvt_pk_bf16_f32 v247, v142, v143
buffer_store_dwordx4 v[244:247], v6, s[16:19], s50 offen offset:64
v_pk_mul_f32 v[144:145], v[144:145], v[10:11] op_sel_hi:[1,0]
v_pk_mul_f32 v[146:147], v[146:147], v[10:11] op_sel_hi:[1,0]
v_pk_mul_f32 v[148:149], v[148:149], v[10:11] op_sel_hi:[1,0]
v_pk_mul_f32 v[150:151], v[150:151], v[10:11] op_sel_hi:[1,0]
v_cvt_pk_bf16_f32 v248, v144, v145
v_cvt_pk_bf16_f32 v249, v146, v147
v_cvt_pk_bf16_f32 v250, v148, v149
v_cvt_pk_bf16_f32 v251, v150, v151
buffer_store_dwordx4 v[248:251], v6, s[16:19], s50 offen offset:128
v_pk_mul_f32 v[152:153], v[152:153], v[10:11] op_sel_hi:[1,0]
v_pk_mul_f32 v[154:155], v[154:155], v[10:11] op_sel_hi:[1,0]
v_pk_mul_f32 v[156:157], v[156:157], v[10:11] op_sel_hi:[1,0]
v_pk_mul_f32 v[158:159], v[158:159], v[10:11] op_sel_hi:[1,0]
v_cvt_pk_bf16_f32 v252, v152, v153
v_cvt_pk_bf16_f32 v253, v154, v155
v_cvt_pk_bf16_f32 v254, v156, v157
v_cvt_pk_bf16_f32 v255, v158, v159
buffer_store_dwordx4 v[252:255], v6, s[16:19], s50 offen offset:192
Lslow_next:
s_add_u32 s24, s24, 25165824
s_add_u32 s27, s27, 16777216
s_lshr_b32 s29, s29, 1
s_cbranch_scc1 Lslow_item
s_branch Lfin
s_endpgm
.section .rodata,"a"
.p2align 6
.amdhsa_kernel standalone__gqa_softmax__near_ridge_kernel
  .amdhsa_next_free_vgpr 512
  .amdhsa_next_free_sgpr 102
  .amdhsa_accum_offset 256
  .amdhsa_group_segment_fixed_size 0
  .amdhsa_kernarg_size 48
  .amdhsa_user_sgpr_count 2
  .amdhsa_user_sgpr_kernarg_segment_ptr 1
  .amdhsa_system_sgpr_workgroup_id_x 1
.end_amdhsa_kernel
```
